```python
import torch

def _softmax(x, axis=-1):
    return torch.softmax(x, dim=axis)
def _gelu(x):
    return torch.nn.functional.gelu(x, approximate="tanh")
def _silu(x):
    return torch.nn.functional.silu(x)
def _sigmoid(x):
    return torch.sigmoid(x)
def _layernorm(x, axis=-1, eps=1e-5):
    m = x.mean(dim=axis, keepdim=True)
    v = x.var(dim=axis, keepdim=True, unbiased=False)
    return (x - m) / torch.sqrt(v + eps)
def _scatter_add(tgt, idx, src, axis=0):
    return tgt.clone().index_add_(axis, idx, src)
def _segment_sum(src, seg, n):
    out = torch.zeros((n,) + src.shape[1:], dtype=src.dtype)
    return out.index_add_(0, seg, src)
def _pad(x, pw):
    flat = tuple(v for pair in reversed(pw) for v in pair)
    return torch.nn.functional.pad(x, flat)

kernel_name = 'sequential_preLN__ssm_conv_h3__glu_gated_geglu__prompt'

def setup_inputs():

    _w = (lambda a: (lambda t: t.to(torch.bfloat16) if t.is_floating_point() else t)(torch.as_tensor(a)))
    def _A_setup():
        B, S, D = 1, 2048, 1024
        ks = 4
        return {
            "q": _w((lambda *s: torch.randn(*s, dtype=torch.bfloat16) * 0.05)(B, S, D)),
            "k": _w((lambda *s: torch.randn(*s, dtype=torch.bfloat16) * 0.2)(B, S, D)),
            "v": _w((lambda *s: torch.randn(*s, dtype=torch.bfloat16) * 0.2)(B, S, D)),
            "shift_k": _w((lambda *s: torch.randn(*s, dtype=torch.bfloat16) * 0.2)(D, ks) * 0.5),
            "ssm_k": _w((lambda *s: torch.randn(*s, dtype=torch.bfloat16) * 0.4)(D, S) * (1.0 / S ** 0.5)),
            "ssm_D": _w((lambda *s: torch.randn(*s, dtype=torch.bfloat16) * 0.2)(D)),
        }
    _A_in = _A_setup()

    def _B_setup():
        B, S, Dm, Df = 1, 2048, 1024, 3584
        return {
            "x": _w((lambda *s: torch.randn(*s, dtype=torch.bfloat16) * 0.05)(B, S, Dm)),
            "w_gate": _w((lambda *s: torch.randn(*s, dtype=torch.bfloat16) * 0.4)(Dm, Df) * (Dm ** -0.5)),
            "w_up": _w((lambda *s: torch.randn(*s, dtype=torch.bfloat16) * 0.4)(Dm, Df) * (Dm ** -0.5)),
            "w_down": _w((lambda *s: torch.randn(*s, dtype=torch.bfloat16) * 0.4)(Df, Dm) * (Df ** -0.5)),
        }
    _B_in = _B_setup()

    return {
        "A_q": _A_in["q"],
        "A_k": _A_in["k"],
        "A_v": _A_in["v"],
        "A_shift_k": _A_in["shift_k"],
        "A_ssm_k": _A_in["ssm_k"],
        "A_ssm_D": _A_in["ssm_D"],
        "B_x": _B_in["x"],
        "B_w_gate": _B_in["w_gate"],
        "B_w_up": _B_in["w_up"],
        "B_w_down": _B_in["w_down"],
    }

def reference(A_q, A_k, A_v, A_shift_k, A_ssm_k, A_ssm_D, B_x, B_w_gate, B_w_up, B_w_down):
    def _A_ref(q, k, v, shift_k, ssm_k, ssm_D):
        B, S, D = q.shape
        ks = shift_k.shape[-1]
        k_pad = _pad(k, ((0, 0), (ks - 1, 0), (0, 0)))
        k_shift = torch.zeros_like(k)
        for t in range(ks):
            k_shift = k_shift + k_pad[:, t:t + S, :] * shift_k[:, ks - 1 - t][None, None, :]
        kv = k_shift * v
        L = 2 * S
        kv_pad = _pad(kv, ((0, 0), (0, S), (0, 0)))
        kf_pad = _pad(ssm_k, ((0, 0), (0, S)))
        kv_f = (lambda x, axes=(-2,-1): torch.fft.rfft2(x.float(), dim=axes))(kv_pad[:, None, :, :], axes=(1, 2))
        kf_f = (lambda x, axes=(-2,-1): torch.fft.rfft2(x.float(), dim=axes))(kf_pad[:, None, :], axes=(1, 2))
        kf_f = (lambda x, *d: x.permute(*d))(kf_f, 1, 2, 0)
        y_f = kv_f * kf_f[None, :, :, :]
        y = (lambda x, s, axes=(-2,-1): torch.fft.irfft2(x, s=s, dim=axes).to(torch.bfloat16))(y_f, (1, L), axes=(1, 2))[:, 0, :S, :]
        y = y + kv * ssm_D[None, None, :]
        return q * y

    def _B_ref(x, w_gate, w_up, w_down):
        g = torch.einsum("bsd,df->bsf", x, w_gate)
        u = torch.einsum("bsd,df->bsf", x, w_up)
        h = _gelu(g) * u
        return torch.einsum("bsf,fd->bsd", h, w_down)

    x = A_q
    h = x + _A_ref(_layernorm(x, axis=-1), A_k, A_v, A_shift_k, A_ssm_k, A_ssm_D)
    h2 = h + _B_ref(_layernorm(h, axis=-1), B_w_gate, B_w_up, B_w_down)
    return h2
```

```asm
; @launch grid=(256,1,1) block=(256,1,1) lds=163840
.amdgcn_target "amdgcn-amd-amdhsa--gfx950"
.text
.globl sequential_preLN__ssm_conv_h3__glu_gated_geglu__prompt_kernel
.p2align 8
.type sequential_preLN__ssm_conv_h3__glu_gated_geglu__prompt_kernel,@function
sequential_preLN__ssm_conv_h3__glu_gated_geglu__prompt_kernel:
  s_cmp_ge_u32 s2, 256
  s_cbranch_scc1 L_sequential_preLN__ssm_conv_h3__glu_gated_geglu__prompt_kernel_end
  s_load_dwordx2 s[4:5], s[0:1], 0
  s_load_dwordx4 s[20:23], s[0:1], 8
  s_load_dwordx4 s[24:27], s[0:1], 24
  s_load_dwordx2 s[28:29], s[0:1], 40
  s_load_dwordx4 s[60:63], s[0:1], 56
  s_load_dwordx4 s[64:67], s[0:1], 72
  s_load_dwordx2 s[30:31], s[0:1], 88
  s_load_dwordx2 s[6:7], s[0:1], 96
  v_lshrrev_b32 v1, 6, v0
  v_and_b32 v2, 63, v0
  v_readfirstlane_b32 s17, v1
  s_and_b32 s18, s2, 7
  s_lshr_b32 s19, s2, 3

  v_lshlrev_b32 v15, 4, v2
  s_lshl_b32 s16, s19, 17
  s_lshl_b32 s3, s18, 8
  s_add_u32 s16, s16, s3
  v_and_b32 v3, 31, v0
  v_lshrrev_b32 v4, 5, v0
  v_lshlrev_b32 v5, 14, v4
  v_lshl_add_u32 v5, v3, 3, v5
  v_add_u32 v5, s16, v5
  v_subrev_u32 v6, 6144, v5
  v_mov_b32 v7, 1073741824
  v_cmp_gt_u32 vcc, 2048, v5
  s_mov_b32 s98, 4096
  s_mov_b32 s99, 8192
  v_cndmask_b32 v6, v6, v7, vcc
  s_mov_b32 s100, 12288

  s_getpc_b64 s[40:41]
L_pc:
  s_lshl_b32 s42, s19, 2
  s_add_u32 s42, s42, s17
  s_lshl_b32 s42, s42, 9
  v_and_b32 v10, 3, v2
  v_lshlrev_b32 v10, 7, v10
  v_add_u32 v10, s42, v10
  v_min_u32 v10, L_code_end - L_pc - 4, v10
  v_mov_b32 v11, s41
  v_add_co_u32 v10, vcc, s40, v10
  s_nop 1
  v_addc_co_u32 v11, vcc, 0, v11, vcc

  global_load_dword v20, v[10:11], off
  s_waitcnt lgkmcnt(0)
  s_mov_b32 s8, s20
  s_mov_b32 s9, s21
  s_mov_b32 s10, 4194304
  s_mov_b32 s11, 0x20000
  buffer_load_dwordx2 v[38:39], v5, s[8:11], 0 offen offset:0
  buffer_load_dwordx2 v[40:41], v5, s[8:11], 0 offen offset:2048
  buffer_load_dwordx2 v[42:43], v5, s[8:11], s98 offen offset:0
  buffer_load_dwordx2 v[44:45], v5, s[8:11], s98 offen offset:2048
  buffer_load_dwordx2 v[46:47], v5, s[8:11], s99 offen offset:0
  buffer_load_dwordx2 v[48:49], v5, s[8:11], s99 offen offset:2048
  buffer_load_dwordx2 v[50:51], v5, s[8:11], s100 offen offset:0
  buffer_load_dwordx2 v[52:53], v5, s[8:11], s100 offen offset:2048
  s_mov_b32 s12, s22
  s_mov_b32 s13, s23
  s_mov_b32 s14, 4194304
  s_mov_b32 s15, 0x20000
  buffer_load_dwordx2 v[54:55], v5, s[12:15], 0 offen offset:0
  buffer_load_dwordx2 v[56:57], v5, s[12:15], 0 offen offset:2048
  buffer_load_dwordx2 v[58:59], v5, s[12:15], s98 offen offset:0
  buffer_load_dwordx2 v[60:61], v5, s[12:15], s98 offen offset:2048
  buffer_load_dwordx2 v[62:63], v5, s[12:15], s99 offen offset:0
  buffer_load_dwordx2 v[64:65], v5, s[12:15], s99 offen offset:2048
  buffer_load_dwordx2 v[66:67], v5, s[12:15], s100 offen offset:0
  buffer_load_dwordx2 v[68:69], v5, s[12:15], s100 offen offset:2048
  v_mov_b32 v180, 0
  v_mov_b32 v181, 0
  v_mov_b32 v182, 0
  v_mov_b32 v183, 0
  s_lshl_b32 s101, s2, 7
  v_and_b32 v8, 31, v2
  v_cmp_gt_u32 vcc, 4, v8
  v_lshlrev_b32 v8, 15, v8
  s_nop 0
  v_cndmask_b32 v8, v8, v180, vcc
  v_and_b32 v200, 7, v2
  v_lshrrev_b32 v201, 3, v2
  v_lshlrev_b32 v203, 11, v200
  v_lshl_add_u32 v203, v201, 4, v203
  s_lshl_b32 s3, s2, 14
  s_lshl_b32 s16, s17, 9
  s_add_u32 s3, s3, s16
  v_add_u32 v203, s3, v203
  v_and_b32 v21, 7, v2
  v_lshlrev_b32 v21, 5, v21
  v_sub_u32 v176, 7, v4
  v_and_b32 v177, 7, v3
  v_xor_b32 v176, v176, v177
  v_lshlrev_b32 v176, 4, v176
  v_lshl_add_u32 v176, v3, 9, v176
  v_add_u32 v176, 51712, v176
  v_lshlrev_b32 v177, 4, v0
  v_add_u32 v177, 51712, v177
  v_and_b32 v184, 7, v0
  v_xor_b32 v184, v184, v4
  v_lshlrev_b32 v184, 4, v184
  v_lshrrev_b32 v30, 3, v0
  v_lshl_add_u32 v184, v30, 12, v184
  v_xor_b32 v31, v0, v30
  v_and_b32 v31, 7, v31
  v_lshlrev_b32 v30, 15, v30
  v_lshrrev_b32 v29, 2, v31
  v_lshl_add_u32 v30, v29, 14, v30
  v_and_b32 v31, 3, v31
  v_lshl_add_u32 v30, v31, 4, v30
  s_lshl_b32 s3, s18, 19
  s_sub_u32 s16, 31, s19
  s_lshl_b32 s16, s16, 7
  s_add_u32 s78, s3, s16
  s_lshl_b32 s79, s18, 5
  s_add_u32 s79, s79, s19
  s_lshl_b32 s79, s79, 6
  s_mul_i32 s76, s17, 4608
  s_mul_i32 s77, s17, 8320
  s_add_u32 s77, s77, 18432
  v_lshlrev_b32 v185, 3, v2
  v_add_u32 v185, s76, v185
  ds_write_b64 v185, v[180:181] offset:4096
  v_and_b32 v186, 1, v2
  v_lshlrev_b32 v185, 4, v186
  v_add_u32 v185, s77, v185
  ds_write_b128 v185, v[180:183]
  v_add_u32 v190, s77, v15
  v_and_b32 v22, 15, v2
  v_lshrrev_b32 v23, 4, v2
  v_lshlrev_b32 v24, 4, v23
  v_lshl_add_u32 v24, v22, 1, v24
  v_and_b32 v25, 1, v22
  v_cmp_eq_u32 vcc, 1, v25
  v_add_u32 v26, 2, v24
  v_add_u32 v27, 4160, v24
  v_cndmask_b32 v24, v27, v26, vcc
  v_add_u32 v24, s77, v24
  v_add_u32 v187, 1024, v24
  v_add_u32 v188, 2048, v24
  v_add_u32 v189, 3072, v24
  v_and_b32 v178, 31, v2
  v_lshlrev_b32 v178, 3, v178
  v_add_u32 v178, s18, v178
  v_lshlrev_b32 v178, 7, v178
  v_add_u32 v178, 32768, v178

  s_mov_b32 s36, s24
  s_mov_b32 s37, s25
  s_mov_b32 s38, 8192
  s_mov_b32 s39, 0x20000
  s_add_u32 s48, s6, 29360128
  s_addc_u32 s49, s7, 0
  s_mov_b32 s50, 1048576
  s_mov_b32 s51, 0x20000
  v_lshlrev_b32 v7, 5, v3
  v_and_b32 v9, 32, v2
  v_lshrrev_b32 v9, 1, v9
  v_add_u32 v7, v7, v9
  s_lshl_b32 s3, s18, 10
  buffer_load_dwordx4 v[72:75], v7, s[36:39], s3 offen

  buffer_load_dwordx2 v[32:33], v6, s[8:11], 0 offen offset:0
  buffer_load_dwordx2 v[34:35], v6, s[8:11], 0 offen offset:2048
  buffer_load_dwordx2 v[36:37], v6, s[8:11], s98 offen offset:0
  s_cmp_lg_u32 s17, 0
  s_cselect_b32 s3, 1073741824, 0
  buffer_load_dword v179, v178, s[48:51], s3 offen sc1
  s_add_u32 s3, s101, 65536
  v_lshlrev_b32 v9, 15, v186
  s_cmp_lg_u32 s17, 1
  s_cselect_b32 s3, 1073741824, s3
  buffer_store_dword v180, v9, s[48:51], s3 offen sc1
  s_lshl_b32 s16, s18, 7
  s_lshl_b32 s3, s19, 2
  s_add_u32 s16, s16, s3
  s_lshl_b32 s3, s16, 1
  s_load_dwordx2 s[98:99], s[28:29], s3
  s_add_u32 s100, s16, s17
  s_lshl_b32 s100, s100, 12

  s_mov_b32 s8, s30
  s_mov_b32 s9, s31
  s_mov_b32 s10, 256
  s_mov_b32 s11, 0x20000
  s_mov_b32 s56, s26
  s_mov_b32 s57, s27
  s_mov_b32 s58, 4194304
  s_mov_b32 s59, 0x20000
  buffer_load_dwordx4 v[228:231], v15, s[56:59], s100 offen offset:0
  buffer_load_dwordx4 v[232:235], v15, s[56:59], s100 offen offset:1024
  buffer_load_dwordx4 v[236:239], v15, s[56:59], s100 offen offset:2048
  buffer_load_dwordx4 v[240:243], v15, s[56:59], s100 offen offset:3072
  s_add_u32 s56, s6, 41943040
  s_addc_u32 s57, s7, 0
  s_mov_b32 s58, 4194304
  s_mov_b32 s59, 0x20000
  s_waitcnt vmcnt(18)
  v_lshlrev_b32 v92, 16, v38
  v_and_b32 v93, 0xffff0000, v38
  v_lshlrev_b32 v94, 16, v39
  v_and_b32 v95, 0xffff0000, v39
  v_lshlrev_b32 v96, 16, v40
  v_and_b32 v97, 0xffff0000, v40
  v_lshlrev_b32 v98, 16, v41
  v_and_b32 v99, 0xffff0000, v41
  v_lshlrev_b32 v100, 16, v42
  v_and_b32 v101, 0xffff0000, v42
  v_lshlrev_b32 v102, 16, v43
  v_and_b32 v103, 0xffff0000, v43
  v_lshlrev_b32 v104, 16, v44
  v_and_b32 v105, 0xffff0000, v44
  v_lshlrev_b32 v106, 16, v45
  v_and_b32 v107, 0xffff0000, v45
  v_lshlrev_b32 v108, 16, v46
  v_and_b32 v109, 0xffff0000, v46
  v_lshlrev_b32 v110, 16, v47
  v_and_b32 v111, 0xffff0000, v47
  v_lshlrev_b32 v112, 16, v48
  v_and_b32 v113, 0xffff0000, v48
  v_lshlrev_b32 v114, 16, v49
  v_and_b32 v115, 0xffff0000, v49
  v_lshlrev_b32 v116, 16, v50
  v_and_b32 v117, 0xffff0000, v50
  v_lshlrev_b32 v118, 16, v51
  v_and_b32 v119, 0xffff0000, v51
  v_lshlrev_b32 v120, 16, v52
  v_and_b32 v121, 0xffff0000, v52
  v_lshlrev_b32 v122, 16, v53
  v_and_b32 v123, 0xffff0000, v53
  s_waitcnt vmcnt(6)
  v_mov_b32 v76, v72
  v_mov_b32 v77, v73
  v_mov_b32 v78, v74
  v_mov_b32 v79, v75
  v_lshlrev_b32 v80, 16, v32
  v_and_b32 v81, 0xffff0000, v32
  v_lshlrev_b32 v82, 16, v33
  v_and_b32 v83, 0xffff0000, v33
  v_lshlrev_b32 v84, 16, v34
  v_and_b32 v85, 0xffff0000, v34
  v_lshlrev_b32 v86, 16, v35
  v_and_b32 v87, 0xffff0000, v35
  v_lshlrev_b32 v88, 16, v36
  v_and_b32 v89, 0xffff0000, v36
  v_lshlrev_b32 v90, 16, v37
  v_and_b32 v91, 0xffff0000, v37
  v_permlane32_swap_b32 v72, v76
  v_permlane32_swap_b32 v73, v77
  v_permlane32_swap_b32 v74, v78
  v_permlane32_swap_b32 v75, v79
  s_nop 0
  v_lshlrev_b32 v156, 16, v72
  v_lshlrev_b32 v157, 16, v74
  v_lshlrev_b32 v158, 16, v76
  v_lshlrev_b32 v159, 16, v78
  v_and_b32 v160, 0xffff0000, v72
  v_and_b32 v161, 0xffff0000, v74
  v_and_b32 v162, 0xffff0000, v76
  v_and_b32 v163, 0xffff0000, v78
  v_lshlrev_b32 v164, 16, v73
  v_lshlrev_b32 v165, 16, v75
  v_lshlrev_b32 v166, 16, v77
  v_lshlrev_b32 v167, 16, v79
  v_and_b32 v168, 0xffff0000, v73
  v_and_b32 v169, 0xffff0000, v75
  v_and_b32 v170, 0xffff0000, v77
  v_and_b32 v171, 0xffff0000, v79
  v_pk_mul_f32 v[124:125], v[92:93], v[156:157]
  v_pk_mul_f32 v[126:127], v[94:95], v[158:159]
  v_pk_mul_f32 v[128:129], v[96:97], v[156:157]
  v_pk_mul_f32 v[130:131], v[98:99], v[158:159]
  v_pk_mul_f32 v[132:133], v[100:101], v[156:157]
  v_pk_mul_f32 v[134:135], v[102:103], v[158:159]
  v_pk_mul_f32 v[136:137], v[104:105], v[156:157]
  v_pk_mul_f32 v[138:139], v[106:107], v[158:159]
  v_pk_mul_f32 v[140:141], v[108:109], v[156:157]
  v_pk_mul_f32 v[142:143], v[110:111], v[158:159]
  v_pk_mul_f32 v[144:145], v[112:113], v[156:157]
  v_pk_mul_f32 v[146:147], v[114:115], v[158:159]
  v_pk_mul_f32 v[148:149], v[116:117], v[156:157]
  v_pk_mul_f32 v[150:151], v[118:119], v[158:159]
  v_pk_mul_f32 v[152:153], v[120:121], v[156:157]
  v_pk_mul_f32 v[154:155], v[122:123], v[158:159]
  v_pk_fma_f32 v[124:125], v[88:89], v[160:161], v[124:125]
  v_pk_fma_f32 v[126:127], v[90:91], v[162:163], v[126:127]
  v_pk_fma_f32 v[128:129], v[92:93], v[160:161], v[128:129]
  v_pk_fma_f32 v[130:131], v[94:95], v[162:163], v[130:131]
  v_pk_fma_f32 v[132:133], v[96:97], v[160:161], v[132:133]
  v_pk_fma_f32 v[134:135], v[98:99], v[162:163], v[134:135]
  v_pk_fma_f32 v[136:137], v[100:101], v[160:161], v[136:137]
  v_pk_fma_f32 v[138:139], v[102:103], v[162:163], v[138:139]
  v_pk_fma_f32 v[140:141], v[104:105], v[160:161], v[140:141]
  v_pk_fma_f32 v[142:143], v[106:107], v[162:163], v[142:143]
  v_pk_fma_f32 v[144:145], v[108:109], v[160:161], v[144:145]
  v_pk_fma_f32 v[146:147], v[110:111], v[162:163], v[146:147]
  v_pk_fma_f32 v[148:149], v[112:113], v[160:161], v[148:149]
  v_pk_fma_f32 v[150:151], v[114:115], v[162:163], v[150:151]
  v_pk_fma_f32 v[152:153], v[116:117], v[160:161], v[152:153]
  v_pk_fma_f32 v[154:155], v[118:119], v[162:163], v[154:155]
  v_pk_fma_f32 v[124:125], v[84:85], v[164:165], v[124:125]
  v_pk_fma_f32 v[126:127], v[86:87], v[166:167], v[126:127]
  v_pk_fma_f32 v[128:129], v[88:89], v[164:165], v[128:129]
  v_pk_fma_f32 v[130:131], v[90:91], v[166:167], v[130:131]
  v_pk_fma_f32 v[132:133], v[92:93], v[164:165], v[132:133]
  v_pk_fma_f32 v[134:135], v[94:95], v[166:167], v[134:135]
  v_pk_fma_f32 v[136:137], v[96:97], v[164:165], v[136:137]
  v_pk_fma_f32 v[138:139], v[98:99], v[166:167], v[138:139]
  v_pk_fma_f32 v[140:141], v[100:101], v[164:165], v[140:141]
  v_pk_fma_f32 v[142:143], v[102:103], v[166:167], v[142:143]
  v_pk_fma_f32 v[144:145], v[104:105], v[164:165], v[144:145]
  v_pk_fma_f32 v[146:147], v[106:107], v[166:167], v[146:147]
  v_pk_fma_f32 v[148:149], v[108:109], v[164:165], v[148:149]
  v_pk_fma_f32 v[150:151], v[110:111], v[166:167], v[150:151]
  v_pk_fma_f32 v[152:153], v[112:113], v[164:165], v[152:153]
  v_pk_fma_f32 v[154:155], v[114:115], v[166:167], v[154:155]
  v_pk_fma_f32 v[124:125], v[80:81], v[168:169], v[124:125]
  v_pk_fma_f32 v[126:127], v[82:83], v[170:171], v[126:127]
  v_pk_fma_f32 v[128:129], v[84:85], v[168:169], v[128:129]
  v_pk_fma_f32 v[130:131], v[86:87], v[170:171], v[130:131]
  v_pk_fma_f32 v[132:133], v[88:89], v[168:169], v[132:133]
  v_pk_fma_f32 v[134:135], v[90:91], v[170:171], v[134:135]
  v_pk_fma_f32 v[136:137], v[92:93], v[168:169], v[136:137]
  v_pk_fma_f32 v[138:139], v[94:95], v[170:171], v[138:139]
  v_pk_fma_f32 v[140:141], v[96:97], v[168:169], v[140:141]
  v_pk_fma_f32 v[142:143], v[98:99], v[170:171], v[142:143]
  v_pk_fma_f32 v[144:145], v[100:101], v[168:169], v[144:145]
  v_pk_fma_f32 v[146:147], v[102:103], v[170:171], v[146:147]
  v_pk_fma_f32 v[148:149], v[104:105], v[168:169], v[148:149]
  v_pk_fma_f32 v[150:151], v[106:107], v[170:171], v[150:151]
  v_pk_fma_f32 v[152:153], v[108:109], v[168:169], v[152:153]
  v_pk_fma_f32 v[154:155], v[110:111], v[170:171], v[154:155]
  v_lshlrev_b32 v80, 16, v54
  v_and_b32 v81, 0xffff0000, v54
  v_lshlrev_b32 v82, 16, v55
  v_and_b32 v83, 0xffff0000, v55
  v_lshlrev_b32 v84, 16, v56
  v_and_b32 v85, 0xffff0000, v56
  v_lshlrev_b32 v86, 16, v57
  v_and_b32 v87, 0xffff0000, v57
  v_lshlrev_b32 v88, 16, v58
  v_and_b32 v89, 0xffff0000, v58
  v_lshlrev_b32 v90, 16, v59
  v_and_b32 v91, 0xffff0000, v59
  v_lshlrev_b32 v92, 16, v60
  v_and_b32 v93, 0xffff0000, v60
  v_lshlrev_b32 v94, 16, v61
  v_and_b32 v95, 0xffff0000, v61
  v_lshlrev_b32 v96, 16, v62
  v_and_b32 v97, 0xffff0000, v62
  v_lshlrev_b32 v98, 16, v63
  v_and_b32 v99, 0xffff0000, v63
  v_lshlrev_b32 v100, 16, v64
  v_and_b32 v101, 0xffff0000, v64
  v_lshlrev_b32 v102, 16, v65
  v_and_b32 v103, 0xffff0000, v65
  v_lshlrev_b32 v104, 16, v66
  v_and_b32 v105, 0xffff0000, v66
  v_lshlrev_b32 v106, 16, v67
  v_and_b32 v107, 0xffff0000, v67
  v_lshlrev_b32 v108, 16, v68
  v_and_b32 v109, 0xffff0000, v68
  v_lshlrev_b32 v110, 16, v69
  v_and_b32 v111, 0xffff0000, v69
  v_pk_mul_f32 v[124:125], v[124:125], v[80:81]
  v_pk_mul_f32 v[126:127], v[126:127], v[82:83]
  v_pk_mul_f32 v[128:129], v[128:129], v[84:85]
  v_pk_mul_f32 v[130:131], v[130:131], v[86:87]
  v_pk_mul_f32 v[132:133], v[132:133], v[88:89]
  v_pk_mul_f32 v[134:135], v[134:135], v[90:91]
  v_pk_mul_f32 v[136:137], v[136:137], v[92:93]
  v_pk_mul_f32 v[138:139], v[138:139], v[94:95]
  v_pk_mul_f32 v[140:141], v[140:141], v[96:97]
  v_pk_mul_f32 v[142:143], v[142:143], v[98:99]
  v_pk_mul_f32 v[144:145], v[144:145], v[100:101]
  v_pk_mul_f32 v[146:147], v[146:147], v[102:103]
  v_pk_mul_f32 v[148:149], v[148:149], v[104:105]
  v_pk_mul_f32 v[150:151], v[150:151], v[106:107]
  v_pk_mul_f32 v[152:153], v[152:153], v[108:109]
  v_pk_mul_f32 v[154:155], v[154:155], v[110:111]
  v_cvt_pk_bf16_f32 v32, v152, v148
  v_cvt_pk_bf16_f32 v33, v144, v140
  v_cvt_pk_bf16_f32 v34, v136, v132
  v_cvt_pk_bf16_f32 v35, v128, v124
  ds_write_b128 v176, v[32:35] offset:0
  v_cvt_pk_bf16_f32 v36, v153, v149
  v_cvt_pk_bf16_f32 v37, v145, v141
  v_cvt_pk_bf16_f32 v38, v137, v133
  v_cvt_pk_bf16_f32 v39, v129, v125
  ds_write_b128 v176, v[36:39] offset:128
  v_cvt_pk_bf16_f32 v40, v154, v150
  v_cvt_pk_bf16_f32 v41, v146, v142
  v_cvt_pk_bf16_f32 v42, v138, v134
  v_cvt_pk_bf16_f32 v43, v130, v126
  ds_write_b128 v176, v[40:43] offset:256
  v_cvt_pk_bf16_f32 v44, v155, v151
  v_cvt_pk_bf16_f32 v45, v147, v143
  v_cvt_pk_bf16_f32 v46, v139, v135
  v_cvt_pk_bf16_f32 v47, v131, v127
  ds_write_b128 v176, v[44:47] offset:384
  s_waitcnt lgkmcnt(0)
  s_barrier
  ds_read_b128 v[48:51], v177 offset:0
  ds_read_b128 v[52:55], v177 offset:4096
  ds_read_b128 v[56:59], v177 offset:8192
  ds_read_b128 v[60:63], v177 offset:12288
  s_waitcnt lgkmcnt(3)
  buffer_store_dwordx4 v[48:51], v184, s[56:59], s78 offen sc1
  s_add_u32 s78, s78, 131072
  s_waitcnt lgkmcnt(2)
  buffer_store_dwordx4 v[52:55], v184, s[56:59], s78 offen sc1
  s_add_u32 s78, s78, 131072
  s_waitcnt lgkmcnt(1)
  buffer_store_dwordx4 v[56:59], v184, s[56:59], s78 offen sc1
  s_add_u32 s78, s78, 131072
  s_waitcnt lgkmcnt(0)
  buffer_store_dwordx4 v[60:63], v184, s[56:59], s78 offen sc1
  s_add_u32 s78, s78, 131072
  s_cmp_ge_u32 s17, 2
  s_cselect_b32 s3, s99, s98
  s_lshl_b32 s78, s3, 16
  s_and_b32 s3, s3, 0xffff0000
  s_bitcmp1_b32 s17, 0
  s_cselect_b32 s3, s3, s78
  s_waitcnt vmcnt(4)
  v_readfirstlane_b32 s98, v228
  v_readfirstlane_b32 s99, v232
  v_readfirstlane_b32 s78, v236
  v_readfirstlane_b32 s39, v240
  v_cmp_eq_u32 vcc, 1, v186
  s_lshl_b32 s98, s98, 16
  v_mov_b32 v184, s98
  v_mov_b32 v244, s99
  v_mov_b32 v245, s78
  v_mov_b32 v246, s39
  v_cndmask_b32 v183, 0, v184, vcc
  ds_write_b128 v185, v[180:183] offset:4160

  ds_write_b128 v190, v[228:231] offset:32
  v_mov_b32_dpp v244, v228 wave_shl:1 row_mask:0xf bank_mask:0xf
  ds_write_b128 v190, v[232:235] offset:1056
  v_mov_b32_dpp v245, v232 wave_shl:1 row_mask:0xf bank_mask:0xf
  ds_write_b128 v190, v[236:239] offset:2080
  v_mov_b32_dpp v246, v236 wave_shl:1 row_mask:0xf bank_mask:0xf
  ds_write_b128 v190, v[240:243] offset:3104
  v_mov_b32_dpp v247, v240 wave_shl:1 row_mask:0xf bank_mask:0xf
  v_alignbit_b32 v96, v229, v228, 16
  v_alignbit_b32 v97, v230, v229, 16
  v_alignbit_b32 v98, v231, v230, 16
  v_alignbit_b32 v99, v244, v231, 16
  ds_write_b128 v190, v[96:99] offset:4192
  v_alignbit_b32 v100, v233, v232, 16
  v_alignbit_b32 v101, v234, v233, 16
  v_alignbit_b32 v102, v235, v234, 16
  v_alignbit_b32 v103, v245, v235, 16
  ds_write_b128 v190, v[100:103] offset:5216
  v_alignbit_b32 v104, v237, v236, 16
  v_alignbit_b32 v105, v238, v237, 16
  v_alignbit_b32 v106, v239, v238, 16
  v_alignbit_b32 v107, v246, v239, 16
  ds_write_b128 v190, v[104:107] offset:6240
  v_alignbit_b32 v108, v241, v240, 16
  v_alignbit_b32 v109, v242, v241, 16
  v_alignbit_b32 v110, v243, v242, 16
  v_alignbit_b32 v111, v247, v243, 16
  ds_write_b128 v190, v[108:111] offset:7264
  s_add_u32 s99, s101, 32768
  s_waitcnt lgkmcnt(0)
  ds_read2_b32 a[0:1], v24 offset0:0 offset1:1
  ds_read2_b32 a[2:3], v24 offset0:2 offset1:3
  ds_read2_b32 a[32:33], v24 offset0:128 offset1:129
  ds_read2_b32 a[34:35], v24 offset0:130 offset1:131
  ds_read2_b32 a[64:65], v187 offset0:0 offset1:1
  ds_read2_b32 a[66:67], v187 offset0:2 offset1:3
  ds_read2_b32 a[96:97], v187 offset0:128 offset1:129
  ds_read2_b32 a[98:99], v187 offset0:130 offset1:131
  ds_read2_b32 a[128:129], v188 offset0:0 offset1:1
  ds_read2_b32 a[130:131], v188 offset0:2 offset1:3
  ds_read2_b32 a[160:161], v188 offset0:128 offset1:129
  ds_read2_b32 a[162:163], v188 offset0:130 offset1:131
  ds_read2_b32 a[192:193], v189 offset0:0 offset1:1
  ds_read2_b32 a[194:195], v189 offset0:2 offset1:3
  ds_read2_b32 a[224:225], v189 offset0:128 offset1:129
  ds_read2_b32 a[226:227], v189 offset0:130 offset1:131
  ds_read2_b32 a[4:5], v24 offset0:16 offset1:17
  ds_read2_b32 a[6:7], v24 offset0:18 offset1:19
  ds_read2_b32 a[36:37], v24 offset0:144 offset1:145
  ds_read2_b32 a[38:39], v24 offset0:146 offset1:147
  ds_read2_b32 a[68:69], v187 offset0:16 offset1:17
  ds_read2_b32 a[70:71], v187 offset0:18 offset1:19
  ds_read2_b32 a[100:101], v187 offset0:144 offset1:145
  ds_read2_b32 a[102:103], v187 offset0:146 offset1:147
  ds_read2_b32 a[132:133], v188 offset0:16 offset1:17
  ds_read2_b32 a[134:135], v188 offset0:18 offset1:19
  ds_read2_b32 a[164:165], v188 offset0:144 offset1:145
  ds_read2_b32 a[166:167], v188 offset0:146 offset1:147
  ds_read2_b32 a[196:197], v189 offset0:16 offset1:17
  ds_read2_b32 a[198:199], v189 offset0:18 offset1:19
  ds_read2_b32 a[228:229], v189 offset0:144 offset1:145
  ds_read2_b32 a[230:231], v189 offset0:146 offset1:147
  s_waitcnt vmcnt(0)
  s_barrier
  s_cmp_lg_u32 s17, 0
  s_cbranch_scc1 L_nosig0
  v_readlane_b32 s98, v179, s19
  v_mov_b32 v0, 0
  s_add_u32 s98, s98, 1
  v_mov_b32 v1, s98
  s_mov_b64 exec, 1
  buffer_store_dword v1, v0, s[48:51], s99 offen sc1
  s_mov_b64 exec, -1

L_nosig0:
  s_cmp_lg_u32 s17, 1
  s_cselect_b32 s98, 1073741824, s101
  buffer_store_dword v180, v8, s[48:51], s98 offen sc1

  ds_read2_b32 a[8:9], v24 offset0:32 offset1:33
  v_lshlrev_b32 v25, 4, v23
  v_lshlrev_b32 v26, 5, v22
  ds_read2_b32 a[10:11], v24 offset0:34 offset1:35
  v_sub_u32 v25, v25, v26
  v_add_u32 v25, 480, v25
  ds_read2_b32 a[40:41], v24 offset0:160 offset1:161
  v_add_u32 v25, s76, v25
  v_lshlrev_b32 v27, 3, v23
  ds_read2_b32 a[42:43], v24 offset0:162 offset1:163
  v_add_u32 v27, v27, v26
  v_sub_u32 v26, 504, v27
  ds_read2_b32 a[72:73], v187 offset0:32 offset1:33
  v_add_u32 v26, s76, v26
  v_lshrrev_b32 v27, 1, v23
  ds_read2_b32 a[74:75], v187 offset0:34 offset1:35
  v_lshlrev_b32 v27, 2, v27
  v_add_u32 v27, s17, v27
  ds_read2_b32 a[104:105], v187 offset0:160 offset1:161
  v_and_b32 v28, 7, v22
  v_xor_b32 v27, v27, v28
  ds_read2_b32 a[106:107], v187 offset0:162 offset1:163
  v_lshlrev_b32 v27, 4, v27
  v_lshl_add_u32 v27, v22, 7, v27
  ds_read2_b32 a[136:137], v188 offset0:32 offset1:33
  v_and_b32 v28, 1, v23
  v_lshl_add_u32 v27, v28, 3, v27
  ds_read2_b32 a[138:139], v188 offset0:34 offset1:35
  v_add_u32 v27, 51712, v27
  v_lshrrev_b32 v29, 1, v2
  ds_read2_b32 a[168:169], v188 offset0:160 offset1:161
  v_lshlrev_b32 v29, 3, v29
  v_add_u32 v29, v29, v186
  ds_read2_b32 a[170:171], v188 offset0:162 offset1:163
  s_lshl_b32 s39, s17, 1
  v_add_u32 v29, s39, v29
  ds_read2_b32 a[200:201], v189 offset0:32 offset1:33
  v_lshlrev_b32 v29, 7, v29
  s_cmp_lt_u32 s2, 0
  ds_read2_b32 a[202:203], v189 offset0:34 offset1:35
  s_cselect_b32 s39, 1, 0
  s_lshl_b32 s39, s39, 15
  ds_read2_b32 a[232:233], v189 offset0:160 offset1:161
  s_sub_u32 s39, 98304, s39
  v_add_u32 v29, s39, v29
  ds_read2_b32 a[234:235], v189 offset0:162 offset1:163
  v_lshrrev_b32 v192, 2, v2
  v_lshlrev_b32 v192, 6, v192
  ds_read2_b32 a[12:13], v24 offset0:48 offset1:49
  v_and_b32 v191, 3, v2
  v_lshl_add_u32 v192, v191, 4, v192
  ds_read2_b32 a[14:15], v24 offset0:50 offset1:51
  v_add_u32 v193, 0, v192
  v_add_u32 v194, 0, v193
  ds_read2_b32 a[44:45], v24 offset0:176 offset1:177
  v_add_u32 v195, 0, v194
  v_lshlrev_b32 v206, 5, v200
  ds_read2_b32 a[46:47], v24 offset0:178 offset1:179
  v_add_u32 v206, 160384, v206
  s_lshl_b32 s16, s17, 3
  ds_read2_b32 a[76:77], v187 offset0:48 offset1:49
  v_add_u32 v207, s16, v206
  v_lshlrev_b32 v204, 8, v23
  ds_read2_b32 a[78:79], v187 offset0:50 offset1:51
  v_bfe_u32 v205, v2, 1, 1
  v_lshl_add_u32 v204, v205, 7, v204
  ds_read2_b32 a[108:109], v187 offset0:176 offset1:177
  v_bfe_u32 v205, v2, 2, 2
  v_lshl_add_u32 v204, v205, 4, v204
  ds_read2_b32 a[110:111], v187 offset0:178 offset1:179
  v_lshl_add_u32 v204, v186, 3, v204
  s_lshl_b32 s39, s17, 12
  ds_read2_b32 a[140:141], v188 offset0:48 offset1:49
  s_add_u32 s37, s39, 144000
  v_add_u32 v204, s37, v204
  ds_read2_b32 a[142:143], v188 offset0:50 offset1:51
  s_lshr_b32 s38, s2, 1
  s_lshl_b32 s38, s38, 15
  ds_read2_b32 a[172:173], v188 offset0:176 offset1:177
  s_and_b32 s39, s2, 1
  s_lshl_b32 s39, s39, 14
  ds_read2_b32 a[174:175], v188 offset0:178 offset1:179
  s_add_u32 s38, s38, s39
  s_lshl_b32 s39, s17, 12
  ds_read2_b32 a[204:205], v189 offset0:48 offset1:49
  s_add_u32 s38, s38, s39
  v_lshlrev_b32 v196, 9, v201
  ds_read2_b32 a[206:207], v189 offset0:50 offset1:51
  v_lshl_add_u32 v196, v200, 4, v196
  v_lshrrev_b32 v197, 2, v201
  ds_read2_b32 a[236:237], v189 offset0:176 offset1:177
  v_lshlrev_b32 v197, 12, v197
  v_and_b32 v198, 3, v201
  ds_read2_b32 a[238:239], v189 offset0:178 offset1:179
  v_lshl_add_u32 v197, v198, 8, v197
  v_lshl_add_u32 v197, v200, 4, v197
  ds_read2_b32 a[16:17], v24 offset0:64 offset1:65
  s_mov_b32 s12, s6
  s_mov_b32 s13, s7
  ds_read2_b32 a[18:19], v24 offset0:66 offset1:67
  s_mov_b32 s14, 4194304
  s_mov_b32 s15, 0x20000
  ds_read2_b32 a[48:49], v24 offset0:192 offset1:193
  s_lshr_b32 s18, s2, 5
  s_and_b32 s19, s2, 7
  ds_read2_b32 a[50:51], v24 offset0:194 offset1:195
  s_lshl_b32 s19, s19, 2
  s_bfe_u32 s20, s2, 0x20003
  ds_read2_b32 a[80:81], v187 offset0:64 offset1:65
  s_add_u32 s19, s19, s20
  s_cmp_ge_u32 s17, 2
  ds_read2_b32 a[82:83], v187 offset0:66 offset1:67
  s_cselect_b32 s24, s62, s60
  ds_read2_b32 a[112:113], v187 offset0:192 offset1:193
  s_cselect_b32 s25, s63, s61
  ds_read2_b32 a[114:115], v187 offset0:194 offset1:195
  s_mov_b32 s26, 7340032
  ds_read2_b32 a[144:145], v188 offset0:64 offset1:65
  s_mov_b32 s27, 0x20000
  ds_read2_b32 a[146:147], v188 offset0:66 offset1:67
  v_and_b32 v18, 7, v2
  ds_read2_b32 a[176:177], v188 offset0:192 offset1:193
  v_lshlrev_b32 v19, 7, v2
  ds_read2_b32 a[178:179], v188 offset0:194 offset1:195
  v_min_u32 v18, 6, v18
  ds_read2_b32 a[208:209], v189 offset0:64 offset1:65
  v_lshlrev_b32 v18, 7, v18
  ds_read2_b32 a[210:211], v189 offset0:66 offset1:67
  v_mul_u32_u24 v3, 7168, v201
  ds_read2_b32 a[240:241], v189 offset0:192 offset1:193
  v_add_u32 v18, v18, v3
  ds_read2_b32 a[242:243], v189 offset0:194 offset1:195
  s_lshr_b32 s21, s2, 3
  ds_read2_b32 a[20:21], v24 offset0:80 offset1:81
  s_lshl_b32 s21, s21, 4
  ds_read2_b32 a[22:23], v24 offset0:82 offset1:83
  s_and_b32 s22, s17, 1
  ds_read2_b32 a[52:53], v24 offset0:208 offset1:209
  s_lshl_b32 s23, s22, 3
  ds_read2_b32 a[54:55], v24 offset0:210 offset1:211
  s_add_u32 s21, s21, s23
  ds_read2_b32 a[84:85], v187 offset0:80 offset1:81
  s_mul_i32 s21, s21, 7168
  ds_read2_b32 a[86:87], v187 offset0:82 offset1:83
  s_and_b32 s23, s2, 7
  ds_read2_b32 a[116:117], v187 offset0:208 offset1:209
  s_mul_i32 s23, s23, 896
  ds_read2_b32 a[118:119], v187 offset0:210 offset1:211
  s_add_u32 s68, s21, s23
  s_cmp_lg_u32 s17, 0
  s_cbranch_scc1 L_p1_done
  s_movk_i32 s39, 6

L_p1_poll:
  buffer_load_dword v20, v178, s[48:51], 0 offen sc1
  s_waitcnt vmcnt(0)
  v_cmp_eq_u32 vcc, v20, v179
  s_nop 1
  s_cmp_eq_u64 vcc, 0
  s_cbranch_scc1 L_p1_done
  s_sleep 1
  s_sub_u32 s39, s39, 1
  s_cmp_lg_u32 s39, 0
  s_cbranch_scc1 L_p1_poll
  s_branch L_p1_slow

L_p1_done:
  s_barrier
  s_mov_b32 m0, s76
  s_nop 0
  buffer_load_dwordx4 v15, s[56:59], s100 offen offset:3072 sc1 lds
  buffer_load_dwordx4 v15, s[56:59], s100 offen offset:2048 sc1 lds
  buffer_load_dwordx4 v15, s[56:59], s100 offen offset:1024 sc1 lds
  buffer_load_dwordx4 v15, s[56:59], s100 offen offset:0 sc1 lds
  s_and_b32 s99, s2, 7
  s_lshl_b32 s99, s99, 5
  s_lshr_b32 s98, s2, 3
  s_or_b32 s98, s98, s17
  s_cmp_lg_u32 s98, 0
  s_cselect_b32 s98, 1073741824, s99
  v_mov_b32 v1, 1
  buffer_store_dword v1, v180, s[8:11], s98 offen sc1

  ds_read2_b32 a[148:149], v188 offset0:80 offset1:81
  ds_read2_b32 a[150:151], v188 offset0:82 offset1:83
  ds_read2_b32 a[180:181], v188 offset0:208 offset1:209
  ds_read2_b32 a[182:183], v188 offset0:210 offset1:211
  ds_read2_b32 a[212:213], v189 offset0:80 offset1:81
  ds_read2_b32 a[214:215], v189 offset0:82 offset1:83
  ds_read2_b32 a[244:245], v189 offset0:208 offset1:209
  ds_read2_b32 a[246:247], v189 offset0:210 offset1:211
  ds_read2_b32 a[24:25], v24 offset0:96 offset1:97
  ds_read2_b32 a[26:27], v24 offset0:98 offset1:99
  ds_read2_b32 a[56:57], v24 offset0:224 offset1:225
  ds_read2_b32 a[58:59], v24 offset0:226 offset1:227
  ds_read2_b32 a[88:89], v187 offset0:96 offset1:97
  ds_read2_b32 a[90:91], v187 offset0:98 offset1:99
  ds_read2_b32 a[120:121], v187 offset0:224 offset1:225
  ds_read2_b32 a[122:123], v187 offset0:226 offset1:227
  ds_read2_b32 a[152:153], v188 offset0:96 offset1:97
  ds_read2_b32 a[154:155], v188 offset0:98 offset1:99
  ds_read2_b32 a[184:185], v188 offset0:224 offset1:225
  ds_read2_b32 a[186:187], v188 offset0:226 offset1:227
  ds_read2_b32 a[216:217], v189 offset0:96 offset1:97
  ds_read2_b32 a[218:219], v189 offset0:98 offset1:99
  ds_read2_b32 a[248:249], v189 offset0:224 offset1:225
  ds_read2_b32 a[250:251], v189 offset0:226 offset1:227
  ds_read2_b32 a[28:29], v24 offset0:112 offset1:113
  ds_read2_b32 a[30:31], v24 offset0:114 offset1:115
  ds_read2_b32 a[60:61], v24 offset0:240 offset1:241
  ds_read2_b32 a[62:63], v24 offset0:242 offset1:243
  ds_read2_b32 a[92:93], v187 offset0:112 offset1:113
  ds_read2_b32 a[94:95], v187 offset0:114 offset1:115
  ds_read2_b32 a[124:125], v187 offset0:240 offset1:241
  ds_read2_b32 a[126:127], v187 offset0:242 offset1:243
  ds_read2_b32 a[156:157], v188 offset0:112 offset1:113
  ds_read2_b32 a[158:159], v188 offset0:114 offset1:115
  ds_read2_b32 a[188:189], v188 offset0:240 offset1:241
  ds_read2_b32 a[190:191], v188 offset0:242 offset1:243
  ds_read2_b32 a[220:221], v189 offset0:112 offset1:113
  ds_read2_b32 a[222:223], v189 offset0:114 offset1:115
  ds_read2_b32 a[252:253], v189 offset0:240 offset1:241
  ds_read2_b32 a[254:255], v189 offset0:242 offset1:243
  s_waitcnt vmcnt(4)
  ds_read_b128 v[64:67], v25 offset:3584
  ds_read_b128 v[68:71], v25 offset:3648
  ds_read_b128 v[72:75], v25 offset:3712
  ds_read_b128 v[76:79], v25 offset:3776
  ds_read_b128 v[80:83], v25 offset:3840
  ds_read_b128 v[84:87], v25 offset:3904
  ds_read_b128 v[88:91], v25 offset:3968
  s_waitcnt lgkmcnt(5)
  v_mfma_f32_16x16x32_bf16 v[32:35], a[0:3], v[64:67], 0
  ds_read_b128 v[92:95], v25 offset:4032
  v_mfma_f32_16x16x32_bf16 v[36:39], a[32:35], v[64:67], 0
  v_mfma_f32_16x16x32_bf16 v[40:43], a[64:67], v[64:67], 0
  v_mfma_f32_16x16x32_bf16 v[44:47], a[96:99], v[64:67], 0
  v_mfma_f32_16x16x32_bf16 v[48:51], a[128:131], v[64:67], 0
  v_mfma_f32_16x16x32_bf16 v[52:55], a[160:163], v[64:67], 0
  v_mfma_f32_16x16x32_bf16 v[56:59], a[192:195], v[64:67], 0
  v_mfma_f32_16x16x32_bf16 v[60:63], a[224:227], v[64:67], 0
  v_mfma_f32_16x16x32_bf16 v[32:35], a[4:7], v[68:71], v[32:35]
  ds_read_b128 v[64:67], v25 offset:3072
  v_mfma_f32_16x16x32_bf16 v[36:39], a[36:39], v[68:71], v[36:39]
  v_mfma_f32_16x16x32_bf16 v[40:43], a[68:71], v[68:71], v[40:43]
  v_mfma_f32_16x16x32_bf16 v[44:47], a[100:103], v[68:71], v[44:47]
  v_mfma_f32_16x16x32_bf16 v[48:51], a[132:135], v[68:71], v[48:51]
  v_mfma_f32_16x16x32_bf16 v[52:55], a[164:167], v[68:71], v[52:55]
  v_mfma_f32_16x16x32_bf16 v[56:59], a[196:199], v[68:71], v[56:59]
  v_mfma_f32_16x16x32_bf16 v[60:63], a[228:231], v[68:71], v[60:63]
  s_waitcnt lgkmcnt(5)
  v_mfma_f32_16x16x32_bf16 v[32:35], a[8:11], v[72:75], v[32:35]
  ds_read_b128 v[68:71], v25 offset:3136
  v_mfma_f32_16x16x32_bf16 v[36:39], a[40:43], v[72:75], v[36:39]
  v_mfma_f32_16x16x32_bf16 v[40:43], a[72:75], v[72:75], v[40:43]
  v_mfma_f32_16x16x32_bf16 v[44:47], a[104:107], v[72:75], v[44:47]
  v_mfma_f32_16x16x32_bf16 v[48:51], a[136:139], v[72:75], v[48:51]
  v_mfma_f32_16x16x32_bf16 v[52:55], a[168:171], v[72:75], v[52:55]
  v_mfma_f32_16x16x32_bf16 v[56:59], a[200:203], v[72:75], v[56:59]
  v_mfma_f32_16x16x32_bf16 v[60:63], a[232:235], v[72:75], v[60:63]
  s_waitcnt lgkmcnt(5)
  v_mfma_f32_16x16x32_bf16 v[32:35], a[12:15], v[76:79], v[32:35]
  ds_read_b128 v[72:75], v25 offset:3200
  v_mfma_f32_16x16x32_bf16 v[36:39], a[44:47], v[76:79], v[36:39]
  v_mfma_f32_16x16x32_bf16 v[40:43], a[76:79], v[76:79], v[40:43]
  v_mfma_f32_16x16x32_bf16 v[44:47], a[108:111], v[76:79], v[44:47]
  v_mfma_f32_16x16x32_bf16 v[48:51], a[140:143], v[76:79], v[48:51]
  v_mfma_f32_16x16x32_bf16 v[52:55], a[172:175], v[76:79], v[52:55]
  v_mfma_f32_16x16x32_bf16 v[56:59], a[204:207], v[76:79], v[56:59]
  v_mfma_f32_16x16x32_bf16 v[60:63], a[236:239], v[76:79], v[60:63]
  s_waitcnt lgkmcnt(5)
  v_mfma_f32_16x16x32_bf16 v[32:35], a[16:19], v[80:83], v[32:35]
  ds_read_b128 v[76:79], v25 offset:3264
  v_mfma_f32_16x16x32_bf16 v[36:39], a[48:51], v[80:83], v[36:39]
  v_mfma_f32_16x16x32_bf16 v[40:43], a[80:83], v[80:83], v[40:43]
  v_mfma_f32_16x16x32_bf16 v[44:47], a[112:115], v[80:83], v[44:47]
  v_mfma_f32_16x16x32_bf16 v[48:51], a[144:147], v[80:83], v[48:51]
  v_mfma_f32_16x16x32_bf16 v[52:55], a[176:179], v[80:83], v[52:55]
  v_mfma_f32_16x16x32_bf16 v[56:59], a[208:211], v[80:83], v[56:59]
  v_mfma_f32_16x16x32_bf16 v[60:63], a[240:243], v[80:83], v[60:63]
  v_mfma_f32_16x16x32_bf16 v[32:35], a[20:23], v[84:87], v[32:35]
  ds_read_b128 v[80:83], v25 offset:3328
  v_mfma_f32_16x16x32_bf16 v[36:39], a[52:55], v[84:87], v[36:39]
  v_mfma_f32_16x16x32_bf16 v[40:43], a[84:87], v[84:87], v[40:43]
  v_mfma_f32_16x16x32_bf16 v[44:47], a[116:119], v[84:87], v[44:47]
  v_mfma_f32_16x16x32_bf16 v[48:51], a[148:151], v[84:87], v[48:51]
  v_mfma_f32_16x16x32_bf16 v[52:55], a[180:183], v[84:87], v[52:55]
  v_mfma_f32_16x16x32_bf16 v[56:59], a[212:215], v[84:87], v[56:59]
  v_mfma_f32_16x16x32_bf16 v[60:63], a[244:247], v[84:87], v[60:63]
  s_waitcnt lgkmcnt(5)
  v_mfma_f32_16x16x32_bf16 v[32:35], a[24:27], v[88:91], v[32:35]
  ds_read_b128 v[84:87], v25 offset:3392
  v_mfma_f32_16x16x32_bf16 v[36:39], a[56:59], v[88:91], v[36:39]
  v_mfma_f32_16x16x32_bf16 v[40:43], a[88:91], v[88:91], v[40:43]
  v_mfma_f32_16x16x32_bf16 v[44:47], a[120:123], v[88:91], v[44:47]
  v_mfma_f32_16x16x32_bf16 v[48:51], a[152:155], v[88:91], v[48:51]
  v_mfma_f32_16x16x32_bf16 v[52:55], a[184:187], v[88:91], v[52:55]
  v_mfma_f32_16x16x32_bf16 v[56:59], a[216:219], v[88:91], v[56:59]
  v_mfma_f32_16x16x32_bf16 v[60:63], a[248:251], v[88:91], v[60:63]
  v_mfma_f32_16x16x32_bf16 v[32:35], a[28:31], v[92:95], v[32:35]
  ds_read_b128 v[88:91], v25 offset:3456
  v_mfma_f32_16x16x32_bf16 v[36:39], a[60:63], v[92:95], v[36:39]
  v_mfma_f32_16x16x32_bf16 v[40:43], a[92:95], v[92:95], v[40:43]
  v_mfma_f32_16x16x32_bf16 v[44:47], a[124:127], v[92:95], v[44:47]
  v_mfma_f32_16x16x32_bf16 v[48:51], a[156:159], v[92:95], v[48:51]
  v_mfma_f32_16x16x32_bf16 v[52:55], a[188:191], v[92:95], v[52:55]
  v_mfma_f32_16x16x32_bf16 v[56:59], a[220:223], v[92:95], v[56:59]
  v_mfma_f32_16x16x32_bf16 v[60:63], a[252:255], v[92:95], v[60:63]
  s_waitcnt lgkmcnt(5)
  v_mfma_f32_16x16x32_bf16 v[36:39], a[0:3], v[64:67], v[36:39]
  ds_read_b128 v[92:95], v25 offset:3520
  v_mfma_f32_16x16x32_bf16 v[40:43], a[32:35], v[64:67], v[40:43]
  ds_read_b64 v[96:97], v26 offset:3584
  v_mfma_f32_16x16x32_bf16 v[44:47], a[64:67], v[64:67], v[44:47]
  v_mfma_f32_16x16x32_bf16 v[48:51], a[96:99], v[64:67], v[48:51]
  v_mfma_f32_16x16x32_bf16 v[52:55], a[128:131], v[64:67], v[52:55]
  v_mfma_f32_16x16x32_bf16 v[56:59], a[160:163], v[64:67], v[56:59]
  v_mfma_f32_16x16x32_bf16 v[60:63], a[192:195], v[64:67], v[60:63]
  s_waitcnt vmcnt(1)
  v_mfma_f32_16x16x32_bf16 v[36:39], a[4:7], v[68:71], v[36:39]
  ds_read_b128 v[64:67], v25 offset:2560
  v_mfma_f32_16x16x32_bf16 v[40:43], a[36:39], v[68:71], v[40:43]
  v_mfma_f32_16x16x32_bf16 v[44:47], a[68:71], v[68:71], v[44:47]
  v_mfma_f32_16x16x32_bf16 v[48:51], a[100:103], v[68:71], v[48:51]
  v_mfma_f32_16x16x32_bf16 v[52:55], a[132:135], v[68:71], v[52:55]
  v_mfma_f32_16x16x32_bf16 v[56:59], a[164:167], v[68:71], v[56:59]
  v_mfma_f32_16x16x32_bf16 v[60:63], a[196:199], v[68:71], v[60:63]
  s_mov_b32 s56, s4
  s_mov_b32 s57, s5
  s_mov_b32 s58, 4194304
  s_mov_b32 s59, 0x20000
  buffer_load_dwordx4 v[212:215], v203, s[56:59], 0 offen offset:0
  buffer_load_dwordx4 v[216:219], v203, s[56:59], 0 offen offset:128
  buffer_load_dwordx4 v[220:223], v203, s[56:59], 0 offen offset:256
  buffer_load_dwordx4 v[224:227], v203, s[56:59], 0 offen offset:384
  s_waitcnt lgkmcnt(6)
  v_mfma_f32_16x16x32_bf16 v[36:39], a[8:11], v[72:75], v[36:39]
  ds_read_b128 v[68:71], v25 offset:2624
  v_mfma_f32_16x16x32_bf16 v[40:43], a[40:43], v[72:75], v[40:43]
  v_mfma_f32_16x16x32_bf16 v[44:47], a[72:75], v[72:75], v[44:47]
  v_mfma_f32_16x16x32_bf16 v[48:51], a[104:107], v[72:75], v[48:51]
  v_mfma_f32_16x16x32_bf16 v[52:55], a[136:139], v[72:75], v[52:55]
  v_mfma_f32_16x16x32_bf16 v[56:59], a[168:171], v[72:75], v[56:59]
  v_mfma_f32_16x16x32_bf16 v[60:63], a[200:203], v[72:75], v[60:63]
  s_waitcnt lgkmcnt(2)
  v_mfma_f32_16x16x32_bf16 v[36:39], a[12:15], v[76:79], v[36:39]
  ds_read_b128 v[72:75], v25 offset:2688
  v_mfma_f32_16x16x32_bf16 v[40:43], a[44:47], v[76:79], v[40:43]
  v_and_b32 v98, 0xffff0000, v97
  v_mfma_f32_16x16x32_bf16 v[44:47], a[76:79], v[76:79], v[44:47]
  v_lshlrev_b32 v99, 16, v97
  v_mfma_f32_16x16x32_bf16 v[48:51], a[108:111], v[76:79], v[48:51]
  v_and_b32 v100, 0xffff0000, v96
  v_mfma_f32_16x16x32_bf16 v[52:55], a[140:143], v[76:79], v[52:55]
  v_lshlrev_b32 v101, 16, v96
  v_mfma_f32_16x16x32_bf16 v[56:59], a[172:175], v[76:79], v[56:59]
  v_fma_f32 v98, v98, s3, v32
  v_mfma_f32_16x16x32_bf16 v[60:63], a[204:207], v[76:79], v[60:63]
  v_fma_f32 v99, v99, s3, v33
  s_waitcnt lgkmcnt(6)
  v_mfma_f32_16x16x32_bf16 v[36:39], a[16:19], v[80:83], v[36:39]
  ds_read_b128 v[76:79], v25 offset:2752
  v_mfma_f32_16x16x32_bf16 v[40:43], a[48:51], v[80:83], v[40:43]
  v_fma_f32 v100, v100, s3, v34
  v_mfma_f32_16x16x32_bf16 v[44:47], a[80:83], v[80:83], v[44:47]
  v_fma_f32 v101, v101, s3, v35
  v_mfma_f32_16x16x32_bf16 v[48:51], a[112:115], v[80:83], v[48:51]
  v_cvt_pk_bf16_f32 v96, v98, v99
  v_mfma_f32_16x16x32_bf16 v[52:55], a[144:147], v[80:83], v[52:55]
  v_cvt_pk_bf16_f32 v97, v100, v101
  v_mfma_f32_16x16x32_bf16 v[56:59], a[176:179], v[80:83], v[56:59]
  ds_write_b64 v27, v[96:97] offset:0
  v_mfma_f32_16x16x32_bf16 v[60:63], a[208:211], v[80:83], v[60:63]
  v_mfma_f32_16x16x32_bf16 v[36:39], a[20:23], v[84:87], v[36:39]
  ds_read_b128 v[80:83], v25 offset:2816
  v_mfma_f32_16x16x32_bf16 v[40:43], a[52:55], v[84:87], v[40:43]
  v_mfma_f32_16x16x32_bf16 v[44:47], a[84:87], v[84:87], v[44:47]
  v_mfma_f32_16x16x32_bf16 v[48:51], a[116:119], v[84:87], v[48:51]
  v_mfma_f32_16x16x32_bf16 v[52:55], a[148:151], v[84:87], v[52:55]
  v_mfma_f32_16x16x32_bf16 v[56:59], a[180:183], v[84:87], v[56:59]
  v_mfma_f32_16x16x32_bf16 v[60:63], a[212:215], v[84:87], v[60:63]
  s_waitcnt lgkmcnt(7)
  v_mfma_f32_16x16x32_bf16 v[36:39], a[24:27], v[88:91], v[36:39]
  ds_read_b128 v[84:87], v25 offset:2880
  v_mfma_f32_16x16x32_bf16 v[40:43], a[56:59], v[88:91], v[40:43]
  v_mfma_f32_16x16x32_bf16 v[44:47], a[88:91], v[88:91], v[44:47]
  v_mfma_f32_16x16x32_bf16 v[48:51], a[120:123], v[88:91], v[48:51]
  v_mfma_f32_16x16x32_bf16 v[52:55], a[152:155], v[88:91], v[52:55]
  v_mfma_f32_16x16x32_bf16 v[56:59], a[184:187], v[88:91], v[56:59]
  v_mfma_f32_16x16x32_bf16 v[60:63], a[216:219], v[88:91], v[60:63]
  buffer_load_dword v20, v18, s[24:27], s68 offen
  s_add_u32 s68, s68, 3670016
  v_mfma_f32_16x16x32_bf16 v[36:39], a[28:31], v[92:95], v[36:39]
  ds_read_b128 v[88:91], v25 offset:2944
  v_mfma_f32_16x16x32_bf16 v[40:43], a[60:63], v[92:95], v[40:43]
  v_mfma_f32_16x16x32_bf16 v[44:47], a[92:95], v[92:95], v[44:47]
  v_mfma_f32_16x16x32_bf16 v[48:51], a[124:127], v[92:95], v[48:51]
  v_mfma_f32_16x16x32_bf16 v[52:55], a[156:159], v[92:95], v[52:55]
  v_mfma_f32_16x16x32_bf16 v[56:59], a[188:191], v[92:95], v[56:59]
  v_mfma_f32_16x16x32_bf16 v[60:63], a[220:223], v[92:95], v[60:63]
  s_waitcnt lgkmcnt(6)
  v_mfma_f32_16x16x32_bf16 v[40:43], a[0:3], v[64:67], v[40:43]
  ds_read_b128 v[92:95], v25 offset:3008
  v_mfma_f32_16x16x32_bf16 v[44:47], a[32:35], v[64:67], v[44:47]
  ds_read_b64 v[104:105], v26 offset:3072
  v_mfma_f32_16x16x32_bf16 v[48:51], a[64:67], v[64:67], v[48:51]
  v_mfma_f32_16x16x32_bf16 v[52:55], a[96:99], v[64:67], v[52:55]
  v_mfma_f32_16x16x32_bf16 v[56:59], a[128:131], v[64:67], v[56:59]
  v_mfma_f32_16x16x32_bf16 v[60:63], a[160:163], v[64:67], v[60:63]
  v_mfma_f32_16x16x32_bf16 v[40:43], a[4:7], v[68:71], v[40:43]
  ds_read_b128 v[64:67], v25 offset:2048
  v_mfma_f32_16x16x32_bf16 v[44:47], a[36:39], v[68:71], v[44:47]
  v_mfma_f32_16x16x32_bf16 v[48:51], a[68:71], v[68:71], v[48:51]
  v_mfma_f32_16x16x32_bf16 v[52:55], a[100:103], v[68:71], v[52:55]
  v_mfma_f32_16x16x32_bf16 v[56:59], a[132:135], v[68:71], v[56:59]
  v_mfma_f32_16x16x32_bf16 v[60:63], a[164:167], v[68:71], v[60:63]
  s_waitcnt lgkmcnt(7)
  v_mfma_f32_16x16x32_bf16 v[40:43], a[8:11], v[72:75], v[40:43]
  ds_read_b128 v[68:71], v25 offset:2112
  v_mfma_f32_16x16x32_bf16 v[44:47], a[40:43], v[72:75], v[44:47]
  v_mfma_f32_16x16x32_bf16 v[48:51], a[72:75], v[72:75], v[48:51]
  v_mfma_f32_16x16x32_bf16 v[52:55], a[104:107], v[72:75], v[52:55]
  v_mfma_f32_16x16x32_bf16 v[56:59], a[136:139], v[72:75], v[56:59]
  v_mfma_f32_16x16x32_bf16 v[60:63], a[168:171], v[72:75], v[60:63]
  s_waitcnt lgkmcnt(2)
  v_mfma_f32_16x16x32_bf16 v[40:43], a[12:15], v[76:79], v[40:43]
  ds_read_b128 v[72:75], v25 offset:2176
  v_mfma_f32_16x16x32_bf16 v[44:47], a[44:47], v[76:79], v[44:47]
  v_and_b32 v106, 0xffff0000, v105
  v_mfma_f32_16x16x32_bf16 v[48:51], a[76:79], v[76:79], v[48:51]
  v_lshlrev_b32 v107, 16, v105
  v_mfma_f32_16x16x32_bf16 v[52:55], a[108:111], v[76:79], v[52:55]
  v_and_b32 v108, 0xffff0000, v104
  v_mfma_f32_16x16x32_bf16 v[56:59], a[140:143], v[76:79], v[56:59]
  v_lshlrev_b32 v109, 16, v104
  v_mfma_f32_16x16x32_bf16 v[60:63], a[172:175], v[76:79], v[60:63]
  v_fma_f32 v106, v106, s3, v36
  s_waitcnt lgkmcnt(6)
  v_mfma_f32_16x16x32_bf16 v[40:43], a[16:19], v[80:83], v[40:43]
  ds_read_b128 v[76:79], v25 offset:2240
  v_mfma_f32_16x16x32_bf16 v[44:47], a[48:51], v[80:83], v[44:47]
  v_fma_f32 v107, v107, s3, v37
  v_mfma_f32_16x16x32_bf16 v[48:51], a[80:83], v[80:83], v[48:51]
  v_fma_f32 v108, v108, s3, v38
  v_mfma_f32_16x16x32_bf16 v[52:55], a[112:115], v[80:83], v[52:55]
  v_fma_f32 v109, v109, s3, v39
  v_mfma_f32_16x16x32_bf16 v[56:59], a[144:147], v[80:83], v[56:59]
  v_cvt_pk_bf16_f32 v104, v106, v107
  v_mfma_f32_16x16x32_bf16 v[60:63], a[176:179], v[80:83], v[60:63]
  v_cvt_pk_bf16_f32 v105, v108, v109
  v_mfma_f32_16x16x32_bf16 v[40:43], a[20:23], v[84:87], v[40:43]
  ds_read_b128 v[80:83], v25 offset:2304
  v_mfma_f32_16x16x32_bf16 v[44:47], a[52:55], v[84:87], v[44:47]
  ds_write_b64 v27, v[104:105] offset:2048
  v_mfma_f32_16x16x32_bf16 v[48:51], a[84:87], v[84:87], v[48:51]
  v_mfma_f32_16x16x32_bf16 v[52:55], a[116:119], v[84:87], v[52:55]
  v_mfma_f32_16x16x32_bf16 v[56:59], a[148:151], v[84:87], v[56:59]
  v_mfma_f32_16x16x32_bf16 v[60:63], a[180:183], v[84:87], v[60:63]
  s_waitcnt lgkmcnt(7)
  v_mfma_f32_16x16x32_bf16 v[40:43], a[24:27], v[88:91], v[40:43]
  ds_read_b128 v[84:87], v25 offset:2368
  v_mfma_f32_16x16x32_bf16 v[44:47], a[56:59], v[88:91], v[44:47]
  v_mfma_f32_16x16x32_bf16 v[48:51], a[88:91], v[88:91], v[48:51]
  v_mfma_f32_16x16x32_bf16 v[52:55], a[120:123], v[88:91], v[52:55]
  v_mfma_f32_16x16x32_bf16 v[56:59], a[152:155], v[88:91], v[56:59]
  v_mfma_f32_16x16x32_bf16 v[60:63], a[184:187], v[88:91], v[60:63]
  v_mfma_f32_16x16x32_bf16 v[40:43], a[28:31], v[92:95], v[40:43]
  ds_read_b128 v[88:91], v25 offset:2432
  v_mfma_f32_16x16x32_bf16 v[44:47], a[60:63], v[92:95], v[44:47]
  v_mfma_f32_16x16x32_bf16 v[48:51], a[92:95], v[92:95], v[48:51]
  v_mfma_f32_16x16x32_bf16 v[52:55], a[124:127], v[92:95], v[52:55]
  v_mfma_f32_16x16x32_bf16 v[56:59], a[156:159], v[92:95], v[56:59]
  v_mfma_f32_16x16x32_bf16 v[60:63], a[188:191], v[92:95], v[60:63]
  s_waitcnt lgkmcnt(6)
  v_mfma_f32_16x16x32_bf16 v[44:47], a[0:3], v[64:67], v[44:47]
  ds_read_b128 v[92:95], v25 offset:2496
  v_mfma_f32_16x16x32_bf16 v[48:51], a[32:35], v[64:67], v[48:51]
  ds_read_b64 v[112:113], v26 offset:2560
  v_mfma_f32_16x16x32_bf16 v[52:55], a[64:67], v[64:67], v[52:55]
  v_mfma_f32_16x16x32_bf16 v[56:59], a[96:99], v[64:67], v[56:59]
  v_mfma_f32_16x16x32_bf16 v[60:63], a[128:131], v[64:67], v[60:63]
  v_mfma_f32_16x16x32_bf16 v[44:47], a[4:7], v[68:71], v[44:47]
  ds_read_b128 v[64:67], v25 offset:1536
  v_mfma_f32_16x16x32_bf16 v[48:51], a[36:39], v[68:71], v[48:51]
  v_mfma_f32_16x16x32_bf16 v[52:55], a[68:71], v[68:71], v[52:55]
  v_mfma_f32_16x16x32_bf16 v[56:59], a[100:103], v[68:71], v[56:59]
  v_mfma_f32_16x16x32_bf16 v[60:63], a[132:135], v[68:71], v[60:63]
  s_waitcnt lgkmcnt(7)
  v_mfma_f32_16x16x32_bf16 v[44:47], a[8:11], v[72:75], v[44:47]
  ds_read_b128 v[68:71], v25 offset:1600
  v_mfma_f32_16x16x32_bf16 v[48:51], a[40:43], v[72:75], v[48:51]
  v_mfma_f32_16x16x32_bf16 v[52:55], a[72:75], v[72:75], v[52:55]
  v_mfma_f32_16x16x32_bf16 v[56:59], a[104:107], v[72:75], v[56:59]
  v_mfma_f32_16x16x32_bf16 v[60:63], a[136:139], v[72:75], v[60:63]
  s_waitcnt lgkmcnt(2)
  v_mfma_f32_16x16x32_bf16 v[44:47], a[12:15], v[76:79], v[44:47]
  ds_read_b128 v[72:75], v25 offset:1664
  v_mfma_f32_16x16x32_bf16 v[48:51], a[44:47], v[76:79], v[48:51]
  v_and_b32 v114, 0xffff0000, v113
  v_mfma_f32_16x16x32_bf16 v[52:55], a[76:79], v[76:79], v[52:55]
  v_lshlrev_b32 v115, 16, v113
  v_mfma_f32_16x16x32_bf16 v[56:59], a[108:111], v[76:79], v[56:59]
  v_and_b32 v116, 0xffff0000, v112
  v_mfma_f32_16x16x32_bf16 v[60:63], a[140:143], v[76:79], v[60:63]
  v_lshlrev_b32 v117, 16, v112
  s_waitcnt lgkmcnt(6)
  v_mfma_f32_16x16x32_bf16 v[44:47], a[16:19], v[80:83], v[44:47]
  ds_read_b128 v[76:79], v25 offset:1728
  v_mfma_f32_16x16x32_bf16 v[48:51], a[48:51], v[80:83], v[48:51]
  v_fma_f32 v114, v114, s3, v40
  v_mfma_f32_16x16x32_bf16 v[52:55], a[80:83], v[80:83], v[52:55]
  v_fma_f32 v115, v115, s3, v41
  v_mfma_f32_16x16x32_bf16 v[56:59], a[112:115], v[80:83], v[56:59]
  v_fma_f32 v116, v116, s3, v42
  v_mfma_f32_16x16x32_bf16 v[60:63], a[144:147], v[80:83], v[60:63]
  v_fma_f32 v117, v117, s3, v43
  v_mfma_f32_16x16x32_bf16 v[44:47], a[20:23], v[84:87], v[44:47]
  ds_read_b128 v[80:83], v25 offset:1792
  v_mfma_f32_16x16x32_bf16 v[48:51], a[52:55], v[84:87], v[48:51]
  v_cvt_pk_bf16_f32 v112, v114, v115
  v_mfma_f32_16x16x32_bf16 v[52:55], a[84:87], v[84:87], v[52:55]
  v_cvt_pk_bf16_f32 v113, v116, v117
  v_mfma_f32_16x16x32_bf16 v[56:59], a[116:119], v[84:87], v[56:59]
  ds_write_b64 v27, v[112:113] offset:4096
  v_mfma_f32_16x16x32_bf16 v[60:63], a[148:151], v[84:87], v[60:63]
  s_waitcnt lgkmcnt(7)
  v_mfma_f32_16x16x32_bf16 v[44:47], a[24:27], v[88:91], v[44:47]
  ds_read_b128 v[84:87], v25 offset:1856
  v_mfma_f32_16x16x32_bf16 v[48:51], a[56:59], v[88:91], v[48:51]
  v_mfma_f32_16x16x32_bf16 v[52:55], a[88:91], v[88:91], v[52:55]
  v_mfma_f32_16x16x32_bf16 v[56:59], a[120:123], v[88:91], v[56:59]
  v_mfma_f32_16x16x32_bf16 v[60:63], a[152:155], v[88:91], v[60:63]
  v_mfma_f32_16x16x32_bf16 v[44:47], a[28:31], v[92:95], v[44:47]
  ds_read_b128 v[88:91], v25 offset:1920
  v_mfma_f32_16x16x32_bf16 v[48:51], a[60:63], v[92:95], v[48:51]
  v_mfma_f32_16x16x32_bf16 v[52:55], a[92:95], v[92:95], v[52:55]
  v_mfma_f32_16x16x32_bf16 v[56:59], a[124:127], v[92:95], v[56:59]
  v_mfma_f32_16x16x32_bf16 v[60:63], a[156:159], v[92:95], v[60:63]
  s_waitcnt lgkmcnt(6)
  v_mfma_f32_16x16x32_bf16 v[48:51], a[0:3], v[64:67], v[48:51]
  ds_read_b128 v[92:95], v25 offset:1984
  v_mfma_f32_16x16x32_bf16 v[52:55], a[32:35], v[64:67], v[52:55]
  ds_read_b64 v[120:121], v26 offset:2048
  v_mfma_f32_16x16x32_bf16 v[56:59], a[64:67], v[64:67], v[56:59]
  v_mfma_f32_16x16x32_bf16 v[60:63], a[96:99], v[64:67], v[60:63]
  v_mfma_f32_16x16x32_bf16 v[48:51], a[4:7], v[68:71], v[48:51]
  ds_read_b128 v[64:67], v25 offset:1024
  v_mfma_f32_16x16x32_bf16 v[52:55], a[36:39], v[68:71], v[52:55]
  v_mfma_f32_16x16x32_bf16 v[56:59], a[68:71], v[68:71], v[56:59]
  v_mfma_f32_16x16x32_bf16 v[60:63], a[100:103], v[68:71], v[60:63]
  s_waitcnt lgkmcnt(7)
  v_mfma_f32_16x16x32_bf16 v[48:51], a[8:11], v[72:75], v[48:51]
  ds_read_b128 v[68:71], v25 offset:1088
  v_mfma_f32_16x16x32_bf16 v[52:55], a[40:43], v[72:75], v[52:55]
  v_mfma_f32_16x16x32_bf16 v[56:59], a[72:75], v[72:75], v[56:59]
  v_mfma_f32_16x16x32_bf16 v[60:63], a[104:107], v[72:75], v[60:63]
  s_waitcnt lgkmcnt(2)
  v_mfma_f32_16x16x32_bf16 v[48:51], a[12:15], v[76:79], v[48:51]
  ds_read_b128 v[72:75], v25 offset:1152
  v_mfma_f32_16x16x32_bf16 v[52:55], a[44:47], v[76:79], v[52:55]
  v_and_b32 v122, 0xffff0000, v121
  v_mfma_f32_16x16x32_bf16 v[56:59], a[76:79], v[76:79], v[56:59]
  v_lshlrev_b32 v123, 16, v121
  v_mfma_f32_16x16x32_bf16 v[60:63], a[108:111], v[76:79], v[60:63]
  v_and_b32 v124, 0xffff0000, v120
  s_waitcnt lgkmcnt(6)
  v_mfma_f32_16x16x32_bf16 v[48:51], a[16:19], v[80:83], v[48:51]
  ds_read_b128 v[76:79], v25 offset:1216
  v_mfma_f32_16x16x32_bf16 v[52:55], a[48:51], v[80:83], v[52:55]
  v_lshlrev_b32 v125, 16, v120
  v_mfma_f32_16x16x32_bf16 v[56:59], a[80:83], v[80:83], v[56:59]
  v_fma_f32 v122, v122, s3, v44
  v_mfma_f32_16x16x32_bf16 v[60:63], a[112:115], v[80:83], v[60:63]
  v_fma_f32 v123, v123, s3, v45
  v_mfma_f32_16x16x32_bf16 v[48:51], a[20:23], v[84:87], v[48:51]
  ds_read_b128 v[80:83], v25 offset:1280
  v_mfma_f32_16x16x32_bf16 v[52:55], a[52:55], v[84:87], v[52:55]
  v_fma_f32 v124, v124, s3, v46
  v_mfma_f32_16x16x32_bf16 v[56:59], a[84:87], v[84:87], v[56:59]
  v_fma_f32 v125, v125, s3, v47
  v_mfma_f32_16x16x32_bf16 v[60:63], a[116:119], v[84:87], v[60:63]
  v_cvt_pk_bf16_f32 v120, v122, v123
  s_waitcnt lgkmcnt(6)
  v_mfma_f32_16x16x32_bf16 v[48:51], a[24:27], v[88:91], v[48:51]
  ds_read_b128 v[84:87], v25 offset:1344
  v_mfma_f32_16x16x32_bf16 v[52:55], a[56:59], v[88:91], v[52:55]
  v_cvt_pk_bf16_f32 v121, v124, v125
  v_mfma_f32_16x16x32_bf16 v[56:59], a[88:91], v[88:91], v[56:59]
  ds_write_b64 v27, v[120:121] offset:6144
  v_mfma_f32_16x16x32_bf16 v[60:63], a[120:123], v[88:91], v[60:63]
  v_mfma_f32_16x16x32_bf16 v[48:51], a[28:31], v[92:95], v[48:51]
  ds_read_b128 v[88:91], v25 offset:1408
  v_mfma_f32_16x16x32_bf16 v[52:55], a[60:63], v[92:95], v[52:55]
  v_mfma_f32_16x16x32_bf16 v[56:59], a[92:95], v[92:95], v[56:59]
  v_mfma_f32_16x16x32_bf16 v[60:63], a[124:127], v[92:95], v[60:63]
  buffer_load_dword v31, v21, s[8:11], 0 offen sc1
  s_waitcnt lgkmcnt(6)
  v_mfma_f32_16x16x32_bf16 v[52:55], a[0:3], v[64:67], v[52:55]
  ds_read_b128 v[92:95], v25 offset:1472
  v_mfma_f32_16x16x32_bf16 v[56:59], a[32:35], v[64:67], v[56:59]
  ds_read_b64 v[96:97], v26 offset:1536
  v_mfma_f32_16x16x32_bf16 v[60:63], a[64:67], v[64:67], v[60:63]
  s_waitcnt lgkmcnt(3)
  s_barrier
  ds_read_b128 v[168:171], v177 offset:0
  ds_read_b128 v[172:175], v177 offset:4096
  v_mfma_f32_16x16x32_bf16 v[52:55], a[4:7], v[68:71], v[52:55]
  ds_read_b128 v[64:67], v25 offset:512
  v_mfma_f32_16x16x32_bf16 v[56:59], a[36:39], v[68:71], v[56:59]
  v_mfma_f32_16x16x32_bf16 v[60:63], a[68:71], v[68:71], v[60:63]
  s_waitcnt lgkmcnt(9)
  v_mfma_f32_16x16x32_bf16 v[52:55], a[8:11], v[72:75], v[52:55]
  ds_read_b128 v[68:71], v25 offset:576
  v_mfma_f32_16x16x32_bf16 v[56:59], a[40:43], v[72:75], v[56:59]
  v_mfma_f32_16x16x32_bf16 v[60:63], a[72:75], v[72:75], v[60:63]
  s_waitcnt lgkmcnt(4)
  v_mfma_f32_16x16x32_bf16 v[52:55], a[12:15], v[76:79], v[52:55]
  ds_read_b128 v[72:75], v25 offset:640
  v_and_b32 v98, 0xffff0000, v97
  v_mfma_f32_16x16x32_bf16 v[56:59], a[44:47], v[76:79], v[56:59]
  v_lshlrev_b32 v99, 16, v97
  v_mfma_f32_16x16x32_bf16 v[60:63], a[76:79], v[76:79], v[60:63]
  v_and_b32 v100, 0xffff0000, v96
  s_waitcnt lgkmcnt(3)
  buffer_store_dwordx4 v[168:171], v30, s[12:15], s79 offen sc1
  s_add_u32 s79, s79, 1048576
  buffer_store_dwordx4 v[172:175], v30, s[12:15], s79 offen sc1
  s_add_u32 s79, s79, 1048576
  s_waitcnt lgkmcnt(9)
  v_mfma_f32_16x16x32_bf16 v[52:55], a[16:19], v[80:83], v[52:55]
  ds_read_b128 v[76:79], v25 offset:704
  v_lshlrev_b32 v101, 16, v96
  v_mfma_f32_16x16x32_bf16 v[56:59], a[48:51], v[80:83], v[56:59]
  v_fma_f32 v98, v98, s3, v48
  v_mfma_f32_16x16x32_bf16 v[60:63], a[80:83], v[80:83], v[60:63]
  v_fma_f32 v99, v99, s3, v49
  v_mfma_f32_16x16x32_bf16 v[52:55], a[20:23], v[84:87], v[52:55]
  ds_read_b128 v[80:83], v25 offset:768
  v_fma_f32 v100, v100, s3, v50
  v_mfma_f32_16x16x32_bf16 v[56:59], a[52:55], v[84:87], v[56:59]
  v_fma_f32 v101, v101, s3, v51
  v_mfma_f32_16x16x32_bf16 v[60:63], a[84:87], v[84:87], v[60:63]
  v_cvt_pk_bf16_f32 v96, v98, v99
  s_waitcnt lgkmcnt(8)
  v_mfma_f32_16x16x32_bf16 v[52:55], a[24:27], v[88:91], v[52:55]
  ds_read_b128 v[84:87], v25 offset:832
  v_cvt_pk_bf16_f32 v97, v100, v101
  v_mfma_f32_16x16x32_bf16 v[56:59], a[56:59], v[88:91], v[56:59]
  ds_write_b64 v27, v[96:97] offset:8192
  v_mfma_f32_16x16x32_bf16 v[60:63], a[88:91], v[88:91], v[60:63]
  v_mfma_f32_16x16x32_bf16 v[52:55], a[28:31], v[92:95], v[52:55]
  ds_read_b128 v[88:91], v25 offset:896
  v_mfma_f32_16x16x32_bf16 v[56:59], a[60:63], v[92:95], v[56:59]
  v_mfma_f32_16x16x32_bf16 v[60:63], a[92:95], v[92:95], v[60:63]
  s_waitcnt lgkmcnt(6)
  v_mfma_f32_16x16x32_bf16 v[56:59], a[0:3], v[64:67], v[56:59]
  ds_read_b128 v[92:95], v25 offset:960
  v_mfma_f32_16x16x32_bf16 v[60:63], a[32:35], v[64:67], v[60:63]
  ds_read_b64 v[104:105], v26 offset:1024
  v_mfma_f32_16x16x32_bf16 v[56:59], a[4:7], v[68:71], v[56:59]
  ds_read_b128 v[64:67], v25 offset:0
  v_mfma_f32_16x16x32_bf16 v[60:63], a[36:39], v[68:71], v[60:63]
  s_waitcnt lgkmcnt(7)
  v_mfma_f32_16x16x32_bf16 v[56:59], a[8:11], v[72:75], v[56:59]
  ds_read_b128 v[68:71], v25 offset:64
  v_mfma_f32_16x16x32_bf16 v[60:63], a[40:43], v[72:75], v[60:63]
  s_waitcnt lgkmcnt(2)
  v_mfma_f32_16x16x32_bf16 v[56:59], a[12:15], v[76:79], v[56:59]
  ds_read_b128 v[72:75], v25 offset:128
  v_and_b32 v106, 0xffff0000, v105
  v_lshlrev_b32 v107, 16, v105
  v_mfma_f32_16x16x32_bf16 v[60:63], a[44:47], v[76:79], v[60:63]
  v_and_b32 v108, 0xffff0000, v104
  v_lshlrev_b32 v109, 16, v104
  s_waitcnt lgkmcnt(7)
  v_mfma_f32_16x16x32_bf16 v[56:59], a[16:19], v[80:83], v[56:59]
  ds_read_b128 v[76:79], v25 offset:192
  v_fma_f32 v106, v106, s3, v52
  v_fma_f32 v107, v107, s3, v53
  v_mfma_f32_16x16x32_bf16 v[60:63], a[48:51], v[80:83], v[60:63]
  v_fma_f32 v108, v108, s3, v54
  v_fma_f32 v109, v109, s3, v55
  v_mfma_f32_16x16x32_bf16 v[56:59], a[20:23], v[84:87], v[56:59]
  ds_read_b128 v[80:83], v25 offset:256
  v_cvt_pk_bf16_f32 v104, v106, v107
  v_cvt_pk_bf16_f32 v105, v108, v109
  v_mfma_f32_16x16x32_bf16 v[60:63], a[52:55], v[84:87], v[60:63]
  ds_write_b64 v27, v[104:105] offset:10240
  s_waitcnt lgkmcnt(7)
  v_mfma_f32_16x16x32_bf16 v[56:59], a[24:27], v[88:91], v[56:59]
  ds_read_b128 v[84:87], v25 offset:320
  v_mfma_f32_16x16x32_bf16 v[60:63], a[56:59], v[88:91], v[60:63]
  v_mfma_f32_16x16x32_bf16 v[56:59], a[28:31], v[92:95], v[56:59]
  ds_read_b128 v[88:91], v25 offset:384
  v_mfma_f32_16x16x32_bf16 v[60:63], a[60:63], v[92:95], v[60:63]
  s_waitcnt lgkmcnt(6)
  v_mfma_f32_16x16x32_bf16 v[60:63], a[0:3], v[64:67], v[60:63]
  ds_read_b128 v[92:95], v25 offset:448
  ds_read_b64 v[112:113], v26 offset:512
  v_mfma_f32_16x16x32_bf16 v[60:63], a[4:7], v[68:71], v[60:63]
  s_waitcnt lgkmcnt(6)
  v_mfma_f32_16x16x32_bf16 v[60:63], a[8:11], v[72:75], v[60:63]
  s_waitcnt lgkmcnt(0)
  v_mfma_f32_16x16x32_bf16 v[60:63], a[12:15], v[76:79], v[60:63]
  v_and_b32 v114, 0xffff0000, v113
  v_lshlrev_b32 v115, 16, v113
  v_and_b32 v116, 0xffff0000, v112
  s_waitcnt lgkmcnt(3)
  v_mfma_f32_16x16x32_bf16 v[60:63], a[16:19], v[80:83], v[60:63]
  v_lshlrev_b32 v117, 16, v112
  v_fma_f32 v114, v114, s3, v56
  v_fma_f32 v115, v115, s3, v57
  ds_read_b64 v[120:121], v26 offset:0
  v_mfma_f32_16x16x32_bf16 v[60:63], a[20:23], v[84:87], v[60:63]
  v_fma_f32 v116, v116, s3, v58
  v_fma_f32 v117, v117, s3, v59
  v_cvt_pk_bf16_f32 v112, v114, v115
  s_waitcnt lgkmcnt(2)
  v_mfma_f32_16x16x32_bf16 v[60:63], a[24:27], v[88:91], v[60:63]
  v_cvt_pk_bf16_f32 v113, v116, v117
  ds_write_b64 v27, v[112:113] offset:12288
  v_mfma_f32_16x16x32_bf16 v[60:63], a[28:31], v[92:95], v[60:63]
  s_waitcnt lgkmcnt(0)
  v_and_b32 v122, 0xffff0000, v121
  v_lshlrev_b32 v123, 16, v121
  v_and_b32 v124, 0xffff0000, v120
  v_lshlrev_b32 v125, 16, v120
  s_nop 3
  v_fma_f32 v122, v122, s3, v60
  v_fma_f32 v123, v123, s3, v61
  v_fma_f32 v124, v124, s3, v62
  v_fma_f32 v125, v125, s3, v63
  v_cvt_pk_bf16_f32 v120, v122, v123
  v_cvt_pk_bf16_f32 v121, v124, v125
  ds_write_b64 v27, v[120:121] offset:14336
  s_waitcnt lgkmcnt(0)
  s_barrier
  ds_read_b128 v[168:171], v177 offset:8192
  ds_read_b128 v[172:175], v177 offset:12288
  s_waitcnt lgkmcnt(1)
  buffer_store_dwordx4 v[168:171], v30, s[12:15], s79 offen sc1
  s_add_u32 s79, s79, 1048576
  s_waitcnt lgkmcnt(0)
  buffer_store_dwordx4 v[172:175], v30, s[12:15], s79 offen sc1
  s_add_u32 s79, s79, 1048576
  s_waitcnt vmcnt(5)
  v_lshlrev_b32 v128, 16, v212
  v_and_b32 v129, 0xffff0000, v212
  v_lshlrev_b32 v130, 16, v213
  v_and_b32 v131, 0xffff0000, v213
  v_lshlrev_b32 v132, 16, v214
  v_and_b32 v133, 0xffff0000, v214
  v_lshlrev_b32 v134, 16, v215
  v_and_b32 v135, 0xffff0000, v215
  v_lshlrev_b32 v136, 16, v216
  v_and_b32 v137, 0xffff0000, v216
  v_lshlrev_b32 v138, 16, v217
  v_and_b32 v139, 0xffff0000, v217
  v_lshlrev_b32 v140, 16, v218
  v_and_b32 v141, 0xffff0000, v218
  v_lshlrev_b32 v142, 16, v219
  v_and_b32 v143, 0xffff0000, v219
  v_lshlrev_b32 v144, 16, v220
  v_and_b32 v145, 0xffff0000, v220
  v_lshlrev_b32 v146, 16, v221
  v_and_b32 v147, 0xffff0000, v221
  v_lshlrev_b32 v148, 16, v222
  v_and_b32 v149, 0xffff0000, v222
  v_lshlrev_b32 v150, 16, v223
  v_and_b32 v151, 0xffff0000, v223
  v_lshlrev_b32 v152, 16, v224
  v_and_b32 v153, 0xffff0000, v224
  v_lshlrev_b32 v154, 16, v225
  v_and_b32 v155, 0xffff0000, v225
  v_lshlrev_b32 v156, 16, v226
  v_and_b32 v157, 0xffff0000, v226
  v_lshlrev_b32 v158, 16, v227
  v_and_b32 v159, 0xffff0000, v227
  s_add_u32 s20, s6, 4194304
  s_addc_u32 s21, s7, 0
  s_mov_b32 s22, 4194304
  s_mov_b32 s23, 0x20000
  s_add_u32 s44, s6, 8388608
  s_addc_u32 s45, s7, 0
  s_mov_b32 s46, 4194304
  s_mov_b32 s47, 0x20000
  s_mov_b32 s52, s64
  s_mov_b32 s53, s65
  s_mov_b32 s54, 7340032
  s_mov_b32 s55, 0x20000
  s_add_u32 s40, s6, 12582912
  s_addc_u32 s41, s7, 0
  s_mov_b32 s42, 14680064
  s_mov_b32 s43, 0x20000
  s_lshl_b32 s16, s18, 2
  s_add_u32 s16, s16, s17
  s_lshl_b32 s32, s16, 17
  s_add_u32 s32, s32, 8388608
  s_add_u32 s28, s6, s32
  s_addc_u32 s29, s7, 0
  s_mov_b32 s30, 131072
  s_mov_b32 s31, 0x20000
  s_mul_i32 s32, s19, 224
  s_and_b32 s33, s17, 1
  s_mul_i32 s34, s33, 229376
  s_add_u32 s32, s32, s34
  s_mov_b32 s34, 74899
  s_movk_i32 s35, 7168
  s_add_u32 s98, s101, 98304
  s_waitcnt vmcnt(0)
  s_barrier
  s_cmp_lg_u32 s17, 0
  s_cbranch_scc1 L_nosigz

  v_mov_b32 v0, 0
  v_mov_b32 v1, 1
  s_mov_b64 exec, 1
  buffer_store_dword v1, v0, s[48:51], s98 offen sc1
  s_mov_b64 exec, -1
L_nosigz:
  v_cmp_eq_u32 vcc, 0, v31
  s_nop 1
  s_cmp_lg_u64 vcc, 0
  s_cbranch_scc1 L_gate_slow

L_gate_back:
  v_add_u32 v3, 0, v2
  v_mul_lo_u32 v4, v3, s34
  v_lshrrev_b32 v4, 20, v4
  v_mul_u32_u24 v5, 14, v4
  v_sub_u32 v5, v3, v5
  v_and_b32 v3, 3, v4
  v_bfe_u32 v6, v4, 2, 2
  v_lshl_add_u32 v3, v6, 3, v3
  v_lshrrev_b32 v4, 4, v4
  v_lshl_add_u32 v4, v4, 2, v3
  v_mul_lo_u32 v4, v4, s35
  v_lshl_add_u32 v4, v5, 4, v4
  v_add_u32 v4, s32, v4
  v_subrev_u32 v8, 0, v4
  v_add_u32 v3, 64, v2
  v_mul_lo_u32 v4, v3, s34
  v_lshrrev_b32 v4, 20, v4
  v_mul_u32_u24 v5, 14, v4
  v_sub_u32 v5, v3, v5
  v_and_b32 v3, 3, v4
  v_bfe_u32 v6, v4, 2, 2
  v_lshl_add_u32 v3, v6, 3, v3
  v_lshrrev_b32 v4, 4, v4
  v_lshl_add_u32 v4, v4, 2, v3
  v_mul_lo_u32 v4, v4, s35
  v_lshl_add_u32 v4, v5, 4, v4
  v_add_u32 v4, s32, v4
  v_subrev_u32 v9, 1024, v4
  v_add_u32 v3, 128, v2
  v_mul_lo_u32 v4, v3, s34
  v_lshrrev_b32 v4, 20, v4
  v_mul_u32_u24 v5, 14, v4
  v_sub_u32 v5, v3, v5
  v_and_b32 v3, 3, v4
  v_bfe_u32 v6, v4, 2, 2
  v_lshl_add_u32 v3, v6, 3, v3
  v_lshrrev_b32 v4, 4, v4
  v_lshl_add_u32 v4, v4, 2, v3
  v_mul_lo_u32 v4, v4, s35
  v_lshl_add_u32 v4, v5, 4, v4
  v_add_u32 v4, s32, v4
  v_subrev_u32 v10, 2048, v4
  v_add_u32 v3, 192, v2
  v_mul_lo_u32 v4, v3, s34
  v_lshrrev_b32 v4, 20, v4
  v_mul_u32_u24 v5, 14, v4
  v_sub_u32 v5, v3, v5
  v_and_b32 v3, 3, v4
  v_bfe_u32 v6, v4, 2, 2
  v_lshl_add_u32 v3, v6, 3, v3
  v_lshrrev_b32 v4, 4, v4
  v_lshl_add_u32 v4, v4, 2, v3
  v_mul_lo_u32 v4, v4, s35
  v_lshl_add_u32 v4, v5, 4, v4
  v_add_u32 v4, s32, v4
  v_subrev_u32 v11, 3072, v4
  v_add_u32 v3, 256, v2
  v_mul_lo_u32 v4, v3, s34
  v_lshrrev_b32 v4, 20, v4
  v_mul_u32_u24 v5, 14, v4
  v_sub_u32 v5, v3, v5
  v_and_b32 v3, 3, v4
  v_bfe_u32 v6, v4, 2, 2
  v_lshl_add_u32 v3, v6, 3, v3
  v_lshrrev_b32 v4, 4, v4
  v_lshl_add_u32 v4, v4, 2, v3
  v_mul_lo_u32 v4, v4, s35
  v_lshl_add_u32 v4, v5, 4, v4
  v_add_u32 v4, s32, v4
  v_subrev_u32 v12, 0, v4
  v_add_u32 v3, 320, v2
  v_mul_lo_u32 v4, v3, s34
  v_lshrrev_b32 v4, 20, v4
  v_mul_u32_u24 v5, 14, v4
  v_sub_u32 v5, v3, v5
  v_and_b32 v3, 3, v4
  v_bfe_u32 v6, v4, 2, 2
  v_lshl_add_u32 v3, v6, 3, v3
  v_lshrrev_b32 v4, 4, v4
  v_lshl_add_u32 v4, v4, 2, v3
  v_mul_lo_u32 v4, v4, s35
  v_lshl_add_u32 v4, v5, 4, v4
  v_add_u32 v4, s32, v4
  v_subrev_u32 v13, 1024, v4
  v_add_u32 v3, 384, v2
  v_mul_lo_u32 v4, v3, s34
  v_lshrrev_b32 v4, 20, v4
  v_mul_u32_u24 v5, 14, v4
  v_sub_u32 v5, v3, v5
  v_and_b32 v3, 3, v4
  v_bfe_u32 v6, v4, 2, 2
  v_lshl_add_u32 v3, v6, 3, v3
  v_lshrrev_b32 v4, 4, v4
  v_lshl_add_u32 v4, v4, 2, v3
  v_mul_lo_u32 v4, v4, s35
  v_lshl_add_u32 v4, v5, 4, v4
  v_add_u32 v4, s32, v4
  v_subrev_u32 v14, 2048, v4
  s_mul_i32 s34, s33, 7168
  s_lshr_b32 s33, s17, 1
  s_mul_i32 s33, s33, 14464
  s_add_u32 s33, s33, s34
  v_lshrrev_b32 v3, 2, v2
  v_mul_u32_u24 v16, 224, v3
  v_and_b32 v3, 3, v2
  v_lshl_add_u32 v16, v3, 3, v16
  s_mov_b32 s34, 0
  s_mov_b32 s35, s33
  s_mov_b32 s36, 0
  s_bfe_u32 s70, s2, 0x20001
  s_and_b32 s71, s2, 1
  s_lshl_b32 s71, s71, 2
  s_lshr_b32 s72, s2, 6
  s_add_u32 s71, s71, s72
  s_bfe_u32 s72, s2, 0x30003
  s_mul_i32 s74, s70, 896
  s_lshl_b32 s75, s17, 7
  s_add_u32 s74, s74, s75
  s_lshr_b32 s75, s2, 3
  s_lshl_b32 s75, s75, 2
  s_add_u32 s74, s74, s75
  s_lshl_b32 s74, s74, 11
  s_add_u32 s75, s74, 1048576
  s_cmp_eq_u32 s17, 3
  s_cselect_b32 s75, 1073741824, s75
  s_lshl_b32 s39, s16, 3
  v_add_u32 v199, s39, v200
  v_lshlrev_b32 v199, 7, v199
  s_mov_b32 s34, 0
  s_add_u32 m0, s33, 86400
  s_nop 0
  buffer_load_dwordx4 v8, s[24:27], s34 offen offset:0 lds
  buffer_load_dwordx4 v9, s[24:27], s34 offen offset:1024 lds
  buffer_load_dwordx4 v10, s[24:27], s34 offen offset:2048 lds
  buffer_load_dwordx4 v11, s[24:27], s34 offen offset:3072 lds
  s_add_u32 m0, s33, 90496
  s_nop 0
  buffer_load_dwordx4 v12, s[24:27], s34 offen offset:0 lds
  buffer_load_dwordx4 v13, s[24:27], s34 offen offset:1024 lds
  buffer_load_dwordx4 v14, s[24:27], s34 offen offset:2048 lds
  v_pk_add_f32 v[160:161], v[128:129], v[130:131]
  v_pk_mul_f32 v[162:163], v[128:129], v[128:129]
  v_pk_fma_f32 v[162:163], v[130:131], v[130:131], v[162:163]
  v_pk_add_f32 v[160:161], v[160:161], v[132:133]
  v_pk_fma_f32 v[162:163], v[132:133], v[132:133], v[162:163]
  v_pk_add_f32 v[160:161], v[160:161], v[134:135]
  v_pk_fma_f32 v[162:163], v[134:135], v[134:135], v[162:163]
  v_pk_add_f32 v[160:161], v[160:161], v[136:137]
  v_pk_fma_f32 v[162:163], v[136:137], v[136:137], v[162:163]
  v_pk_add_f32 v[160:161], v[160:161], v[138:139]
  v_pk_fma_f32 v[162:163], v[138:139], v[138:139], v[162:163]
  v_pk_add_f32 v[160:161], v[160:161], v[140:141]
  v_pk_fma_f32 v[162:163], v[140:141], v[140:141], v[162:163]
  v_pk_add_f32 v[160:161], v[160:161], v[142:143]
  v_pk_fma_f32 v[162:163], v[142:143], v[142:143], v[162:163]
  v_pk_add_f32 v[160:161], v[160:161], v[144:145]
  v_pk_fma_f32 v[162:163], v[144:145], v[144:145], v[162:163]
  v_pk_add_f32 v[160:161], v[160:161], v[146:147]
  v_pk_fma_f32 v[162:163], v[146:147], v[146:147], v[162:163]
  v_pk_add_f32 v[160:161], v[160:161], v[148:149]
  v_pk_fma_f32 v[162:163], v[148:149], v[148:149], v[162:163]
  v_pk_add_f32 v[160:161], v[160:161], v[150:151]
  v_pk_fma_f32 v[162:163], v[150:151], v[150:151], v[162:163]
  v_pk_add_f32 v[160:161], v[160:161], v[152:153]
  v_pk_fma_f32 v[162:163], v[152:153], v[152:153], v[162:163]
  v_pk_add_f32 v[160:161], v[160:161], v[154:155]
  v_pk_fma_f32 v[162:163], v[154:155], v[154:155], v[162:163]
  v_pk_add_f32 v[160:161], v[160:161], v[156:157]
  v_pk_fma_f32 v[162:163], v[156:157], v[156:157], v[162:163]
  v_pk_add_f32 v[160:161], v[160:161], v[158:159]
  v_pk_fma_f32 v[162:163], v[158:159], v[158:159], v[162:163]
  v_add_f32 v208, v160, v161
  v_add_f32 v209, v162, v163
  s_nop 1
  v_add_f32_dpp v208, v208, v208 row_ror:8 row_mask:0xf bank_mask:0xf
  v_add_f32_dpp v209, v209, v209 row_ror:8 row_mask:0xf bank_mask:0xf
  v_mov_b32 v210, v208
  v_mov_b32 v211, v209
  s_nop 1
  v_permlane16_swap_b32 v208, v210
  v_permlane16_swap_b32 v209, v211
  s_nop 1
  v_add_f32 v208, v208, v210
  v_add_f32 v209, v209, v211
  v_mov_b32 v210, v208
  v_mov_b32 v211, v209
  s_nop 1
  v_permlane32_swap_b32 v208, v210
  v_permlane32_swap_b32 v209, v211
  s_nop 1
  v_add_f32 v208, v208, v210
  v_add_f32 v209, v209, v211
  ds_write_b64 v207, v[208:209] offset:0
  s_waitcnt lgkmcnt(0)
  s_barrier
  ds_read_b128 v[160:163], v206 offset:0
  ds_read_b128 v[164:167], v206 offset:16
  s_waitcnt lgkmcnt(0)
  v_pk_add_f32 v[160:161], v[160:161], v[162:163]
  v_pk_add_f32 v[164:165], v[164:165], v[166:167]
  v_pk_add_f32 v[160:161], v[160:161], v[164:165]
  v_mul_f32 v208, 0x3a800000, v160
  v_mul_f32 v209, 0x3a800000, v161
  v_fma_f32 v209, -v208, v208, v209
  v_max_f32 v209, 0, v209

  v_cvt_pk_bf16_f32 v208, v208, v208
  v_and_b32 v208, 0xffff0000, v208
  v_cvt_pk_bf16_f32 v209, v209, v209
  v_and_b32 v209, 0xffff0000, v209
  v_add_f32 v209, 0x3727c5ac, v209
  v_cvt_pk_bf16_f32 v209, v209, v209
  v_and_b32 v209, 0xffff0000, v209
  v_sqrt_f32 v209, v209
  s_nop 0
  v_cvt_pk_bf16_f32 v209, v209, v209
  v_and_b32 v209, 0xffff0000, v209
  v_rcp_f32 v209, v209
  s_nop 0
  v_mul_f32 v210, v208, v209
  v_sub_f32 v210, 0, v210
  v_mov_b32 v211, v210
  v_mov_b32 v208, v209
  v_pk_fma_f32 v[32:33], v[128:129], v[208:209], v[210:211]
  v_pk_fma_f32 v[34:35], v[130:131], v[208:209], v[210:211]
  v_pk_fma_f32 v[36:37], v[132:133], v[208:209], v[210:211]
  v_pk_fma_f32 v[38:39], v[134:135], v[208:209], v[210:211]
  v_pk_fma_f32 v[40:41], v[136:137], v[208:209], v[210:211]
  v_pk_fma_f32 v[42:43], v[138:139], v[208:209], v[210:211]
  v_pk_fma_f32 v[44:45], v[140:141], v[208:209], v[210:211]
  v_pk_fma_f32 v[46:47], v[142:143], v[208:209], v[210:211]
  v_pk_fma_f32 v[48:49], v[144:145], v[208:209], v[210:211]
  v_pk_fma_f32 v[50:51], v[146:147], v[208:209], v[210:211]
  v_pk_fma_f32 v[52:53], v[148:149], v[208:209], v[210:211]
  v_pk_fma_f32 v[54:55], v[150:151], v[208:209], v[210:211]
  v_pk_fma_f32 v[56:57], v[152:153], v[208:209], v[210:211]
  v_pk_fma_f32 v[58:59], v[154:155], v[208:209], v[210:211]
  v_pk_fma_f32 v[60:61], v[156:157], v[208:209], v[210:211]
  v_pk_fma_f32 v[62:63], v[158:159], v[208:209], v[210:211]
  s_lshr_b32 s76, s2, 2
  s_lshl_b32 s76, s76, 16
  s_and_b32 s77, s2, 3
  s_lshl_b32 s77, s77, 7
  s_add_u32 s76, s76, s77
  s_lshl_b32 s78, s17, 14
  s_add_u32 s76, s76, s78
  s_lshr_b32 s78, s2, 3
  s_lshl_b32 s78, s78, 17
  s_and_b32 s77, s2, 1
  s_lshl_b32 s77, s77, 7
  s_add_u32 s78, s78, s77
  s_bfe_u32 s77, s2, 0x20001
  s_lshl_b32 s77, s77, 10
  s_add_u32 s78, s78, s77
  s_lshl_b32 s77, s17, 15
  s_add_u32 s78, s78, s77
  s_mov_b32 m0, s37

  s_mov_b32 s39, 0x8000
L_poll_pz:
  buffer_load_dword v20, v29, s[48:51], 0 offen sc1
  s_waitcnt vmcnt(0)
  v_cmp_gt_u32 vcc, 1, v20
  s_nop 1
  s_cmp_eq_u64 vcc, 0
  s_cbranch_scc1 L_polled_pz
  s_sleep 1
  s_sub_u32 s39, s39, 1
  s_cmp_lg_u32 s39, 0
  s_cbranch_scc1 L_poll_pz

L_polled_pz:
  buffer_load_dwordx4 v192, s[12:15], s38 offen offset:0 sc1 lds
  buffer_load_dwordx4 v193, s[12:15], s38 offen offset:1024 sc1 lds
  buffer_load_dwordx4 v194, s[12:15], s38 offen offset:2048 sc1 lds
  buffer_load_dwordx4 v195, s[12:15], s38 offen offset:3072 sc1 lds
  s_waitcnt vmcnt(3)
  ds_read_b64_tr_b16 v[80:81], v204 offset:0
  ds_read_b64_tr_b16 v[82:83], v204 offset:64
  s_waitcnt vmcnt(2)
  ds_read_b64_tr_b16 v[84:85], v204 offset:1024
  ds_read_b64_tr_b16 v[86:87], v204 offset:1088
  s_waitcnt vmcnt(1)
  ds_read_b64_tr_b16 v[88:89], v204 offset:2048
  ds_read_b64_tr_b16 v[90:91], v204 offset:2112
  s_waitcnt vmcnt(0)
  ds_read_b64_tr_b16 v[92:93], v204 offset:3072
  ds_read_b64_tr_b16 v[94:95], v204 offset:3136
  s_waitcnt lgkmcnt(6)
  v_lshlrev_b32 v96, 16, v80
  v_and_b32 v97, 0xffff0000, v80
  v_lshlrev_b32 v98, 16, v81
  v_and_b32 v99, 0xffff0000, v81
  v_lshlrev_b32 v100, 16, v82
  v_and_b32 v101, 0xffff0000, v82
  v_lshlrev_b32 v102, 16, v83
  v_and_b32 v103, 0xffff0000, v83
  v_pk_fma_f32 v[128:129], v[32:33], v[96:97], v[128:129]
  v_pk_fma_f32 v[130:131], v[34:35], v[98:99], v[130:131]
  v_pk_fma_f32 v[132:133], v[36:37], v[100:101], v[132:133]
  v_pk_fma_f32 v[134:135], v[38:39], v[102:103], v[134:135]
  s_waitcnt lgkmcnt(4)
  v_lshlrev_b32 v104, 16, v84
  v_and_b32 v105, 0xffff0000, v84
  v_lshlrev_b32 v106, 16, v85
  v_and_b32 v107, 0xffff0000, v85
  v_lshlrev_b32 v108, 16, v86
  v_and_b32 v109, 0xffff0000, v86
  v_lshlrev_b32 v110, 16, v87
  v_and_b32 v111, 0xffff0000, v87
  v_pk_fma_f32 v[136:137], v[40:41], v[104:105], v[136:137]
  v_pk_fma_f32 v[138:139], v[42:43], v[106:107], v[138:139]
  v_pk_fma_f32 v[140:141], v[44:45], v[108:109], v[140:141]
  v_pk_fma_f32 v[142:143], v[46:47], v[110:111], v[142:143]
  s_waitcnt lgkmcnt(2)
  v_lshlrev_b32 v112, 16, v88
  v_and_b32 v113, 0xffff0000, v88
  v_lshlrev_b32 v114, 16, v89
  v_and_b32 v115, 0xffff0000, v89
  v_lshlrev_b32 v116, 16, v90
  v_and_b32 v117, 0xffff0000, v90
  v_lshlrev_b32 v118, 16, v91
  v_and_b32 v119, 0xffff0000, v91
  v_pk_fma_f32 v[144:145], v[48:49], v[112:113], v[144:145]
  v_pk_fma_f32 v[146:147], v[50:51], v[114:115], v[146:147]
  v_pk_fma_f32 v[148:149], v[52:53], v[116:117], v[148:149]
  v_pk_fma_f32 v[150:151], v[54:55], v[118:119], v[150:151]
  s_waitcnt lgkmcnt(0)
  v_lshlrev_b32 v120, 16, v92
  v_and_b32 v121, 0xffff0000, v92
  v_lshlrev_b32 v122, 16, v93
  v_and_b32 v123, 0xffff0000, v93
  v_lshlrev_b32 v124, 16, v94
  v_and_b32 v125, 0xffff0000, v94
  v_lshlrev_b32 v126, 16, v95
  v_and_b32 v127, 0xffff0000, v95
  v_pk_fma_f32 v[152:153], v[56:57], v[120:121], v[152:153]
  v_pk_fma_f32 v[154:155], v[58:59], v[122:123], v[154:155]
  v_pk_fma_f32 v[156:157], v[60:61], v[124:125], v[156:157]
  v_pk_fma_f32 v[158:159], v[62:63], v[126:127], v[158:159]
  v_pk_add_f32 v[160:161], v[128:129], v[130:131]
  v_pk_mul_f32 v[162:163], v[128:129], v[128:129]
  v_pk_fma_f32 v[162:163], v[130:131], v[130:131], v[162:163]
  v_pk_add_f32 v[160:161], v[160:161], v[132:133]
  v_pk_fma_f32 v[162:163], v[132:133], v[132:133], v[162:163]
  v_pk_add_f32 v[160:161], v[160:161], v[134:135]
  v_pk_fma_f32 v[162:163], v[134:135], v[134:135], v[162:163]
  v_pk_add_f32 v[160:161], v[160:161], v[136:137]
  v_pk_fma_f32 v[162:163], v[136:137], v[136:137], v[162:163]
  v_pk_add_f32 v[160:161], v[160:161], v[138:139]
  v_pk_fma_f32 v[162:163], v[138:139], v[138:139], v[162:163]
  v_pk_add_f32 v[160:161], v[160:161], v[140:141]
  v_pk_fma_f32 v[162:163], v[140:141], v[140:141], v[162:163]
  v_pk_add_f32 v[160:161], v[160:161], v[142:143]
  v_pk_fma_f32 v[162:163], v[142:143], v[142:143], v[162:163]
  v_pk_add_f32 v[160:161], v[160:161], v[144:145]
  v_pk_fma_f32 v[162:163], v[144:145], v[144:145], v[162:163]
  v_pk_add_f32 v[160:161], v[160:161], v[146:147]
  v_pk_fma_f32 v[162:163], v[146:147], v[146:147], v[162:163]
  v_pk_add_f32 v[160:161], v[160:161], v[148:149]
  v_pk_fma_f32 v[162:163], v[148:149], v[148:149], v[162:163]
  v_pk_add_f32 v[160:161], v[160:161], v[150:151]
  v_pk_fma_f32 v[162:163], v[150:151], v[150:151], v[162:163]
  v_pk_add_f32 v[160:161], v[160:161], v[152:153]
  v_pk_fma_f32 v[162:163], v[152:153], v[152:153], v[162:163]
  v_pk_add_f32 v[160:161], v[160:161], v[154:155]
  v_pk_fma_f32 v[162:163], v[154:155], v[154:155], v[162:163]
  v_pk_add_f32 v[160:161], v[160:161], v[156:157]
  v_pk_fma_f32 v[162:163], v[156:157], v[156:157], v[162:163]
  v_pk_add_f32 v[160:161], v[160:161], v[158:159]
  v_pk_fma_f32 v[162:163], v[158:159], v[158:159], v[162:163]
  v_add_f32 v208, v160, v161
  v_add_f32 v209, v162, v163
  s_nop 1
  v_add_f32_dpp v208, v208, v208 row_ror:8 row_mask:0xf bank_mask:0xf
  v_add_f32_dpp v209, v209, v209 row_ror:8 row_mask:0xf bank_mask:0xf
  v_mov_b32 v210, v208
  v_mov_b32 v211, v209
  s_nop 1
  v_permlane16_swap_b32 v208, v210
  v_permlane16_swap_b32 v209, v211
  s_nop 1
  v_add_f32 v208, v208, v210
  v_add_f32 v209, v209, v211
  v_mov_b32 v210, v208
  v_mov_b32 v211, v209
  s_nop 1
  v_permlane32_swap_b32 v208, v210
  v_permlane32_swap_b32 v209, v211
  s_nop 1
  v_add_f32 v208, v208, v210
  v_add_f32 v209, v209, v211
  ds_write_b64 v207, v[208:209] offset:256
  s_waitcnt lgkmcnt(0)
  s_barrier
  ds_read_b128 v[160:163], v206 offset:256
  ds_read_b128 v[164:167], v206 offset:272
  s_waitcnt lgkmcnt(0)
  v_pk_add_f32 v[160:161], v[160:161], v[162:163]
  v_pk_add_f32 v[164:165], v[164:165], v[166:167]
  v_pk_add_f32 v[160:161], v[160:161], v[164:165]
  v_mul_f32 v208, 0x3a800000, v160
  v_mul_f32 v209, 0x3a800000, v161
  v_fma_f32 v209, -v208, v208, v209
  v_max_f32 v209, 0, v209

  v_cvt_pk_bf16_f32 v208, v208, v208
  v_and_b32 v208, 0xffff0000, v208
  v_cvt_pk_bf16_f32 v209, v209, v209
  v_and_b32 v209, 0xffff0000, v209
  v_add_f32 v209, 0x3727c5ac, v209
  v_cvt_pk_bf16_f32 v209, v209, v209
  v_and_b32 v209, 0xffff0000, v209
  v_sqrt_f32 v209, v209
  s_nop 0
  v_cvt_pk_bf16_f32 v209, v209, v209
  v_and_b32 v209, 0xffff0000, v209
  v_rcp_f32 v209, v209
  s_nop 0
  v_mul_f32 v210, v208, v209
  v_sub_f32 v210, 0, v210
  v_mov_b32 v211, v210
  v_mov_b32 v208, v209
  v_pk_fma_f32 v[96:97], v[128:129], v[208:209], v[210:211]
  v_pk_fma_f32 v[98:99], v[130:131], v[208:209], v[210:211]
  v_pk_fma_f32 v[100:101], v[132:133], v[208:209], v[210:211]
  v_pk_fma_f32 v[102:103], v[134:135], v[208:209], v[210:211]
  v_cvt_pk_bf16_f32 v80, v96, v97
  v_cvt_pk_bf16_f32 v81, v98, v99
  v_cvt_pk_bf16_f32 v82, v100, v101
  v_cvt_pk_bf16_f32 v83, v102, v103
  buffer_store_dwordx4 v[80:83], v197, s[44:47], s78 offen sc1
  s_add_u32 s78, s78, 8192
  v_pk_fma_f32 v[104:105], v[136:137], v[208:209], v[210:211]
  v_pk_fma_f32 v[106:107], v[138:139], v[208:209], v[210:211]
  v_pk_fma_f32 v[108:109], v[140:141], v[208:209], v[210:211]
  v_pk_fma_f32 v[110:111], v[142:143], v[208:209], v[210:211]
  v_cvt_pk_bf16_f32 v84, v104, v105
  v_cvt_pk_bf16_f32 v85, v106, v107
  v_cvt_pk_bf16_f32 v86, v108, v109
  v_cvt_pk_bf16_f32 v87, v110, v111
  buffer_store_dwordx4 v[84:87], v197, s[44:47], s78 offen sc1
  s_add_u32 s78, s78, 8192
  v_pk_fma_f32 v[112:113], v[144:145], v[208:209], v[210:211]
  v_pk_fma_f32 v[114:115], v[146:147], v[208:209], v[210:211]
  v_pk_fma_f32 v[116:117], v[148:149], v[208:209], v[210:211]
  v_pk_fma_f32 v[118:119], v[150:151], v[208:209], v[210:211]
  v_cvt_pk_bf16_f32 v88, v112, v113
  v_cvt_pk_bf16_f32 v89, v114, v115
  v_cvt_pk_bf16_f32 v90, v116, v117
  v_cvt_pk_bf16_f32 v91, v118, v119
  buffer_store_dwordx4 v[88:91], v197, s[44:47], s78 offen sc1
  s_add_u32 s78, s78, 8192
  v_pk_fma_f32 v[120:121], v[152:153], v[208:209], v[210:211]
  v_pk_fma_f32 v[122:123], v[154:155], v[208:209], v[210:211]
  v_pk_fma_f32 v[124:125], v[156:157], v[208:209], v[210:211]
  v_pk_fma_f32 v[126:127], v[158:159], v[208:209], v[210:211]
  v_cvt_pk_bf16_f32 v92, v120, v121
  v_cvt_pk_bf16_f32 v93, v122, v123
  v_cvt_pk_bf16_f32 v94, v124, v125
  v_cvt_pk_bf16_f32 v95, v126, v127
  buffer_store_dwordx4 v[92:95], v197, s[44:47], s78 offen sc1
  s_add_u32 s78, s78, 8192
  v_cvt_pk_bf16_f32 v212, v128, v129
  v_cvt_pk_bf16_f32 v213, v130, v131
  v_cvt_pk_bf16_f32 v214, v132, v133
  v_cvt_pk_bf16_f32 v215, v134, v135
  v_cvt_pk_bf16_f32 v216, v136, v137
  v_cvt_pk_bf16_f32 v217, v138, v139
  v_cvt_pk_bf16_f32 v218, v140, v141
  v_cvt_pk_bf16_f32 v219, v142, v143
  v_cvt_pk_bf16_f32 v220, v144, v145
  v_cvt_pk_bf16_f32 v221, v146, v147
  v_cvt_pk_bf16_f32 v222, v148, v149
  v_cvt_pk_bf16_f32 v223, v150, v151
  v_cvt_pk_bf16_f32 v224, v152, v153
  v_cvt_pk_bf16_f32 v225, v154, v155
  v_cvt_pk_bf16_f32 v226, v156, v157
  v_cvt_pk_bf16_f32 v227, v158, v159
  v_accvgpr_write_b32 a184, v212
  v_accvgpr_write_b32 a185, v213
  v_accvgpr_write_b32 a186, v214
  v_accvgpr_write_b32 a187, v215
  v_accvgpr_write_b32 a188, v216
  v_accvgpr_write_b32 a189, v217
  v_accvgpr_write_b32 a190, v218
  v_accvgpr_write_b32 a191, v219
  v_accvgpr_write_b32 a192, v220
  v_accvgpr_write_b32 a193, v221
  v_accvgpr_write_b32 a194, v222
  v_accvgpr_write_b32 a195, v223
  v_accvgpr_write_b32 a196, v224
  v_accvgpr_write_b32 a197, v225
  v_accvgpr_write_b32 a198, v226
  v_accvgpr_write_b32 a199, v227
  v_mov_b32 v23, v196
  s_waitcnt vmcnt(0)
  s_barrier
  s_cmp_lg_u32 s17, 0
  s_cbranch_scc1 L_nosig1

  v_mov_b32 v0, 0
  v_mov_b32 v1, 1
  s_mov_b64 exec, 1
  buffer_store_dword v1, v0, s[48:51], s101 offen sc1
  s_mov_b64 exec, -1
L_nosig1:
  s_mov_b32 s34, 458752
  s_add_u32 m0, s33, 115200
  s_nop 0
  buffer_load_dwordx4 v8, s[24:27], s34 offen offset:0 lds
  buffer_load_dwordx4 v9, s[24:27], s34 offen offset:1024 lds
  buffer_load_dwordx4 v10, s[24:27], s34 offen offset:2048 lds
  buffer_load_dwordx4 v11, s[24:27], s34 offen offset:3072 lds
  s_add_u32 m0, s33, 119296
  s_nop 0
  buffer_load_dwordx4 v12, s[24:27], s34 offen offset:0 lds
  buffer_load_dwordx4 v13, s[24:27], s34 offen offset:1024 lds
  buffer_load_dwordx4 v14, s[24:27], s34 offen offset:2048 lds
  s_mov_b32 s34, 917504
  s_add_u32 m0, s33, 0
  s_nop 0
  buffer_load_dwordx4 v8, s[24:27], s34 offen offset:0 lds
  buffer_load_dwordx4 v9, s[24:27], s34 offen offset:1024 lds
  buffer_load_dwordx4 v10, s[24:27], s34 offen offset:2048 lds
  buffer_load_dwordx4 v11, s[24:27], s34 offen offset:3072 lds
  s_add_u32 m0, s33, 4096
  s_nop 0
  buffer_load_dwordx4 v12, s[24:27], s34 offen offset:0 lds
  buffer_load_dwordx4 v13, s[24:27], s34 offen offset:1024 lds
  buffer_load_dwordx4 v14, s[24:27], s34 offen offset:2048 lds
  s_mov_b32 s44, 0xbdd2d3e8
  s_mov_b32 s45, 0xbdd2d3e8
  v_mov_b32 v30, 0xc0135761
  v_mov_b32 v31, 0xc0135761
  s_mul_i32 s46, s16, 458752
  s_lshr_b32 s47, s19, 3
  s_mul_i32 s47, s47, 114688
  s_add_u32 s46, s46, s47
  s_and_b32 s47, s19, 7
  s_lshl_b32 s47, s47, 11
  s_add_u32 s46, s46, s47
  s_add_u32 s47, s46, 1024

  s_lshr_b32 s69, s2, 6
  s_bitcmp1_b32 s2, 0
  s_cselect_b32 s74, s75, s74
  s_lshr_b32 s75, s2, 5
  s_lshr_b32 s98, s2, 3
  s_getpc_b64 s[12:13]
L_pc2:
  s_lshl_b32 s14, s98, 2
  s_add_u32 s14, s14, s17
  s_lshl_b32 s14, s14, 9
  v_and_b32 v28, 3, v2
  v_lshlrev_b32 v28, 7, v28
  v_add_u32 v28, s14, v28
  v_min_u32 v28, L_code_end - L_pc2 - 4, v28
  v_mov_b32 v29, s13
  v_add_co_u32 v28, vcc, s12, v28
  s_nop 1
  v_addc_co_u32 v29, vcc, 0, v29, vcc

  s_add_u32 s56, s6, 67108864
  s_addc_u32 s57, s7, 0
  s_mov_b32 s58, 16777216
  s_mov_b32 s59, 0x20000
  s_lshl_b32 s99, s2, 2
  s_add_u32 s99, s99, s17
  s_lshl_b32 s99, s99, 14
  v_mov_b32 v24, -1
  v_mov_b32 v25, -1
  v_mov_b32 v26, -1
  v_mov_b32 v27, -1

  v_add_u32 v4, 0, v16
  v_add_u32 v5, 28800, v16
  v_add_u32 v6, 57600, v16
  v_add_u32 v7, 86400, v16
  v_add_u32 v17, 115200, v16
  ds_read_b64_tr_b16 a[0:1], v7 offset:0
  ds_read_b64_tr_b16 a[2:3], v7 offset:3584
  ds_read_b64_tr_b16 a[4:5], v7 offset:14464
  ds_read_b64_tr_b16 a[6:7], v7 offset:18048
  ds_read_b64_tr_b16 a[8:9], v7 offset:32
  ds_read_b64_tr_b16 a[10:11], v7 offset:3616
  ds_read_b64_tr_b16 a[12:13], v7 offset:14496
  ds_read_b64_tr_b16 a[14:15], v7 offset:18080
  ds_read_b64_tr_b16 a[16:17], v7 offset:64
  ds_read_b64_tr_b16 a[18:19], v7 offset:3648
  ds_read_b64_tr_b16 a[20:21], v7 offset:14528
  ds_read_b64_tr_b16 a[22:23], v7 offset:18112
  ds_read_b64_tr_b16 a[24:25], v7 offset:96
  ds_read_b64_tr_b16 a[26:27], v7 offset:3680
  s_mov_b32 s39, 0x8000
L_poll_f1:
  buffer_load_dword v22, v199, s[48:51], 0 offen sc1
  s_waitcnt vmcnt(0)
  v_cmp_gt_u32 vcc, 1, v22
  s_nop 1
  s_cmp_eq_u64 vcc, 0
  s_cbranch_scc1 L_polled_f1
  s_sleep 1
  s_sub_u32 s39, s39, 1
  s_cmp_lg_u32 s39, 0
  s_cbranch_scc1 L_poll_f1

L_polled_f1:
  s_mov_b32 s36, 0
  buffer_load_dwordx4 a[56:59], v15, s[28:31], s36 offen offset:0 sc1
  buffer_load_dwordx4 a[60:63], v15, s[28:31], s36 offen offset:1024 sc1
  buffer_load_dwordx4 a[64:67], v15, s[28:31], s36 offen offset:2048 sc1
  buffer_load_dwordx4 a[68:71], v15, s[28:31], s36 offen offset:3072 sc1
  s_mov_b32 s36, 4096
  buffer_load_dwordx4 a[72:75], v15, s[28:31], s36 offen offset:0 sc1
  buffer_load_dwordx4 a[76:79], v15, s[28:31], s36 offen offset:1024 sc1
  buffer_load_dwordx4 a[80:83], v15, s[28:31], s36 offen offset:2048 sc1
  buffer_load_dwordx4 a[84:87], v15, s[28:31], s36 offen offset:3072 sc1
  s_mov_b32 s36, 8192
  buffer_load_dwordx4 a[88:91], v15, s[28:31], s36 offen offset:0 sc1
  buffer_load_dwordx4 a[92:95], v15, s[28:31], s36 offen offset:1024 sc1
  buffer_load_dwordx4 a[96:99], v15, s[28:31], s36 offen offset:2048 sc1
  buffer_load_dwordx4 a[100:103], v15, s[28:31], s36 offen offset:3072 sc1
  s_waitcnt vmcnt(8) lgkmcnt(10)
  v_mfma_f32_16x16x32_bf16 v[32:35], a[0:3], a[56:59], 0
  ds_read_b64_tr_b16 a[28:29], v7 offset:14560
  v_mfma_f32_16x16x32_bf16 v[36:39], a[0:3], a[60:63], 0
  ds_read_b64_tr_b16 a[30:31], v7 offset:18144
  s_mov_b32 s36, 12288
  v_mfma_f32_16x16x32_bf16 v[40:43], a[0:3], a[64:67], 0
  buffer_load_dwordx4 a[104:107], v15, s[28:31], s36 offen offset:0 sc1
  v_mfma_f32_16x16x32_bf16 v[44:47], a[0:3], a[68:71], 0
  v_mfma_f32_16x16x32_bf16 v[48:51], a[4:7], a[56:59], 0
  ds_read_b64_tr_b16 a[32:33], v7 offset:128
  v_mfma_f32_16x16x32_bf16 v[52:55], a[4:7], a[60:63], 0
  ds_read_b64_tr_b16 a[34:35], v7 offset:3712
  v_mfma_f32_16x16x32_bf16 v[56:59], a[4:7], a[64:67], 0
  buffer_load_dwordx4 a[108:111], v15, s[28:31], s36 offen offset:1024 sc1
  v_mfma_f32_16x16x32_bf16 v[60:63], a[4:7], a[68:71], 0
  s_waitcnt lgkmcnt(10)
  v_mfma_f32_16x16x32_bf16 v[64:67], a[8:11], a[56:59], 0
  ds_read_b64_tr_b16 a[36:37], v7 offset:14592
  v_mfma_f32_16x16x32_bf16 v[68:71], a[8:11], a[60:63], 0
  ds_read_b64_tr_b16 a[38:39], v7 offset:18176
  v_mfma_f32_16x16x32_bf16 v[72:75], a[8:11], a[64:67], 0
  buffer_load_dwordx4 a[112:115], v15, s[28:31], s36 offen offset:2048 sc1
  v_mfma_f32_16x16x32_bf16 v[76:79], a[8:11], a[68:71], 0
  v_mfma_f32_16x16x32_bf16 v[80:83], a[12:15], a[56:59], 0
  ds_read_b64_tr_b16 a[40:41], v7 offset:160
  v_mfma_f32_16x16x32_bf16 v[84:87], a[12:15], a[60:63], 0
  ds_read_b64_tr_b16 a[42:43], v7 offset:3744
  v_mfma_f32_16x16x32_bf16 v[88:91], a[12:15], a[64:67], 0
  buffer_load_dwordx4 a[116:119], v15, s[28:31], s36 offen offset:3072 sc1
  v_mfma_f32_16x16x32_bf16 v[92:95], a[12:15], a[68:71], 0
  s_mov_b32 s34, 1376256
  s_add_u32 m0, s33, 28800
  s_waitcnt lgkmcnt(10)
  v_mfma_f32_16x16x32_bf16 v[96:99], a[16:19], a[56:59], 0
  ds_read_b64_tr_b16 a[44:45], v7 offset:14624
  v_mfma_f32_16x16x32_bf16 v[100:103], a[16:19], a[60:63], 0
  ds_read_b64_tr_b16 a[46:47], v7 offset:18208
  v_mfma_f32_16x16x32_bf16 v[104:107], a[16:19], a[64:67], 0
  buffer_load_dwordx4 v8, s[24:27], s34 offen offset:0 lds
  v_mfma_f32_16x16x32_bf16 v[108:111], a[16:19], a[68:71], 0
  v_mfma_f32_16x16x32_bf16 v[112:115], a[20:23], a[56:59], 0
  ds_read_b64_tr_b16 a[48:49], v7 offset:192
  v_mfma_f32_16x16x32_bf16 v[116:119], a[20:23], a[60:63], 0
  ds_read_b64_tr_b16 a[50:51], v7 offset:3776
  v_mfma_f32_16x16x32_bf16 v[120:123], a[20:23], a[64:67], 0
  global_load_dword v20, v[28:29], off
  v_mfma_f32_16x16x32_bf16 v[124:127], a[20:23], a[68:71], 0
  s_waitcnt lgkmcnt(10)
  v_mfma_f32_16x16x32_bf16 v[128:131], a[24:27], a[56:59], 0
  ds_read_b64_tr_b16 a[52:53], v7 offset:14656
  v_mfma_f32_16x16x32_bf16 v[132:135], a[24:27], a[60:63], 0
  ds_read_b64_tr_b16 a[54:55], v7 offset:18240
  v_mfma_f32_16x16x32_bf16 v[136:139], a[24:27], a[64:67], 0
  v_mfma_f32_16x16x32_bf16 v[140:143], a[24:27], a[68:71], 0
  v_mfma_f32_16x16x32_bf16 v[144:147], a[28:31], a[56:59], 0
  ds_read_b64_tr_b16 a[0:1], v7 offset:7168
  v_mfma_f32_16x16x32_bf16 v[148:151], a[28:31], a[60:63], 0
  ds_read_b64_tr_b16 a[2:3], v7 offset:10752
  v_mfma_f32_16x16x32_bf16 v[152:155], a[28:31], a[64:67], 0
  buffer_load_dwordx4 v9, s[24:27], s34 offen offset:1024 lds
  v_mfma_f32_16x16x32_bf16 v[156:159], a[28:31], a[68:71], 0
  s_mov_b32 s36, 16384
  s_waitcnt lgkmcnt(10)
  v_mfma_f32_16x16x32_bf16 v[160:163], a[32:35], a[56:59], 0
  ds_read_b64_tr_b16 a[4:5], v7 offset:21632
  v_mfma_f32_16x16x32_bf16 v[164:167], a[32:35], a[60:63], 0
  ds_read_b64_tr_b16 a[6:7], v7 offset:25216
  v_mfma_f32_16x16x32_bf16 v[168:171], a[32:35], a[64:67], 0
  buffer_load_dwordx4 a[120:123], v15, s[28:31], s36 offen offset:0 sc1
  v_mfma_f32_16x16x32_bf16 v[172:175], a[32:35], a[68:71], 0
  v_mfma_f32_16x16x32_bf16 v[176:179], a[36:39], a[56:59], 0
  ds_read_b64_tr_b16 a[8:9], v7 offset:7200
  v_mfma_f32_16x16x32_bf16 v[180:183], a[36:39], a[60:63], 0
  ds_read_b64_tr_b16 a[10:11], v7 offset:10784
  v_mfma_f32_16x16x32_bf16 v[184:187], a[36:39], a[64:67], 0
  buffer_load_dwordx4 v10, s[24:27], s34 offen offset:2048 lds
  v_mfma_f32_16x16x32_bf16 v[188:191], a[36:39], a[68:71], 0
  s_waitcnt lgkmcnt(10)
  v_mfma_f32_16x16x32_bf16 v[192:195], a[40:43], a[56:59], 0
  ds_read_b64_tr_b16 a[12:13], v7 offset:21664
  v_mfma_f32_16x16x32_bf16 v[196:199], a[40:43], a[60:63], 0
  ds_read_b64_tr_b16 a[14:15], v7 offset:25248
  v_mfma_f32_16x16x32_bf16 v[200:203], a[40:43], a[64:67], 0
  buffer_load_dwordx4 a[124:127], v15, s[28:31], s36 offen offset:1024 sc1
  v_mfma_f32_16x16x32_bf16 v[204:207], a[40:43], a[68:71], 0
  v_mfma_f32_16x16x32_bf16 v[208:211], a[44:47], a[56:59], 0
  ds_read_b64_tr_b16 a[16:17], v7 offset:7232
  v_mfma_f32_16x16x32_bf16 v[212:215], a[44:47], a[60:63], 0
  ds_read_b64_tr_b16 a[18:19], v7 offset:10816
  v_mfma_f32_16x16x32_bf16 v[216:219], a[44:47], a[64:67], 0
  buffer_load_dwordx4 a[128:131], v15, s[28:31], s36 offen offset:2048 sc1
  v_mfma_f32_16x16x32_bf16 v[220:223], a[44:47], a[68:71], 0
  s_cmp_eq_u32 s69, 0
  s_cselect_b32 s39, s68, 1073741824
  s_waitcnt lgkmcnt(10)
  v_mfma_f32_16x16x32_bf16 v[224:227], a[48:51], a[56:59], 0
  ds_read_b64_tr_b16 a[20:21], v7 offset:21696
  v_mfma_f32_16x16x32_bf16 v[228:231], a[48:51], a[60:63], 0
  ds_read_b64_tr_b16 a[22:23], v7 offset:25280
  v_mfma_f32_16x16x32_bf16 v[232:235], a[48:51], a[64:67], 0
  buffer_load_dword v20, v18, s[24:27], s39 offen
  v_mfma_f32_16x16x32_bf16 v[236:239], a[48:51], a[68:71], 0
  v_mfma_f32_16x16x32_bf16 v[240:243], a[52:55], a[56:59], 0
  ds_read_b64_tr_b16 a[24:25], v7 offset:7264
  v_mfma_f32_16x16x32_bf16 v[244:247], a[52:55], a[60:63], 0
  ds_read_b64_tr_b16 a[26:27], v7 offset:10848
  v_mfma_f32_16x16x32_bf16 v[248:251], a[52:55], a[64:67], 0
  v_mfma_f32_16x16x32_bf16 v[252:255], a[52:55], a[68:71], 0
  s_waitcnt vmcnt(16) lgkmcnt(10)
  v_mfma_f32_16x16x32_bf16 v[32:35], a[0:3], a[72:75], v[32:35]
  ds_read_b64_tr_b16 a[28:29], v7 offset:21728
  v_mfma_f32_16x16x32_bf16 v[36:39], a[0:3], a[76:79], v[36:39]
  ds_read_b64_tr_b16 a[30:31], v7 offset:25312
  v_mfma_f32_16x16x32_bf16 v[40:43], a[0:3], a[80:83], v[40:43]
  buffer_load_dwordx4 v11, s[24:27], s34 offen offset:3072 lds
  v_mfma_f32_16x16x32_bf16 v[44:47], a[0:3], a[84:87], v[44:47]
  v_mfma_f32_16x16x32_bf16 v[48:51], a[4:7], a[72:75], v[48:51]
  ds_read_b64_tr_b16 a[32:33], v7 offset:7296
  v_mfma_f32_16x16x32_bf16 v[52:55], a[4:7], a[76:79], v[52:55]
  ds_read_b64_tr_b16 a[34:35], v7 offset:10880
  v_mfma_f32_16x16x32_bf16 v[56:59], a[4:7], a[80:83], v[56:59]
  buffer_load_dwordx4 a[132:135], v15, s[28:31], s36 offen offset:3072 sc1
  v_mfma_f32_16x16x32_bf16 v[60:63], a[4:7], a[84:87], v[60:63]
  s_add_u32 m0, s33, 32896
  s_waitcnt lgkmcnt(10)
  v_mfma_f32_16x16x32_bf16 v[64:67], a[8:11], a[72:75], v[64:67]
  ds_read_b64_tr_b16 a[36:37], v7 offset:21760
  v_mfma_f32_16x16x32_bf16 v[68:71], a[8:11], a[76:79], v[68:71]
  ds_read_b64_tr_b16 a[38:39], v7 offset:25344
  v_mfma_f32_16x16x32_bf16 v[72:75], a[8:11], a[80:83], v[72:75]
  buffer_load_dwordx4 v12, s[24:27], s34 offen offset:0 lds
  v_mfma_f32_16x16x32_bf16 v[76:79], a[8:11], a[84:87], v[76:79]
  v_mfma_f32_16x16x32_bf16 v[80:83], a[12:15], a[72:75], v[80:83]
  ds_read_b64_tr_b16 a[40:41], v7 offset:7328
  v_mfma_f32_16x16x32_bf16 v[84:87], a[12:15], a[76:79], v[84:87]
  ds_read_b64_tr_b16 a[42:43], v7 offset:10912
  v_mfma_f32_16x16x32_bf16 v[88:91], a[12:15], a[80:83], v[88:91]
  buffer_load_dwordx4 v13, s[24:27], s34 offen offset:1024 lds
  v_mfma_f32_16x16x32_bf16 v[92:95], a[12:15], a[84:87], v[92:95]
  s_mov_b32 s36, 20480
  s_waitcnt lgkmcnt(10)
  v_mfma_f32_16x16x32_bf16 v[96:99], a[16:19], a[72:75], v[96:99]
  ds_read_b64_tr_b16 a[44:45], v7 offset:21792
  v_mfma_f32_16x16x32_bf16 v[100:103], a[16:19], a[76:79], v[100:103]
  ds_read_b64_tr_b16 a[46:47], v7 offset:25376
  v_mfma_f32_16x16x32_bf16 v[104:107], a[16:19], a[80:83], v[104:107]
  buffer_load_dwordx4 a[136:139], v15, s[28:31], s36 offen offset:0 sc1
  v_mfma_f32_16x16x32_bf16 v[108:111], a[16:19], a[84:87], v[108:111]
  v_mfma_f32_16x16x32_bf16 v[112:115], a[20:23], a[72:75], v[112:115]
  ds_read_b64_tr_b16 a[48:49], v7 offset:7360
  v_mfma_f32_16x16x32_bf16 v[116:119], a[20:23], a[76:79], v[116:119]
  ds_read_b64_tr_b16 a[50:51], v7 offset:10944
  v_mfma_f32_16x16x32_bf16 v[120:123], a[20:23], a[80:83], v[120:123]
  v_mfma_f32_16x16x32_bf16 v[124:127], a[20:23], a[84:87], v[124:127]
  s_waitcnt lgkmcnt(10)
  v_mfma_f32_16x16x32_bf16 v[128:131], a[24:27], a[72:75], v[128:131]
  ds_read_b64_tr_b16 a[52:53], v7 offset:21824
  v_mfma_f32_16x16x32_bf16 v[132:135], a[24:27], a[76:79], v[132:135]
  ds_read_b64_tr_b16 a[54:55], v7 offset:25408
  v_mfma_f32_16x16x32_bf16 v[136:139], a[24:27], a[80:83], v[136:139]
  v_mfma_f32_16x16x32_bf16 v[140:143], a[24:27], a[84:87], v[140:143]
  s_waitcnt vmcnt(36) lgkmcnt(0)
  s_barrier
  v_mfma_f32_16x16x32_bf16 v[144:147], a[28:31], a[72:75], v[144:147]
  ds_read_b64_tr_b16 a[0:1], v17 offset:0
  v_mfma_f32_16x16x32_bf16 v[148:151], a[28:31], a[76:79], v[148:151]
  ds_read_b64_tr_b16 a[2:3], v17 offset:3584
  v_mfma_f32_16x16x32_bf16 v[152:155], a[28:31], a[80:83], v[152:155]
  buffer_load_dwordx4 a[140:143], v15, s[28:31], s36 offen offset:1024 sc1
  v_mfma_f32_16x16x32_bf16 v[156:159], a[28:31], a[84:87], v[156:159]
  s_waitcnt lgkmcnt(10)
  v_mfma_f32_16x16x32_bf16 v[160:163], a[32:35], a[72:75], v[160:163]
  ds_read_b64_tr_b16 a[4:5], v17 offset:14464
  v_mfma_f32_16x16x32_bf16 v[164:167], a[32:35], a[76:79], v[164:167]
  ds_read_b64_tr_b16 a[6:7], v17 offset:18048
  v_mfma_f32_16x16x32_bf16 v[168:171], a[32:35], a[80:83], v[168:171]
  buffer_load_dwordx4 v14, s[24:27], s34 offen offset:2048 lds
  v_mfma_f32_16x16x32_bf16 v[172:175], a[32:35], a[84:87], v[172:175]
  v_mfma_f32_16x16x32_bf16 v[176:179], a[36:39], a[72:75], v[176:179]
  ds_read_b64_tr_b16 a[8:9], v17 offset:32
  v_mfma_f32_16x16x32_bf16 v[180:183], a[36:39], a[76:79], v[180:183]
  ds_read_b64_tr_b16 a[10:11], v17 offset:3616
  v_mfma_f32_16x16x32_bf16 v[184:187], a[36:39], a[80:83], v[184:187]
  buffer_load_dwordx4 a[144:147], v15, s[28:31], s36 offen offset:2048 sc1
  v_mfma_f32_16x16x32_bf16 v[188:191], a[36:39], a[84:87], v[188:191]
  s_waitcnt lgkmcnt(10)
  v_mfma_f32_16x16x32_bf16 v[192:195], a[40:43], a[72:75], v[192:195]
  ds_read_b64_tr_b16 a[12:13], v17 offset:14496
  v_mfma_f32_16x16x32_bf16 v[196:199], a[40:43], a[76:79], v[196:199]
  ds_read_b64_tr_b16 a[14:15], v17 offset:18080
  v_mfma_f32_16x16x32_bf16 v[200:203], a[40:43], a[80:83], v[200:203]
  buffer_load_dwordx4 a[148:151], v15, s[28:31], s36 offen offset:3072 sc1
  v_mfma_f32_16x16x32_bf16 v[204:207], a[40:43], a[84:87], v[204:207]
  s_mov_b32 s34, 1835008
  s_add_u32 m0, s33, 57600
  v_mfma_f32_16x16x32_bf16 v[208:211], a[44:47], a[72:75], v[208:211]
  ds_read_b64_tr_b16 a[16:17], v17 offset:64
  v_mfma_f32_16x16x32_bf16 v[212:215], a[44:47], a[76:79], v[212:215]
  ds_read_b64_tr_b16 a[18:19], v17 offset:3648
  v_mfma_f32_16x16x32_bf16 v[216:219], a[44:47], a[80:83], v[216:219]
  buffer_load_dwordx4 v8, s[24:27], s34 offen offset:0 lds
  v_mfma_f32_16x16x32_bf16 v[220:223], a[44:47], a[84:87], v[220:223]
  s_waitcnt lgkmcnt(10)
  v_mfma_f32_16x16x32_bf16 v[224:227], a[48:51], a[72:75], v[224:227]
  ds_read_b64_tr_b16 a[20:21], v17 offset:14528
  v_mfma_f32_16x16x32_bf16 v[228:231], a[48:51], a[76:79], v[228:231]
  ds_read_b64_tr_b16 a[22:23], v17 offset:18112
  v_mfma_f32_16x16x32_bf16 v[232:235], a[48:51], a[80:83], v[232:235]
  v_mfma_f32_16x16x32_bf16 v[236:239], a[48:51], a[84:87], v[236:239]
  v_mfma_f32_16x16x32_bf16 v[240:243], a[52:55], a[72:75], v[240:243]
  ds_read_b64_tr_b16 a[24:25], v17 offset:96
  v_mfma_f32_16x16x32_bf16 v[244:247], a[52:55], a[76:79], v[244:247]
  ds_read_b64_tr_b16 a[26:27], v17 offset:3680
  v_mfma_f32_16x16x32_bf16 v[248:251], a[52:55], a[80:83], v[248:251]
  v_mfma_f32_16x16x32_bf16 v[252:255], a[52:55], a[84:87], v[252:255]
  s_waitcnt vmcnt(22) lgkmcnt(10)
  v_mfma_f32_16x16x32_bf16 v[32:35], a[0:3], a[88:91], v[32:35]
  ds_read_b64_tr_b16 a[28:29], v17 offset:14560
  v_mfma_f32_16x16x32_bf16 v[36:39], a[0:3], a[92:95], v[36:39]
  ds_read_b64_tr_b16 a[30:31], v17 offset:18144
  v_mfma_f32_16x16x32_bf16 v[40:43], a[0:3], a[96:99], v[40:43]
  buffer_load_dwordx4 v9, s[24:27], s34 offen offset:1024 lds
  v_mfma_f32_16x16x32_bf16 v[44:47], a[0:3], a[100:103], v[44:47]
  s_mov_b32 s36, 24576
  v_mfma_f32_16x16x32_bf16 v[48:51], a[4:7], a[88:91], v[48:51]
  ds_read_b64_tr_b16 a[32:33], v17 offset:128
  v_mfma_f32_16x16x32_bf16 v[52:55], a[4:7], a[92:95], v[52:55]
  ds_read_b64_tr_b16 a[34:35], v17 offset:3712
  v_mfma_f32_16x16x32_bf16 v[56:59], a[4:7], a[96:99], v[56:59]
  buffer_load_dwordx4 a[152:155], v15, s[28:31], s36 offen offset:0 sc1
  v_mfma_f32_16x16x32_bf16 v[60:63], a[4:7], a[100:103], v[60:63]
  s_waitcnt lgkmcnt(10)
  v_mfma_f32_16x16x32_bf16 v[64:67], a[8:11], a[88:91], v[64:67]
  ds_read_b64_tr_b16 a[36:37], v17 offset:14592
  v_mfma_f32_16x16x32_bf16 v[68:71], a[8:11], a[92:95], v[68:71]
  ds_read_b64_tr_b16 a[38:39], v17 offset:18176
  v_mfma_f32_16x16x32_bf16 v[72:75], a[8:11], a[96:99], v[72:75]
  buffer_load_dwordx4 v10, s[24:27], s34 offen offset:2048 lds
  v_mfma_f32_16x16x32_bf16 v[76:79], a[8:11], a[100:103], v[76:79]
  v_mfma_f32_16x16x32_bf16 v[80:83], a[12:15], a[88:91], v[80:83]
  ds_read_b64_tr_b16 a[40:41], v17 offset:160
  v_mfma_f32_16x16x32_bf16 v[84:87], a[12:15], a[92:95], v[84:87]
  ds_read_b64_tr_b16 a[42:43], v17 offset:3744
  v_mfma_f32_16x16x32_bf16 v[88:91], a[12:15], a[96:99], v[88:91]
  buffer_load_dwordx4 a[156:159], v15, s[28:31], s36 offen offset:1024 sc1
  v_mfma_f32_16x16x32_bf16 v[92:95], a[12:15], a[100:103], v[92:95]
  s_waitcnt lgkmcnt(10)
  v_mfma_f32_16x16x32_bf16 v[96:99], a[16:19], a[88:91], v[96:99]
  ds_read_b64_tr_b16 a[44:45], v17 offset:14624
  v_mfma_f32_16x16x32_bf16 v[100:103], a[16:19], a[92:95], v[100:103]
  ds_read_b64_tr_b16 a[46:47], v17 offset:18208
  v_mfma_f32_16x16x32_bf16 v[104:107], a[16:19], a[96:99], v[104:107]
  buffer_load_dwordx4 a[160:163], v15, s[28:31], s36 offen offset:2048 sc1
  v_mfma_f32_16x16x32_bf16 v[108:111], a[16:19], a[100:103], v[108:111]
  v_mfma_f32_16x16x32_bf16 v[112:115], a[20:23], a[88:91], v[112:115]
  ds_read_b64_tr_b16 a[48:49], v17 offset:192
  v_mfma_f32_16x16x32_bf16 v[116:119], a[20:23], a[92:95], v[116:119]
  ds_read_b64_tr_b16 a[50:51], v17 offset:3776
  v_mfma_f32_16x16x32_bf16 v[120:123], a[20:23], a[96:99], v[120:123]
  v_mfma_f32_16x16x32_bf16 v[124:127], a[20:23], a[100:103], v[124:127]
  s_waitcnt lgkmcnt(10)
  v_mfma_f32_16x16x32_bf16 v[128:131], a[24:27], a[88:91], v[128:131]
  ds_read_b64_tr_b16 a[52:53], v17 offset:14656
  v_mfma_f32_16x16x32_bf16 v[132:135], a[24:27], a[92:95], v[132:135]
  ds_read_b64_tr_b16 a[54:55], v17 offset:18240
  v_mfma_f32_16x16x32_bf16 v[136:139], a[24:27], a[96:99], v[136:139]
  v_mfma_f32_16x16x32_bf16 v[140:143], a[24:27], a[100:103], v[140:143]
  v_mfma_f32_16x16x32_bf16 v[144:147], a[28:31], a[88:91], v[144:147]
  ds_read_b64_tr_b16 a[0:1], v17 offset:7168
  v_mfma_f32_16x16x32_bf16 v[148:151], a[28:31], a[92:95], v[148:151]
  ds_read_b64_tr_b16 a[2:3], v17 offset:10752
  v_mfma_f32_16x16x32_bf16 v[152:155], a[28:31], a[96:99], v[152:155]
  buffer_load_dwordx4 v11, s[24:27], s34 offen offset:3072 lds
  v_mfma_f32_16x16x32_bf16 v[156:159], a[28:31], a[100:103], v[156:159]
  s_waitcnt lgkmcnt(10)
  v_mfma_f32_16x16x32_bf16 v[160:163], a[32:35], a[88:91], v[160:163]
  ds_read_b64_tr_b16 a[4:5], v17 offset:21632
  v_mfma_f32_16x16x32_bf16 v[164:167], a[32:35], a[92:95], v[164:167]
  ds_read_b64_tr_b16 a[6:7], v17 offset:25216
  v_mfma_f32_16x16x32_bf16 v[168:171], a[32:35], a[96:99], v[168:171]
  buffer_load_dwordx4 a[164:167], v15, s[28:31], s36 offen offset:3072 sc1
  v_mfma_f32_16x16x32_bf16 v[172:175], a[32:35], a[100:103], v[172:175]
  s_add_u32 m0, s33, 61696
  v_mfma_f32_16x16x32_bf16 v[176:179], a[36:39], a[88:91], v[176:179]
  ds_read_b64_tr_b16 a[8:9], v17 offset:7200
  v_mfma_f32_16x16x32_bf16 v[180:183], a[36:39], a[92:95], v[180:183]
  ds_read_b64_tr_b16 a[10:11], v17 offset:10784
  v_mfma_f32_16x16x32_bf16 v[184:187], a[36:39], a[96:99], v[184:187]
  buffer_load_dwordx4 v12, s[24:27], s34 offen offset:0 lds
  v_mfma_f32_16x16x32_bf16 v[188:191], a[36:39], a[100:103], v[188:191]
  s_waitcnt lgkmcnt(10)
  v_mfma_f32_16x16x32_bf16 v[192:195], a[40:43], a[88:91], v[192:195]
  ds_read_b64_tr_b16 a[12:13], v17 offset:21664
  v_mfma_f32_16x16x32_bf16 v[196:199], a[40:43], a[92:95], v[196:199]
  ds_read_b64_tr_b16 a[14:15], v17 offset:25248
  v_mfma_f32_16x16x32_bf16 v[200:203], a[40:43], a[96:99], v[200:203]
  buffer_load_dwordx4 v13, s[24:27], s34 offen offset:1024 lds
  v_mfma_f32_16x16x32_bf16 v[204:207], a[40:43], a[100:103], v[204:207]
  s_mov_b32 s36, 28672
  v_mfma_f32_16x16x32_bf16 v[208:211], a[44:47], a[88:91], v[208:211]
  ds_read_b64_tr_b16 a[16:17], v17 offset:7232
  v_mfma_f32_16x16x32_bf16 v[212:215], a[44:47], a[92:95], v[212:215]
  ds_read_b64_tr_b16 a[18:19], v17 offset:10816
  v_mfma_f32_16x16x32_bf16 v[216:219], a[44:47], a[96:99], v[216:219]
  buffer_load_dwordx4 a[168:171], v15, s[28:31], s36 offen offset:0 sc1
  v_mfma_f32_16x16x32_bf16 v[220:223], a[44:47], a[100:103], v[220:223]
  s_cmp_eq_u32 s69, 1
  s_cselect_b32 s39, s68, 1073741824
  s_waitcnt lgkmcnt(10)
  v_mfma_f32_16x16x32_bf16 v[224:227], a[48:51], a[88:91], v[224:227]
  ds_read_b64_tr_b16 a[20:21], v17 offset:21696
  v_mfma_f32_16x16x32_bf16 v[228:231], a[48:51], a[92:95], v[228:231]
  ds_read_b64_tr_b16 a[22:23], v17 offset:25280
  v_mfma_f32_16x16x32_bf16 v[232:235], a[48:51], a[96:99], v[232:235]
  buffer_load_dword v20, v18, s[24:27], s39 offen
  v_mfma_f32_16x16x32_bf16 v[236:239], a[48:51], a[100:103], v[236:239]
  v_mfma_f32_16x16x32_bf16 v[240:243], a[52:55], a[88:91], v[240:243]
  ds_read_b64_tr_b16 a[24:25], v17 offset:7264
  v_mfma_f32_16x16x32_bf16 v[244:247], a[52:55], a[92:95], v[244:247]
  ds_read_b64_tr_b16 a[26:27], v17 offset:10848
  v_mfma_f32_16x16x32_bf16 v[248:251], a[52:55], a[96:99], v[248:251]
  v_mfma_f32_16x16x32_bf16 v[252:255], a[52:55], a[100:103], v[252:255]
  s_waitcnt vmcnt(29) lgkmcnt(10)
  v_mfma_f32_16x16x32_bf16 v[32:35], a[0:3], a[104:107], v[32:35]
  ds_read_b64_tr_b16 a[28:29], v17 offset:21728
  v_mfma_f32_16x16x32_bf16 v[36:39], a[0:3], a[108:111], v[36:39]
  ds_read_b64_tr_b16 a[30:31], v17 offset:25312
  v_mfma_f32_16x16x32_bf16 v[40:43], a[0:3], a[112:115], v[40:43]
  buffer_load_dwordx4 a[172:175], v15, s[28:31], s36 offen offset:1024 sc1
  v_mfma_f32_16x16x32_bf16 v[44:47], a[0:3], a[116:119], v[44:47]
  v_mfma_f32_16x16x32_bf16 v[48:51], a[4:7], a[104:107], v[48:51]
  ds_read_b64_tr_b16 a[32:33], v17 offset:7296
  v_mfma_f32_16x16x32_bf16 v[52:55], a[4:7], a[108:111], v[52:55]
  ds_read_b64_tr_b16 a[34:35], v17 offset:10880
  v_mfma_f32_16x16x32_bf16 v[56:59], a[4:7], a[112:115], v[56:59]
  buffer_load_dwordx4 v14, s[24:27], s34 offen offset:2048 lds
  v_mfma_f32_16x16x32_bf16 v[60:63], a[4:7], a[116:119], v[60:63]
  s_waitcnt lgkmcnt(10)
  v_mfma_f32_16x16x32_bf16 v[64:67], a[8:11], a[104:107], v[64:67]
  ds_read_b64_tr_b16 a[36:37], v17 offset:21760
  v_mfma_f32_16x16x32_bf16 v[68:71], a[8:11], a[108:111], v[68:71]
  ds_read_b64_tr_b16 a[38:39], v17 offset:25344
  v_mfma_f32_16x16x32_bf16 v[72:75], a[8:11], a[112:115], v[72:75]
  buffer_load_dwordx4 a[176:179], v15, s[28:31], s36 offen offset:2048 sc1
  v_mfma_f32_16x16x32_bf16 v[76:79], a[8:11], a[116:119], v[76:79]
  v_mfma_f32_16x16x32_bf16 v[80:83], a[12:15], a[104:107], v[80:83]
  ds_read_b64_tr_b16 a[40:41], v17 offset:7328
  v_mfma_f32_16x16x32_bf16 v[84:87], a[12:15], a[108:111], v[84:87]
  ds_read_b64_tr_b16 a[42:43], v17 offset:10912
  v_mfma_f32_16x16x32_bf16 v[88:91], a[12:15], a[112:115], v[88:91]
  buffer_load_dwordx4 a[180:183], v15, s[28:31], s36 offen offset:3072 sc1
  v_mfma_f32_16x16x32_bf16 v[92:95], a[12:15], a[116:119], v[92:95]
  s_mov_b32 s34, 2293760
  s_add_u32 m0, s33, 86400
  s_waitcnt lgkmcnt(10)
  v_mfma_f32_16x16x32_bf16 v[96:99], a[16:19], a[104:107], v[96:99]
  ds_read_b64_tr_b16 a[44:45], v17 offset:21792
  v_mfma_f32_16x16x32_bf16 v[100:103], a[16:19], a[108:111], v[100:103]
  ds_read_b64_tr_b16 a[46:47], v17 offset:25376
  v_mfma_f32_16x16x32_bf16 v[104:107], a[16:19], a[112:115], v[104:107]
  buffer_load_dwordx4 v8, s[24:27], s34 offen offset:0 lds
  v_mfma_f32_16x16x32_bf16 v[108:111], a[16:19], a[116:119], v[108:111]
  v_mfma_f32_16x16x32_bf16 v[112:115], a[20:23], a[104:107], v[112:115]
  ds_read_b64_tr_b16 a[48:49], v17 offset:7360
  v_mfma_f32_16x16x32_bf16 v[116:119], a[20:23], a[108:111], v[116:119]
  ds_read_b64_tr_b16 a[50:51], v17 offset:10944
  v_mfma_f32_16x16x32_bf16 v[120:123], a[20:23], a[112:115], v[120:123]
  v_mfma_f32_16x16x32_bf16 v[124:127], a[20:23], a[116:119], v[124:127]
  s_waitcnt lgkmcnt(10)
  v_mfma_f32_16x16x32_bf16 v[128:131], a[24:27], a[104:107], v[128:131]
  ds_read_b64_tr_b16 a[52:53], v17 offset:21824
  v_mfma_f32_16x16x32_bf16 v[132:135], a[24:27], a[108:111], v[132:135]
  ds_read_b64_tr_b16 a[54:55], v17 offset:25408
  v_mfma_f32_16x16x32_bf16 v[136:139], a[24:27], a[112:115], v[136:139]
  v_mfma_f32_16x16x32_bf16 v[140:143], a[24:27], a[116:119], v[140:143]
  s_waitcnt vmcnt(50) lgkmcnt(0)
  s_barrier
  v_mfma_f32_16x16x32_bf16 v[144:147], a[28:31], a[104:107], v[144:147]
  ds_read_b64_tr_b16 a[0:1], v4 offset:0
  v_mfma_f32_16x16x32_bf16 v[148:151], a[28:31], a[108:111], v[148:151]
  ds_read_b64_tr_b16 a[2:3], v4 offset:3584
  v_mfma_f32_16x16x32_bf16 v[152:155], a[28:31], a[112:115], v[152:155]
  buffer_load_dwordx4 v9, s[24:27], s34 offen offset:1024 lds
  v_mfma_f32_16x16x32_bf16 v[156:159], a[28:31], a[116:119], v[156:159]
  s_mov_b32 s36, 32768
  s_waitcnt lgkmcnt(10)
  v_mfma_f32_16x16x32_bf16 v[160:163], a[32:35], a[104:107], v[160:163]
  ds_read_b64_tr_b16 a[4:5], v4 offset:14464
  v_mfma_f32_16x16x32_bf16 v[164:167], a[32:35], a[108:111], v[164:167]
  ds_read_b64_tr_b16 a[6:7], v4 offset:18048
  v_mfma_f32_16x16x32_bf16 v[168:171], a[32:35], a[112:115], v[168:171]
  buffer_load_dwordx4 a[56:59], v15, s[28:31], s36 offen offset:0 sc1
  v_mfma_f32_16x16x32_bf16 v[172:175], a[32:35], a[116:119], v[172:175]
  v_mfma_f32_16x16x32_bf16 v[176:179], a[36:39], a[104:107], v[176:179]
  ds_read_b64_tr_b16 a[8:9], v4 offset:32
  v_mfma_f32_16x16x32_bf16 v[180:183], a[36:39], a[108:111], v[180:183]
  ds_read_b64_tr_b16 a[10:11], v4 offset:3616
  v_mfma_f32_16x16x32_bf16 v[184:187], a[36:39], a[112:115], v[184:187]
  buffer_load_dwordx4 v10, s[24:27], s34 offen offset:2048 lds
  v_mfma_f32_16x16x32_bf16 v[188:191], a[36:39], a[116:119], v[188:191]
  s_waitcnt lgkmcnt(10)
  v_mfma_f32_16x16x32_bf16 v[192:195], a[40:43], a[104:107], v[192:195]
  ds_read_b64_tr_b16 a[12:13], v4 offset:14496
  v_mfma_f32_16x16x32_bf16 v[196:199], a[40:43], a[108:111], v[196:199]
  ds_read_b64_tr_b16 a[14:15], v4 offset:18080
  v_mfma_f32_16x16x32_bf16 v[200:203], a[40:43], a[112:115], v[200:203]
  buffer_load_dwordx4 a[60:63], v15, s[28:31], s36 offen offset:1024 sc1
  v_mfma_f32_16x16x32_bf16 v[204:207], a[40:43], a[116:119], v[204:207]
  v_mfma_f32_16x16x32_bf16 v[208:211], a[44:47], a[104:107], v[208:211]
  ds_read_b64_tr_b16 a[16:17], v4 offset:64
  v_mfma_f32_16x16x32_bf16 v[212:215], a[44:47], a[108:111], v[212:215]
  ds_read_b64_tr_b16 a[18:19], v4 offset:3648
  v_mfma_f32_16x16x32_bf16 v[216:219], a[44:47], a[112:115], v[216:219]
  buffer_load_dwordx4 a[64:67], v15, s[28:31], s36 offen offset:2048 sc1
  v_mfma_f32_16x16x32_bf16 v[220:223], a[44:47], a[116:119], v[220:223]
  s_waitcnt lgkmcnt(10)
  v_mfma_f32_16x16x32_bf16 v[224:227], a[48:51], a[104:107], v[224:227]
  ds_read_b64_tr_b16 a[20:21], v4 offset:14528
  v_mfma_f32_16x16x32_bf16 v[228:231], a[48:51], a[108:111], v[228:231]
  ds_read_b64_tr_b16 a[22:23], v4 offset:18112
  v_mfma_f32_16x16x32_bf16 v[232:235], a[48:51], a[112:115], v[232:235]
  v_mfma_f32_16x16x32_bf16 v[236:239], a[48:51], a[116:119], v[236:239]
  v_mfma_f32_16x16x32_bf16 v[240:243], a[52:55], a[104:107], v[240:243]
  ds_read_b64_tr_b16 a[24:25], v4 offset:96
  v_mfma_f32_16x16x32_bf16 v[244:247], a[52:55], a[108:111], v[244:247]
  ds_read_b64_tr_b16 a[26:27], v4 offset:3680
  v_mfma_f32_16x16x32_bf16 v[248:251], a[52:55], a[112:115], v[248:251]
  v_mfma_f32_16x16x32_bf16 v[252:255], a[52:55], a[116:119], v[252:255]
  s_waitcnt vmcnt(29) lgkmcnt(10)
  v_mfma_f32_16x16x32_bf16 v[32:35], a[0:3], a[120:123], v[32:35]
  ds_read_b64_tr_b16 a[28:29], v4 offset:14560
  v_mfma_f32_16x16x32_bf16 v[36:39], a[0:3], a[124:127], v[36:39]
  ds_read_b64_tr_b16 a[30:31], v4 offset:18144
  v_mfma_f32_16x16x32_bf16 v[40:43], a[0:3], a[128:131], v[40:43]
  buffer_load_dwordx4 v11, s[24:27], s34 offen offset:3072 lds
  v_mfma_f32_16x16x32_bf16 v[44:47], a[0:3], a[132:135], v[44:47]
  v_mfma_f32_16x16x32_bf16 v[48:51], a[4:7], a[120:123], v[48:51]
  ds_read_b64_tr_b16 a[32:33], v4 offset:128
  v_mfma_f32_16x16x32_bf16 v[52:55], a[4:7], a[124:127], v[52:55]
  ds_read_b64_tr_b16 a[34:35], v4 offset:3712
  v_mfma_f32_16x16x32_bf16 v[56:59], a[4:7], a[128:131], v[56:59]
  buffer_load_dwordx4 a[68:71], v15, s[28:31], s36 offen offset:3072 sc1
  v_mfma_f32_16x16x32_bf16 v[60:63], a[4:7], a[132:135], v[60:63]
  s_add_u32 m0, s33, 90496
  s_waitcnt lgkmcnt(10)
  v_mfma_f32_16x16x32_bf16 v[64:67], a[8:11], a[120:123], v[64:67]
  ds_read_b64_tr_b16 a[36:37], v4 offset:14592
  v_mfma_f32_16x16x32_bf16 v[68:71], a[8:11], a[124:127], v[68:71]
  ds_read_b64_tr_b16 a[38:39], v4 offset:18176
  v_mfma_f32_16x16x32_bf16 v[72:75], a[8:11], a[128:131], v[72:75]
  buffer_load_dwordx4 v12, s[24:27], s34 offen offset:0 lds
  v_mfma_f32_16x16x32_bf16 v[76:79], a[8:11], a[132:135], v[76:79]
  v_mfma_f32_16x16x32_bf16 v[80:83], a[12:15], a[120:123], v[80:83]
  ds_read_b64_tr_b16 a[40:41], v4 offset:160
  v_mfma_f32_16x16x32_bf16 v[84:87], a[12:15], a[124:127], v[84:87]
  ds_read_b64_tr_b16 a[42:43], v4 offset:3744
  v_mfma_f32_16x16x32_bf16 v[88:91], a[12:15], a[128:131], v[88:91]
  buffer_load_dwordx4 v13, s[24:27], s34 offen offset:1024 lds
  v_mfma_f32_16x16x32_bf16 v[92:95], a[12:15], a[132:135], v[92:95]
  s_mov_b32 s36, 36864
  s_waitcnt lgkmcnt(10)
  v_mfma_f32_16x16x32_bf16 v[96:99], a[16:19], a[120:123], v[96:99]
  ds_read_b64_tr_b16 a[44:45], v4 offset:14624
  v_mfma_f32_16x16x32_bf16 v[100:103], a[16:19], a[124:127], v[100:103]
  ds_read_b64_tr_b16 a[46:47], v4 offset:18208
  v_mfma_f32_16x16x32_bf16 v[104:107], a[16:19], a[128:131], v[104:107]
  buffer_load_dwordx4 a[72:75], v15, s[28:31], s36 offen offset:0 sc1
  v_mfma_f32_16x16x32_bf16 v[108:111], a[16:19], a[132:135], v[108:111]
  v_mfma_f32_16x16x32_bf16 v[112:115], a[20:23], a[120:123], v[112:115]
  ds_read_b64_tr_b16 a[48:49], v4 offset:192
  v_mfma_f32_16x16x32_bf16 v[116:119], a[20:23], a[124:127], v[116:119]
  ds_read_b64_tr_b16 a[50:51], v4 offset:3776
  v_mfma_f32_16x16x32_bf16 v[120:123], a[20:23], a[128:131], v[120:123]
  v_mfma_f32_16x16x32_bf16 v[124:127], a[20:23], a[132:135], v[124:127]
  s_waitcnt lgkmcnt(10)
  v_mfma_f32_16x16x32_bf16 v[128:131], a[24:27], a[120:123], v[128:131]
  ds_read_b64_tr_b16 a[52:53], v4 offset:14656
  v_mfma_f32_16x16x32_bf16 v[132:135], a[24:27], a[124:127], v[132:135]
  ds_read_b64_tr_b16 a[54:55], v4 offset:18240
  v_mfma_f32_16x16x32_bf16 v[136:139], a[24:27], a[128:131], v[136:139]
  v_mfma_f32_16x16x32_bf16 v[140:143], a[24:27], a[132:135], v[140:143]
  v_mfma_f32_16x16x32_bf16 v[144:147], a[28:31], a[120:123], v[144:147]
  ds_read_b64_tr_b16 a[0:1], v4 offset:7168
  v_mfma_f32_16x16x32_bf16 v[148:151], a[28:31], a[124:127], v[148:151]
  ds_read_b64_tr_b16 a[2:3], v4 offset:10752
  v_mfma_f32_16x16x32_bf16 v[152:155], a[28:31], a[128:131], v[152:155]
  buffer_load_dwordx4 a[76:79], v15, s[28:31], s36 offen offset:1024 sc1
  v_mfma_f32_16x16x32_bf16 v[156:159], a[28:31], a[132:135], v[156:159]
  s_waitcnt lgkmcnt(10)
  v_mfma_f32_16x16x32_bf16 v[160:163], a[32:35], a[120:123], v[160:163]
  ds_read_b64_tr_b16 a[4:5], v4 offset:21632
  v_mfma_f32_16x16x32_bf16 v[164:167], a[32:35], a[124:127], v[164:167]
  ds_read_b64_tr_b16 a[6:7], v4 offset:25216
  v_mfma_f32_16x16x32_bf16 v[168:171], a[32:35], a[128:131], v[168:171]
  buffer_load_dwordx4 v14, s[24:27], s34 offen offset:2048 lds
  v_mfma_f32_16x16x32_bf16 v[172:175], a[32:35], a[132:135], v[172:175]
  v_mfma_f32_16x16x32_bf16 v[176:179], a[36:39], a[120:123], v[176:179]
  ds_read_b64_tr_b16 a[8:9], v4 offset:7200
  v_mfma_f32_16x16x32_bf16 v[180:183], a[36:39], a[124:127], v[180:183]
  ds_read_b64_tr_b16 a[10:11], v4 offset:10784
  v_mfma_f32_16x16x32_bf16 v[184:187], a[36:39], a[128:131], v[184:187]
  buffer_load_dwordx4 a[80:83], v15, s[28:31], s36 offen offset:2048 sc1
  v_mfma_f32_16x16x32_bf16 v[188:191], a[36:39], a[132:135], v[188:191]
  s_waitcnt lgkmcnt(10)
  v_mfma_f32_16x16x32_bf16 v[192:195], a[40:43], a[120:123], v[192:195]
  ds_read_b64_tr_b16 a[12:13], v4 offset:21664
  v_mfma_f32_16x16x32_bf16 v[196:199], a[40:43], a[124:127], v[196:199]
  ds_read_b64_tr_b16 a[14:15], v4 offset:25248
  v_mfma_f32_16x16x32_bf16 v[200:203], a[40:43], a[128:131], v[200:203]
  buffer_load_dwordx4 a[84:87], v15, s[28:31], s36 offen offset:3072 sc1
  v_mfma_f32_16x16x32_bf16 v[204:207], a[40:43], a[132:135], v[204:207]
  s_mov_b32 s34, 2752512
  s_add_u32 m0, s33, 115200
  v_mfma_f32_16x16x32_bf16 v[208:211], a[44:47], a[120:123], v[208:211]
  ds_read_b64_tr_b16 a[16:17], v4 offset:7232
  v_mfma_f32_16x16x32_bf16 v[212:215], a[44:47], a[124:127], v[212:215]
  ds_read_b64_tr_b16 a[18:19], v4 offset:10816
  v_mfma_f32_16x16x32_bf16 v[216:219], a[44:47], a[128:131], v[216:219]
  buffer_load_dwordx4 v8, s[24:27], s34 offen offset:0 lds
  v_mfma_f32_16x16x32_bf16 v[220:223], a[44:47], a[132:135], v[220:223]
  s_cmp_eq_u32 s69, 2
  s_cselect_b32 s39, s68, 1073741824
  s_waitcnt lgkmcnt(10)
  v_mfma_f32_16x16x32_bf16 v[224:227], a[48:51], a[120:123], v[224:227]
  ds_read_b64_tr_b16 a[20:21], v4 offset:21696
  v_mfma_f32_16x16x32_bf16 v[228:231], a[48:51], a[124:127], v[228:231]
  ds_read_b64_tr_b16 a[22:23], v4 offset:25280
  v_mfma_f32_16x16x32_bf16 v[232:235], a[48:51], a[128:131], v[232:235]
  buffer_load_dword v20, v18, s[24:27], s39 offen
  v_mfma_f32_16x16x32_bf16 v[236:239], a[48:51], a[132:135], v[236:239]
  v_mfma_f32_16x16x32_bf16 v[240:243], a[52:55], a[120:123], v[240:243]
  ds_read_b64_tr_b16 a[24:25], v4 offset:7264
  v_mfma_f32_16x16x32_bf16 v[244:247], a[52:55], a[124:127], v[244:247]
  ds_read_b64_tr_b16 a[26:27], v4 offset:10848
  v_mfma_f32_16x16x32_bf16 v[248:251], a[52:55], a[128:131], v[248:251]
  v_mfma_f32_16x16x32_bf16 v[252:255], a[52:55], a[132:135], v[252:255]
  s_waitcnt vmcnt(33) lgkmcnt(10)
  v_mfma_f32_16x16x32_bf16 v[32:35], a[0:3], a[136:139], v[32:35]
  ds_read_b64_tr_b16 a[28:29], v4 offset:21728
  v_mfma_f32_16x16x32_bf16 v[36:39], a[0:3], a[140:143], v[36:39]
  ds_read_b64_tr_b16 a[30:31], v4 offset:25312
  v_mfma_f32_16x16x32_bf16 v[40:43], a[0:3], a[144:147], v[40:43]
  buffer_load_dwordx4 v9, s[24:27], s34 offen offset:1024 lds
  v_mfma_f32_16x16x32_bf16 v[44:47], a[0:3], a[148:151], v[44:47]
  s_mov_b32 s36, 40960
  v_mfma_f32_16x16x32_bf16 v[48:51], a[4:7], a[136:139], v[48:51]
  ds_read_b64_tr_b16 a[32:33], v4 offset:7296
  v_mfma_f32_16x16x32_bf16 v[52:55], a[4:7], a[140:143], v[52:55]
  ds_read_b64_tr_b16 a[34:35], v4 offset:10880
  v_mfma_f32_16x16x32_bf16 v[56:59], a[4:7], a[144:147], v[56:59]
  buffer_load_dwordx4 a[88:91], v15, s[28:31], s36 offen offset:0 sc1
  v_mfma_f32_16x16x32_bf16 v[60:63], a[4:7], a[148:151], v[60:63]
  s_waitcnt lgkmcnt(10)
  v_mfma_f32_16x16x32_bf16 v[64:67], a[8:11], a[136:139], v[64:67]
  ds_read_b64_tr_b16 a[36:37], v4 offset:21760
  v_mfma_f32_16x16x32_bf16 v[68:71], a[8:11], a[140:143], v[68:71]
  ds_read_b64_tr_b16 a[38:39], v4 offset:25344
  v_mfma_f32_16x16x32_bf16 v[72:75], a[8:11], a[144:147], v[72:75]
  buffer_load_dwordx4 v10, s[24:27], s34 offen offset:2048 lds
  v_mfma_f32_16x16x32_bf16 v[76:79], a[8:11], a[148:151], v[76:79]
  v_mfma_f32_16x16x32_bf16 v[80:83], a[12:15], a[136:139], v[80:83]
  ds_read_b64_tr_b16 a[40:41], v4 offset:7328
  v_mfma_f32_16x16x32_bf16 v[84:87], a[12:15], a[140:143], v[84:87]
  ds_read_b64_tr_b16 a[42:43], v4 offset:10912
  v_mfma_f32_16x16x32_bf16 v[88:91], a[12:15], a[144:147], v[88:91]
  buffer_load_dwordx4 a[92:95], v15, s[28:31], s36 offen offset:1024 sc1
  v_mfma_f32_16x16x32_bf16 v[92:95], a[12:15], a[148:151], v[92:95]
  s_waitcnt lgkmcnt(10)
  v_mfma_f32_16x16x32_bf16 v[96:99], a[16:19], a[136:139], v[96:99]
  ds_read_b64_tr_b16 a[44:45], v4 offset:21792
  v_mfma_f32_16x16x32_bf16 v[100:103], a[16:19], a[140:143], v[100:103]
  ds_read_b64_tr_b16 a[46:47], v4 offset:25376
  v_mfma_f32_16x16x32_bf16 v[104:107], a[16:19], a[144:147], v[104:107]
  buffer_load_dwordx4 a[96:99], v15, s[28:31], s36 offen offset:2048 sc1
  v_mfma_f32_16x16x32_bf16 v[108:111], a[16:19], a[148:151], v[108:111]
  v_mfma_f32_16x16x32_bf16 v[112:115], a[20:23], a[136:139], v[112:115]
  ds_read_b64_tr_b16 a[48:49], v4 offset:7360
  v_mfma_f32_16x16x32_bf16 v[116:119], a[20:23], a[140:143], v[116:119]
  ds_read_b64_tr_b16 a[50:51], v4 offset:10944
  v_mfma_f32_16x16x32_bf16 v[120:123], a[20:23], a[144:147], v[120:123]
  v_mfma_f32_16x16x32_bf16 v[124:127], a[20:23], a[148:151], v[124:127]
  s_waitcnt lgkmcnt(10)
  v_mfma_f32_16x16x32_bf16 v[128:131], a[24:27], a[136:139], v[128:131]
  ds_read_b64_tr_b16 a[52:53], v4 offset:21824
  v_mfma_f32_16x16x32_bf16 v[132:135], a[24:27], a[140:143], v[132:135]
  ds_read_b64_tr_b16 a[54:55], v4 offset:25408
  v_mfma_f32_16x16x32_bf16 v[136:139], a[24:27], a[144:147], v[136:139]
  v_mfma_f32_16x16x32_bf16 v[140:143], a[24:27], a[148:151], v[140:143]
  s_waitcnt vmcnt(40) lgkmcnt(0)
  s_barrier
  v_mfma_f32_16x16x32_bf16 v[144:147], a[28:31], a[136:139], v[144:147]
  ds_read_b64_tr_b16 a[0:1], v5 offset:0
  v_mfma_f32_16x16x32_bf16 v[148:151], a[28:31], a[140:143], v[148:151]
  ds_read_b64_tr_b16 a[2:3], v5 offset:3584
  v_mfma_f32_16x16x32_bf16 v[152:155], a[28:31], a[144:147], v[152:155]
  buffer_load_dwordx4 v11, s[24:27], s34 offen offset:3072 lds
  v_mfma_f32_16x16x32_bf16 v[156:159], a[28:31], a[148:151], v[156:159]
  s_waitcnt lgkmcnt(10)
  v_mfma_f32_16x16x32_bf16 v[160:163], a[32:35], a[136:139], v[160:163]
  ds_read_b64_tr_b16 a[4:5], v5 offset:14464
  v_mfma_f32_16x16x32_bf16 v[164:167], a[32:35], a[140:143], v[164:167]
  ds_read_b64_tr_b16 a[6:7], v5 offset:18048
  v_mfma_f32_16x16x32_bf16 v[168:171], a[32:35], a[144:147], v[168:171]
  buffer_load_dwordx4 a[100:103], v15, s[28:31], s36 offen offset:3072 sc1
  v_mfma_f32_16x16x32_bf16 v[172:175], a[32:35], a[148:151], v[172:175]
  s_add_u32 m0, s33, 119296
  v_mfma_f32_16x16x32_bf16 v[176:179], a[36:39], a[136:139], v[176:179]
  ds_read_b64_tr_b16 a[8:9], v5 offset:32
  v_mfma_f32_16x16x32_bf16 v[180:183], a[36:39], a[140:143], v[180:183]
  ds_read_b64_tr_b16 a[10:11], v5 offset:3616
  v_mfma_f32_16x16x32_bf16 v[184:187], a[36:39], a[144:147], v[184:187]
  buffer_load_dwordx4 v12, s[24:27], s34 offen offset:0 lds
  v_mfma_f32_16x16x32_bf16 v[188:191], a[36:39], a[148:151], v[188:191]
  s_waitcnt lgkmcnt(10)
  v_mfma_f32_16x16x32_bf16 v[192:195], a[40:43], a[136:139], v[192:195]
  ds_read_b64_tr_b16 a[12:13], v5 offset:14496
  v_mfma_f32_16x16x32_bf16 v[196:199], a[40:43], a[140:143], v[196:199]
  ds_read_b64_tr_b16 a[14:15], v5 offset:18080
  v_mfma_f32_16x16x32_bf16 v[200:203], a[40:43], a[144:147], v[200:203]
  v_mfma_f32_16x16x32_bf16 v[204:207], a[40:43], a[148:151], v[204:207]
  v_mfma_f32_16x16x32_bf16 v[208:211], a[44:47], a[136:139], v[208:211]
  ds_read_b64_tr_b16 a[16:17], v5 offset:64
  v_mfma_f32_16x16x32_bf16 v[212:215], a[44:47], a[140:143], v[212:215]
  ds_read_b64_tr_b16 a[18:19], v5 offset:3648
  v_mfma_f32_16x16x32_bf16 v[216:219], a[44:47], a[144:147], v[216:219]
  buffer_load_dwordx4 v13, s[24:27], s34 offen offset:1024 lds
  v_mfma_f32_16x16x32_bf16 v[220:223], a[44:47], a[148:151], v[220:223]
  s_waitcnt lgkmcnt(10)
  v_mfma_f32_16x16x32_bf16 v[224:227], a[48:51], a[136:139], v[224:227]
  ds_read_b64_tr_b16 a[20:21], v5 offset:14528
  v_mfma_f32_16x16x32_bf16 v[228:231], a[48:51], a[140:143], v[228:231]
  ds_read_b64_tr_b16 a[22:23], v5 offset:18112
  v_mfma_f32_16x16x32_bf16 v[232:235], a[48:51], a[144:147], v[232:235]
  v_mfma_f32_16x16x32_bf16 v[236:239], a[48:51], a[148:151], v[236:239]
  v_mfma_f32_16x16x32_bf16 v[240:243], a[52:55], a[136:139], v[240:243]
  ds_read_b64_tr_b16 a[24:25], v5 offset:96
  v_mfma_f32_16x16x32_bf16 v[244:247], a[52:55], a[140:143], v[244:247]
  ds_read_b64_tr_b16 a[26:27], v5 offset:3680
  v_mfma_f32_16x16x32_bf16 v[248:251], a[52:55], a[144:147], v[248:251]
  v_mfma_f32_16x16x32_bf16 v[252:255], a[52:55], a[148:151], v[252:255]
  s_waitcnt vmcnt(34) lgkmcnt(10)
  v_mfma_f32_16x16x32_bf16 v[32:35], a[0:3], a[152:155], v[32:35]
  ds_read_b64_tr_b16 a[28:29], v5 offset:14560
  v_mfma_f32_16x16x32_bf16 v[36:39], a[0:3], a[156:159], v[36:39]
  ds_read_b64_tr_b16 a[30:31], v5 offset:18144
  s_mov_b32 s36, 45056
  v_mfma_f32_16x16x32_bf16 v[40:43], a[0:3], a[160:163], v[40:43]
  buffer_load_dwordx4 a[104:107], v15, s[28:31], s36 offen offset:0 sc1
  v_mfma_f32_16x16x32_bf16 v[44:47], a[0:3], a[164:167], v[44:47]
  v_mfma_f32_16x16x32_bf16 v[48:51], a[4:7], a[152:155], v[48:51]
  ds_read_b64_tr_b16 a[32:33], v5 offset:128
  v_mfma_f32_16x16x32_bf16 v[52:55], a[4:7], a[156:159], v[52:55]
  ds_read_b64_tr_b16 a[34:35], v5 offset:3712
  v_mfma_f32_16x16x32_bf16 v[56:59], a[4:7], a[160:163], v[56:59]
  buffer_load_dwordx4 a[108:111], v15, s[28:31], s36 offen offset:1024 sc1
  v_mfma_f32_16x16x32_bf16 v[60:63], a[4:7], a[164:167], v[60:63]
  s_waitcnt lgkmcnt(10)
  v_mfma_f32_16x16x32_bf16 v[64:67], a[8:11], a[152:155], v[64:67]
  ds_read_b64_tr_b16 a[36:37], v5 offset:14592
  v_mfma_f32_16x16x32_bf16 v[68:71], a[8:11], a[156:159], v[68:71]
  ds_read_b64_tr_b16 a[38:39], v5 offset:18176
  v_mfma_f32_16x16x32_bf16 v[72:75], a[8:11], a[160:163], v[72:75]
  buffer_load_dwordx4 v14, s[24:27], s34 offen offset:2048 lds
  v_mfma_f32_16x16x32_bf16 v[76:79], a[8:11], a[164:167], v[76:79]
  v_mfma_f32_16x16x32_bf16 v[80:83], a[12:15], a[152:155], v[80:83]
  ds_read_b64_tr_b16 a[40:41], v5 offset:160
  v_mfma_f32_16x16x32_bf16 v[84:87], a[12:15], a[156:159], v[84:87]
  ds_read_b64_tr_b16 a[42:43], v5 offset:3744
  v_mfma_f32_16x16x32_bf16 v[88:91], a[12:15], a[160:163], v[88:91]
  v_mfma_f32_16x16x32_bf16 v[92:95], a[12:15], a[164:167], v[92:95]
  s_waitcnt lgkmcnt(10)
  v_mfma_f32_16x16x32_bf16 v[96:99], a[16:19], a[152:155], v[96:99]
  ds_read_b64_tr_b16 a[44:45], v5 offset:14624
  v_mfma_f32_16x16x32_bf16 v[100:103], a[16:19], a[156:159], v[100:103]
  ds_read_b64_tr_b16 a[46:47], v5 offset:18208
  v_mfma_f32_16x16x32_bf16 v[104:107], a[16:19], a[160:163], v[104:107]
  buffer_load_dwordx4 a[112:115], v15, s[28:31], s36 offen offset:2048 sc1
  v_mfma_f32_16x16x32_bf16 v[108:111], a[16:19], a[164:167], v[108:111]
  v_mfma_f32_16x16x32_bf16 v[112:115], a[20:23], a[152:155], v[112:115]
  ds_read_b64_tr_b16 a[48:49], v5 offset:192
  v_mfma_f32_16x16x32_bf16 v[116:119], a[20:23], a[156:159], v[116:119]
  ds_read_b64_tr_b16 a[50:51], v5 offset:3776
  v_mfma_f32_16x16x32_bf16 v[120:123], a[20:23], a[160:163], v[120:123]
  v_mfma_f32_16x16x32_bf16 v[124:127], a[20:23], a[164:167], v[124:127]
  s_waitcnt lgkmcnt(10)
  v_mfma_f32_16x16x32_bf16 v[128:131], a[24:27], a[152:155], v[128:131]
  ds_read_b64_tr_b16 a[52:53], v5 offset:14656
  v_mfma_f32_16x16x32_bf16 v[132:135], a[24:27], a[156:159], v[132:135]
  ds_read_b64_tr_b16 a[54:55], v5 offset:18240
  v_mfma_f32_16x16x32_bf16 v[136:139], a[24:27], a[160:163], v[136:139]
  v_mfma_f32_16x16x32_bf16 v[140:143], a[24:27], a[164:167], v[140:143]
  v_mfma_f32_16x16x32_bf16 v[144:147], a[28:31], a[152:155], v[144:147]
  ds_read_b64_tr_b16 a[0:1], v5 offset:7168
  v_mfma_f32_16x16x32_bf16 v[148:151], a[28:31], a[156:159], v[148:151]
  ds_read_b64_tr_b16 a[2:3], v5 offset:10752
  v_mfma_f32_16x16x32_bf16 v[152:155], a[28:31], a[160:163], v[152:155]
  buffer_load_dwordx4 a[116:119], v15, s[28:31], s36 offen offset:3072 sc1
  v_mfma_f32_16x16x32_bf16 v[156:159], a[28:31], a[164:167], v[156:159]
  s_mov_b32 s34, 3211264
  s_add_u32 m0, s33, 0
  s_waitcnt lgkmcnt(10)
  v_mfma_f32_16x16x32_bf16 v[160:163], a[32:35], a[152:155], v[160:163]
  ds_read_b64_tr_b16 a[4:5], v5 offset:21632
  v_mfma_f32_16x16x32_bf16 v[164:167], a[32:35], a[156:159], v[164:167]
  ds_read_b64_tr_b16 a[6:7], v5 offset:25216
  v_mfma_f32_16x16x32_bf16 v[168:171], a[32:35], a[160:163], v[168:171]
  buffer_load_dwordx4 v8, s[24:27], s34 offen offset:0 lds
  v_mfma_f32_16x16x32_bf16 v[172:175], a[32:35], a[164:167], v[172:175]
  v_mfma_f32_16x16x32_bf16 v[176:179], a[36:39], a[152:155], v[176:179]
  ds_read_b64_tr_b16 a[8:9], v5 offset:7200
  v_mfma_f32_16x16x32_bf16 v[180:183], a[36:39], a[156:159], v[180:183]
  ds_read_b64_tr_b16 a[10:11], v5 offset:10784
  v_mfma_f32_16x16x32_bf16 v[184:187], a[36:39], a[160:163], v[184:187]
  buffer_load_dwordx4 v9, s[24:27], s34 offen offset:1024 lds
  v_mfma_f32_16x16x32_bf16 v[188:191], a[36:39], a[164:167], v[188:191]
  s_mov_b32 s36, 49152
  s_waitcnt lgkmcnt(10)
  v_mfma_f32_16x16x32_bf16 v[192:195], a[40:43], a[152:155], v[192:195]
  ds_read_b64_tr_b16 a[12:13], v5 offset:21664
  v_mfma_f32_16x16x32_bf16 v[196:199], a[40:43], a[156:159], v[196:199]
  ds_read_b64_tr_b16 a[14:15], v5 offset:25248
  v_mfma_f32_16x16x32_bf16 v[200:203], a[40:43], a[160:163], v[200:203]
  buffer_load_dwordx4 a[120:123], v15, s[28:31], s36 offen offset:0 sc1
  v_mfma_f32_16x16x32_bf16 v[204:207], a[40:43], a[164:167], v[204:207]
  s_cmp_eq_u32 s69, 3
  s_cselect_b32 s39, s68, 1073741824
  v_mfma_f32_16x16x32_bf16 v[208:211], a[44:47], a[152:155], v[208:211]
  ds_read_b64_tr_b16 a[16:17], v5 offset:7232
  v_mfma_f32_16x16x32_bf16 v[212:215], a[44:47], a[156:159], v[212:215]
  ds_read_b64_tr_b16 a[18:19], v5 offset:10816
  v_mfma_f32_16x16x32_bf16 v[216:219], a[44:47], a[160:163], v[216:219]
  buffer_load_dword v20, v18, s[24:27], s39 offen
  v_mfma_f32_16x16x32_bf16 v[220:223], a[44:47], a[164:167], v[220:223]
  s_waitcnt lgkmcnt(10)
  v_mfma_f32_16x16x32_bf16 v[224:227], a[48:51], a[152:155], v[224:227]
  ds_read_b64_tr_b16 a[20:21], v5 offset:21696
  v_mfma_f32_16x16x32_bf16 v[228:231], a[48:51], a[156:159], v[228:231]
  ds_read_b64_tr_b16 a[22:23], v5 offset:25280
  v_mfma_f32_16x16x32_bf16 v[232:235], a[48:51], a[160:163], v[232:235]
  v_mfma_f32_16x16x32_bf16 v[236:239], a[48:51], a[164:167], v[236:239]
  v_mfma_f32_16x16x32_bf16 v[240:243], a[52:55], a[152:155], v[240:243]
  ds_read_b64_tr_b16 a[24:25], v5 offset:7264
  v_mfma_f32_16x16x32_bf16 v[244:247], a[52:55], a[156:159], v[244:247]
  ds_read_b64_tr_b16 a[26:27], v5 offset:10848
  v_mfma_f32_16x16x32_bf16 v[248:251], a[52:55], a[160:163], v[248:251]
  v_mfma_f32_16x16x32_bf16 v[252:255], a[52:55], a[164:167], v[252:255]
  s_waitcnt vmcnt(35) lgkmcnt(10)
  v_mfma_f32_16x16x32_bf16 v[32:35], a[0:3], a[168:171], v[32:35]
  ds_read_b64_tr_b16 a[28:29], v5 offset:21728
  v_mfma_f32_16x16x32_bf16 v[36:39], a[0:3], a[172:175], v[36:39]
  ds_read_b64_tr_b16 a[30:31], v5 offset:25312
  v_mfma_f32_16x16x32_bf16 v[40:43], a[0:3], a[176:179], v[40:43]
  buffer_load_dwordx4 v10, s[24:27], s34 offen offset:2048 lds
  v_mfma_f32_16x16x32_bf16 v[44:47], a[0:3], a[180:183], v[44:47]
  v_mfma_f32_16x16x32_bf16 v[48:51], a[4:7], a[168:171], v[48:51]
  ds_read_b64_tr_b16 a[32:33], v5 offset:7296
  v_mfma_f32_16x16x32_bf16 v[52:55], a[4:7], a[172:175], v[52:55]
  ds_read_b64_tr_b16 a[34:35], v5 offset:10880
  v_mfma_f32_16x16x32_bf16 v[56:59], a[4:7], a[176:179], v[56:59]
  buffer_load_dwordx4 a[124:127], v15, s[28:31], s36 offen offset:1024 sc1
  v_mfma_f32_16x16x32_bf16 v[60:63], a[4:7], a[180:183], v[60:63]
  s_waitcnt lgkmcnt(10)
  v_mfma_f32_16x16x32_bf16 v[64:67], a[8:11], a[168:171], v[64:67]
  ds_read_b64_tr_b16 a[36:37], v5 offset:21760
  v_mfma_f32_16x16x32_bf16 v[68:71], a[8:11], a[172:175], v[68:71]
  ds_read_b64_tr_b16 a[38:39], v5 offset:25344
  v_mfma_f32_16x16x32_bf16 v[72:75], a[8:11], a[176:179], v[72:75]
  buffer_load_dwordx4 a[128:131], v15, s[28:31], s36 offen offset:2048 sc1
  v_mfma_f32_16x16x32_bf16 v[76:79], a[8:11], a[180:183], v[76:79]
  v_mfma_f32_16x16x32_bf16 v[80:83], a[12:15], a[168:171], v[80:83]
  ds_read_b64_tr_b16 a[40:41], v5 offset:7328
  v_mfma_f32_16x16x32_bf16 v[84:87], a[12:15], a[172:175], v[84:87]
  ds_read_b64_tr_b16 a[42:43], v5 offset:10912
  v_mfma_f32_16x16x32_bf16 v[88:91], a[12:15], a[176:179], v[88:91]
  v_mfma_f32_16x16x32_bf16 v[92:95], a[12:15], a[180:183], v[92:95]
  s_waitcnt lgkmcnt(10)
  v_mfma_f32_16x16x32_bf16 v[96:99], a[16:19], a[168:171], v[96:99]
  ds_read_b64_tr_b16 a[44:45], v5 offset:21792
  v_mfma_f32_16x16x32_bf16 v[100:103], a[16:19], a[172:175], v[100:103]
  ds_read_b64_tr_b16 a[46:47], v5 offset:25376
  v_mfma_f32_16x16x32_bf16 v[104:107], a[16:19], a[176:179], v[104:107]
  buffer_load_dwordx4 v11, s[24:27], s34 offen offset:3072 lds
  v_mfma_f32_16x16x32_bf16 v[108:111], a[16:19], a[180:183], v[108:111]
  v_mfma_f32_16x16x32_bf16 v[112:115], a[20:23], a[168:171], v[112:115]
  ds_read_b64_tr_b16 a[48:49], v5 offset:7360
  v_mfma_f32_16x16x32_bf16 v[116:119], a[20:23], a[172:175], v[116:119]
  ds_read_b64_tr_b16 a[50:51], v5 offset:10944
  v_mfma_f32_16x16x32_bf16 v[120:123], a[20:23], a[176:179], v[120:123]
  v_mfma_f32_16x16x32_bf16 v[124:127], a[20:23], a[180:183], v[124:127]
  s_waitcnt lgkmcnt(10)
  v_mfma_f32_16x16x32_bf16 v[128:131], a[24:27], a[168:171], v[128:131]
  ds_read_b64_tr_b16 a[52:53], v5 offset:21824
  v_mfma_f32_16x16x32_bf16 v[132:135], a[24:27], a[172:175], v[132:135]
  ds_read_b64_tr_b16 a[54:55], v5 offset:25408
  v_mfma_f32_16x16x32_bf16 v[136:139], a[24:27], a[176:179], v[136:139]
  v_mfma_f32_16x16x32_bf16 v[140:143], a[24:27], a[180:183], v[140:143]
  s_waitcnt vmcnt(41) lgkmcnt(0)
  s_barrier
  v_mfma_f32_16x16x32_bf16 v[144:147], a[28:31], a[168:171], v[144:147]
  ds_read_b64_tr_b16 a[0:1], v6 offset:0
  v_mfma_f32_16x16x32_bf16 v[148:151], a[28:31], a[172:175], v[148:151]
  ds_read_b64_tr_b16 a[2:3], v6 offset:3584
  v_mfma_f32_16x16x32_bf16 v[152:155], a[28:31], a[176:179], v[152:155]
  buffer_load_dwordx4 a[132:135], v15, s[28:31], s36 offen offset:3072 sc1
  v_mfma_f32_16x16x32_bf16 v[156:159], a[28:31], a[180:183], v[156:159]
  s_add_u32 m0, s33, 4096
  s_waitcnt lgkmcnt(10)
  v_mfma_f32_16x16x32_bf16 v[160:163], a[32:35], a[168:171], v[160:163]
  ds_read_b64_tr_b16 a[4:5], v6 offset:14464
  v_mfma_f32_16x16x32_bf16 v[164:167], a[32:35], a[172:175], v[164:167]
  ds_read_b64_tr_b16 a[6:7], v6 offset:18048
  v_mfma_f32_16x16x32_bf16 v[168:171], a[32:35], a[176:179], v[168:171]
  buffer_load_dwordx4 v12, s[24:27], s34 offen offset:0 lds
  v_mfma_f32_16x16x32_bf16 v[172:175], a[32:35], a[180:183], v[172:175]
  v_mfma_f32_16x16x32_bf16 v[176:179], a[36:39], a[168:171], v[176:179]
  ds_read_b64_tr_b16 a[8:9], v6 offset:32
  v_mfma_f32_16x16x32_bf16 v[180:183], a[36:39], a[172:175], v[180:183]
  ds_read_b64_tr_b16 a[10:11], v6 offset:3616
  v_mfma_f32_16x16x32_bf16 v[184:187], a[36:39], a[176:179], v[184:187]
  buffer_load_dwordx4 v13, s[24:27], s34 offen offset:1024 lds
  v_mfma_f32_16x16x32_bf16 v[188:191], a[36:39], a[180:183], v[188:191]
  s_mov_b32 s36, 53248
  s_waitcnt lgkmcnt(10)
  v_mfma_f32_16x16x32_bf16 v[192:195], a[40:43], a[168:171], v[192:195]
  ds_read_b64_tr_b16 a[12:13], v6 offset:14496
  v_mfma_f32_16x16x32_bf16 v[196:199], a[40:43], a[172:175], v[196:199]
  ds_read_b64_tr_b16 a[14:15], v6 offset:18080
  v_mfma_f32_16x16x32_bf16 v[200:203], a[40:43], a[176:179], v[200:203]
  v_mfma_f32_16x16x32_bf16 v[204:207], a[40:43], a[180:183], v[204:207]
  v_mfma_f32_16x16x32_bf16 v[208:211], a[44:47], a[168:171], v[208:211]
  ds_read_b64_tr_b16 a[16:17], v6 offset:64
  v_mfma_f32_16x16x32_bf16 v[212:215], a[44:47], a[172:175], v[212:215]
  ds_read_b64_tr_b16 a[18:19], v6 offset:3648
  v_mfma_f32_16x16x32_bf16 v[216:219], a[44:47], a[176:179], v[216:219]
  buffer_load_dwordx4 a[136:139], v15, s[28:31], s36 offen offset:0 sc1
  v_mfma_f32_16x16x32_bf16 v[220:223], a[44:47], a[180:183], v[220:223]
  s_waitcnt lgkmcnt(10)
  v_mfma_f32_16x16x32_bf16 v[224:227], a[48:51], a[168:171], v[224:227]
  ds_read_b64_tr_b16 a[20:21], v6 offset:14528
  v_mfma_f32_16x16x32_bf16 v[228:231], a[48:51], a[172:175], v[228:231]
  ds_read_b64_tr_b16 a[22:23], v6 offset:18112
  v_mfma_f32_16x16x32_bf16 v[232:235], a[48:51], a[176:179], v[232:235]
  v_mfma_f32_16x16x32_bf16 v[236:239], a[48:51], a[180:183], v[236:239]
  v_mfma_f32_16x16x32_bf16 v[240:243], a[52:55], a[168:171], v[240:243]
  ds_read_b64_tr_b16 a[24:25], v6 offset:96
  v_mfma_f32_16x16x32_bf16 v[244:247], a[52:55], a[172:175], v[244:247]
  ds_read_b64_tr_b16 a[26:27], v6 offset:3680
  v_mfma_f32_16x16x32_bf16 v[248:251], a[52:55], a[176:179], v[248:251]
  v_mfma_f32_16x16x32_bf16 v[252:255], a[52:55], a[180:183], v[252:255]
  s_waitcnt vmcnt(35) lgkmcnt(10)
  v_mfma_f32_16x16x32_bf16 v[32:35], a[0:3], a[56:59], v[32:35]
  ds_read_b64_tr_b16 a[28:29], v6 offset:14560
  v_mfma_f32_16x16x32_bf16 v[36:39], a[0:3], a[60:63], v[36:39]
  ds_read_b64_tr_b16 a[30:31], v6 offset:18144
  v_mfma_f32_16x16x32_bf16 v[40:43], a[0:3], a[64:67], v[40:43]
  buffer_load_dwordx4 a[140:143], v15, s[28:31], s36 offen offset:1024 sc1
  v_mfma_f32_16x16x32_bf16 v[44:47], a[0:3], a[68:71], v[44:47]
  v_mfma_f32_16x16x32_bf16 v[48:51], a[4:7], a[56:59], v[48:51]
  ds_read_b64_tr_b16 a[32:33], v6 offset:128
  v_mfma_f32_16x16x32_bf16 v[52:55], a[4:7], a[60:63], v[52:55]
  ds_read_b64_tr_b16 a[34:35], v6 offset:3712
  v_mfma_f32_16x16x32_bf16 v[56:59], a[4:7], a[64:67], v[56:59]
  buffer_load_dwordx4 v14, s[24:27], s34 offen offset:2048 lds
  v_mfma_f32_16x16x32_bf16 v[60:63], a[4:7], a[68:71], v[60:63]
  s_waitcnt lgkmcnt(10)
  v_mfma_f32_16x16x32_bf16 v[64:67], a[8:11], a[56:59], v[64:67]
  ds_read_b64_tr_b16 a[36:37], v6 offset:14592
  v_mfma_f32_16x16x32_bf16 v[68:71], a[8:11], a[60:63], v[68:71]
  ds_read_b64_tr_b16 a[38:39], v6 offset:18176
  v_mfma_f32_16x16x32_bf16 v[72:75], a[8:11], a[64:67], v[72:75]
  buffer_load_dwordx4 a[144:147], v15, s[28:31], s36 offen offset:2048 sc1
  v_mfma_f32_16x16x32_bf16 v[76:79], a[8:11], a[68:71], v[76:79]
  v_mfma_f32_16x16x32_bf16 v[80:83], a[12:15], a[56:59], v[80:83]
  ds_read_b64_tr_b16 a[40:41], v6 offset:160
  v_mfma_f32_16x16x32_bf16 v[84:87], a[12:15], a[60:63], v[84:87]
  ds_read_b64_tr_b16 a[42:43], v6 offset:3744
  v_mfma_f32_16x16x32_bf16 v[88:91], a[12:15], a[64:67], v[88:91]
  v_mfma_f32_16x16x32_bf16 v[92:95], a[12:15], a[68:71], v[92:95]
  s_waitcnt lgkmcnt(10)
  v_mfma_f32_16x16x32_bf16 v[96:99], a[16:19], a[56:59], v[96:99]
  ds_read_b64_tr_b16 a[44:45], v6 offset:14624
  v_mfma_f32_16x16x32_bf16 v[100:103], a[16:19], a[60:63], v[100:103]
  ds_read_b64_tr_b16 a[46:47], v6 offset:18208
  v_mfma_f32_16x16x32_bf16 v[104:107], a[16:19], a[64:67], v[104:107]
  buffer_load_dwordx4 a[148:151], v15, s[28:31], s36 offen offset:3072 sc1
  v_mfma_f32_16x16x32_bf16 v[108:111], a[16:19], a[68:71], v[108:111]
  v_mfma_f32_16x16x32_bf16 v[112:115], a[20:23], a[56:59], v[112:115]
  ds_read_b64_tr_b16 a[48:49], v6 offset:192
  v_mfma_f32_16x16x32_bf16 v[116:119], a[20:23], a[60:63], v[116:119]
  ds_read_b64_tr_b16 a[50:51], v6 offset:3776
  v_mfma_f32_16x16x32_bf16 v[120:123], a[20:23], a[64:67], v[120:123]
  v_mfma_f32_16x16x32_bf16 v[124:127], a[20:23], a[68:71], v[124:127]
  s_waitcnt lgkmcnt(10)
  v_mfma_f32_16x16x32_bf16 v[128:131], a[24:27], a[56:59], v[128:131]
  ds_read_b64_tr_b16 a[52:53], v6 offset:14656
  v_mfma_f32_16x16x32_bf16 v[132:135], a[24:27], a[60:63], v[132:135]
  ds_read_b64_tr_b16 a[54:55], v6 offset:18240
  v_mfma_f32_16x16x32_bf16 v[136:139], a[24:27], a[64:67], v[136:139]
  v_mfma_f32_16x16x32_bf16 v[140:143], a[24:27], a[68:71], v[140:143]
  v_mfma_f32_16x16x32_bf16 v[144:147], a[28:31], a[56:59], v[144:147]
  ds_read_b64_tr_b16 a[0:1], v6 offset:7168
  v_mfma_f32_16x16x32_bf16 v[148:151], a[28:31], a[60:63], v[148:151]
  ds_read_b64_tr_b16 a[2:3], v6 offset:10752
  s_mov_b32 s34, 3670016
  s_add_u32 m0, s33, 28800
  v_mfma_f32_16x16x32_bf16 v[152:155], a[28:31], a[64:67], v[152:155]
  buffer_load_dwordx4 v8, s[24:27], s34 offen offset:0 lds
  v_mfma_f32_16x16x32_bf16 v[156:159], a[28:31], a[68:71], v[156:159]
  s_waitcnt lgkmcnt(10)
  v_mfma_f32_16x16x32_bf16 v[160:163], a[32:35], a[56:59], v[160:163]
  ds_read_b64_tr_b16 a[4:5], v6 offset:21632
  v_mfma_f32_16x16x32_bf16 v[164:167], a[32:35], a[60:63], v[164:167]
  ds_read_b64_tr_b16 a[6:7], v6 offset:25216
  v_mfma_f32_16x16x32_bf16 v[168:171], a[32:35], a[64:67], v[168:171]
  buffer_load_dwordx4 v9, s[24:27], s34 offen offset:1024 lds
  v_mfma_f32_16x16x32_bf16 v[172:175], a[32:35], a[68:71], v[172:175]
  s_mov_b32 s36, 57344
  v_mfma_f32_16x16x32_bf16 v[176:179], a[36:39], a[56:59], v[176:179]
  ds_read_b64_tr_b16 a[8:9], v6 offset:7200
  v_mfma_f32_16x16x32_bf16 v[180:183], a[36:39], a[60:63], v[180:183]
  ds_read_b64_tr_b16 a[10:11], v6 offset:10784
  v_mfma_f32_16x16x32_bf16 v[184:187], a[36:39], a[64:67], v[184:187]
  buffer_load_dwordx4 a[152:155], v15, s[28:31], s36 offen offset:0 sc1
  v_mfma_f32_16x16x32_bf16 v[188:191], a[36:39], a[68:71], v[188:191]
  s_waitcnt lgkmcnt(10)
  v_mfma_f32_16x16x32_bf16 v[192:195], a[40:43], a[56:59], v[192:195]
  ds_read_b64_tr_b16 a[12:13], v6 offset:21664
  v_mfma_f32_16x16x32_bf16 v[196:199], a[40:43], a[60:63], v[196:199]
  ds_read_b64_tr_b16 a[14:15], v6 offset:25248
  v_mfma_f32_16x16x32_bf16 v[200:203], a[40:43], a[64:67], v[200:203]
  buffer_load_dwordx4 v10, s[24:27], s34 offen offset:2048 lds
  v_mfma_f32_16x16x32_bf16 v[204:207], a[40:43], a[68:71], v[204:207]
  s_cmp_eq_u32 s75, 0
  s_cselect_b32 s39, s74, 1073741824
  v_mfma_f32_16x16x32_bf16 v[208:211], a[44:47], a[56:59], v[208:211]
  ds_read_b64_tr_b16 a[16:17], v6 offset:7232
  v_mfma_f32_16x16x32_bf16 v[212:215], a[44:47], a[60:63], v[212:215]
  ds_read_b64_tr_b16 a[18:19], v6 offset:10816
  v_mfma_f32_16x16x32_bf16 v[216:219], a[44:47], a[64:67], v[216:219]
  buffer_load_dword v20, v19, s[52:55], s39 offen
  v_mfma_f32_16x16x32_bf16 v[220:223], a[44:47], a[68:71], v[220:223]
  s_waitcnt lgkmcnt(10)
  v_mfma_f32_16x16x32_bf16 v[224:227], a[48:51], a[56:59], v[224:227]
  ds_read_b64_tr_b16 a[20:21], v6 offset:21696
  v_mfma_f32_16x16x32_bf16 v[228:231], a[48:51], a[60:63], v[228:231]
  ds_read_b64_tr_b16 a[22:23], v6 offset:25280
  v_mfma_f32_16x16x32_bf16 v[232:235], a[48:51], a[64:67], v[232:235]
  v_mfma_f32_16x16x32_bf16 v[236:239], a[48:51], a[68:71], v[236:239]
  v_mfma_f32_16x16x32_bf16 v[240:243], a[52:55], a[56:59], v[240:243]
  ds_read_b64_tr_b16 a[24:25], v6 offset:7264
  v_mfma_f32_16x16x32_bf16 v[244:247], a[52:55], a[60:63], v[244:247]
  ds_read_b64_tr_b16 a[26:27], v6 offset:10848
  v_mfma_f32_16x16x32_bf16 v[248:251], a[52:55], a[64:67], v[248:251]
  v_mfma_f32_16x16x32_bf16 v[252:255], a[52:55], a[68:71], v[252:255]
  s_waitcnt vmcnt(37) lgkmcnt(10)
  v_mfma_f32_16x16x32_bf16 v[32:35], a[0:3], a[72:75], v[32:35]
  ds_read_b64_tr_b16 a[28:29], v6 offset:21728
  v_mfma_f32_16x16x32_bf16 v[36:39], a[0:3], a[76:79], v[36:39]
  ds_read_b64_tr_b16 a[30:31], v6 offset:25312
  v_mfma_f32_16x16x32_bf16 v[40:43], a[0:3], a[80:83], v[40:43]
  buffer_load_dwordx4 a[156:159], v15, s[28:31], s36 offen offset:1024 sc1
  v_mfma_f32_16x16x32_bf16 v[44:47], a[0:3], a[84:87], v[44:47]
  v_mfma_f32_16x16x32_bf16 v[48:51], a[4:7], a[72:75], v[48:51]
  ds_read_b64_tr_b16 a[32:33], v6 offset:7296
  v_mfma_f32_16x16x32_bf16 v[52:55], a[4:7], a[76:79], v[52:55]
  ds_read_b64_tr_b16 a[34:35], v6 offset:10880
  v_mfma_f32_16x16x32_bf16 v[56:59], a[4:7], a[80:83], v[56:59]
  buffer_load_dwordx4 a[160:163], v15, s[28:31], s36 offen offset:2048 sc1
  v_mfma_f32_16x16x32_bf16 v[60:63], a[4:7], a[84:87], v[60:63]
  s_waitcnt lgkmcnt(10)
  v_mfma_f32_16x16x32_bf16 v[64:67], a[8:11], a[72:75], v[64:67]
  ds_read_b64_tr_b16 a[36:37], v6 offset:21760
  v_mfma_f32_16x16x32_bf16 v[68:71], a[8:11], a[76:79], v[68:71]
  ds_read_b64_tr_b16 a[38:39], v6 offset:25344
  v_mfma_f32_16x16x32_bf16 v[72:75], a[8:11], a[80:83], v[72:75]
  buffer_load_dwordx4 v11, s[24:27], s34 offen offset:3072 lds
  v_mfma_f32_16x16x32_bf16 v[76:79], a[8:11], a[84:87], v[76:79]
  v_mfma_f32_16x16x32_bf16 v[80:83], a[12:15], a[72:75], v[80:83]
  ds_read_b64_tr_b16 a[40:41], v6 offset:7328
  v_mfma_f32_16x16x32_bf16 v[84:87], a[12:15], a[76:79], v[84:87]
  ds_read_b64_tr_b16 a[42:43], v6 offset:10912
  v_mfma_f32_16x16x32_bf16 v[88:91], a[12:15], a[80:83], v[88:91]
  v_mfma_f32_16x16x32_bf16 v[92:95], a[12:15], a[84:87], v[92:95]
  s_waitcnt lgkmcnt(10)
  v_mfma_f32_16x16x32_bf16 v[96:99], a[16:19], a[72:75], v[96:99]
  ds_read_b64_tr_b16 a[44:45], v6 offset:21792
  v_mfma_f32_16x16x32_bf16 v[100:103], a[16:19], a[76:79], v[100:103]
  ds_read_b64_tr_b16 a[46:47], v6 offset:25376
  v_mfma_f32_16x16x32_bf16 v[104:107], a[16:19], a[80:83], v[104:107]
  buffer_load_dwordx4 a[164:167], v15, s[28:31], s36 offen offset:3072 sc1
  v_mfma_f32_16x16x32_bf16 v[108:111], a[16:19], a[84:87], v[108:111]
  v_mfma_f32_16x16x32_bf16 v[112:115], a[20:23], a[72:75], v[112:115]
  ds_read_b64_tr_b16 a[48:49], v6 offset:7360
  v_mfma_f32_16x16x32_bf16 v[116:119], a[20:23], a[76:79], v[116:119]
  ds_read_b64_tr_b16 a[50:51], v6 offset:10944
  v_mfma_f32_16x16x32_bf16 v[120:123], a[20:23], a[80:83], v[120:123]
  v_mfma_f32_16x16x32_bf16 v[124:127], a[20:23], a[84:87], v[124:127]
  s_waitcnt lgkmcnt(10)
  v_mfma_f32_16x16x32_bf16 v[128:131], a[24:27], a[72:75], v[128:131]
  ds_read_b64_tr_b16 a[52:53], v6 offset:21824
  v_mfma_f32_16x16x32_bf16 v[132:135], a[24:27], a[76:79], v[132:135]
  ds_read_b64_tr_b16 a[54:55], v6 offset:25408
  v_mfma_f32_16x16x32_bf16 v[136:139], a[24:27], a[80:83], v[136:139]
  v_mfma_f32_16x16x32_bf16 v[140:143], a[24:27], a[84:87], v[140:143]
  s_waitcnt vmcnt(43) lgkmcnt(0)
  s_barrier
  v_mfma_f32_16x16x32_bf16 v[144:147], a[28:31], a[72:75], v[144:147]
  ds_read_b64_tr_b16 a[0:1], v7 offset:0
  v_mfma_f32_16x16x32_bf16 v[148:151], a[28:31], a[76:79], v[148:151]
  ds_read_b64_tr_b16 a[2:3], v7 offset:3584
  s_add_u32 m0, s33, 32896
  v_mfma_f32_16x16x32_bf16 v[152:155], a[28:31], a[80:83], v[152:155]
  buffer_load_dwordx4 v12, s[24:27], s34 offen offset:0 lds
  v_mfma_f32_16x16x32_bf16 v[156:159], a[28:31], a[84:87], v[156:159]
  s_waitcnt lgkmcnt(10)
  v_mfma_f32_16x16x32_bf16 v[160:163], a[32:35], a[72:75], v[160:163]
  ds_read_b64_tr_b16 a[4:5], v7 offset:14464
  v_mfma_f32_16x16x32_bf16 v[164:167], a[32:35], a[76:79], v[164:167]
  ds_read_b64_tr_b16 a[6:7], v7 offset:18048
  v_mfma_f32_16x16x32_bf16 v[168:171], a[32:35], a[80:83], v[168:171]
  buffer_load_dwordx4 v13, s[24:27], s34 offen offset:1024 lds
  v_mfma_f32_16x16x32_bf16 v[172:175], a[32:35], a[84:87], v[172:175]
  s_mov_b32 s36, 61440
  v_mfma_f32_16x16x32_bf16 v[176:179], a[36:39], a[72:75], v[176:179]
  ds_read_b64_tr_b16 a[8:9], v7 offset:32
  v_mfma_f32_16x16x32_bf16 v[180:183], a[36:39], a[76:79], v[180:183]
  ds_read_b64_tr_b16 a[10:11], v7 offset:3616
  v_mfma_f32_16x16x32_bf16 v[184:187], a[36:39], a[80:83], v[184:187]
  buffer_load_dwordx4 a[168:171], v15, s[28:31], s36 offen offset:0 sc1
  v_mfma_f32_16x16x32_bf16 v[188:191], a[36:39], a[84:87], v[188:191]
  s_waitcnt lgkmcnt(10)
  v_mfma_f32_16x16x32_bf16 v[192:195], a[40:43], a[72:75], v[192:195]
  ds_read_b64_tr_b16 a[12:13], v7 offset:14496
  v_mfma_f32_16x16x32_bf16 v[196:199], a[40:43], a[76:79], v[196:199]
  ds_read_b64_tr_b16 a[14:15], v7 offset:18080
  v_mfma_f32_16x16x32_bf16 v[200:203], a[40:43], a[80:83], v[200:203]
  v_mfma_f32_16x16x32_bf16 v[204:207], a[40:43], a[84:87], v[204:207]
  v_mfma_f32_16x16x32_bf16 v[208:211], a[44:47], a[72:75], v[208:211]
  ds_read_b64_tr_b16 a[16:17], v7 offset:64
  v_mfma_f32_16x16x32_bf16 v[212:215], a[44:47], a[76:79], v[212:215]
  ds_read_b64_tr_b16 a[18:19], v7 offset:3648
  v_mfma_f32_16x16x32_bf16 v[216:219], a[44:47], a[80:83], v[216:219]
  buffer_load_dwordx4 a[172:175], v15, s[28:31], s36 offen offset:1024 sc1
  v_mfma_f32_16x16x32_bf16 v[220:223], a[44:47], a[84:87], v[220:223]
  s_waitcnt lgkmcnt(10)
  v_mfma_f32_16x16x32_bf16 v[224:227], a[48:51], a[72:75], v[224:227]
  ds_read_b64_tr_b16 a[20:21], v7 offset:14528
  v_mfma_f32_16x16x32_bf16 v[228:231], a[48:51], a[76:79], v[228:231]
  ds_read_b64_tr_b16 a[22:23], v7 offset:18112
  v_mfma_f32_16x16x32_bf16 v[232:235], a[48:51], a[80:83], v[232:235]
  v_mfma_f32_16x16x32_bf16 v[236:239], a[48:51], a[84:87], v[236:239]
  v_mfma_f32_16x16x32_bf16 v[240:243], a[52:55], a[72:75], v[240:243]
  ds_read_b64_tr_b16 a[24:25], v7 offset:96
  v_mfma_f32_16x16x32_bf16 v[244:247], a[52:55], a[76:79], v[244:247]
  ds_read_b64_tr_b16 a[26:27], v7 offset:3680
  v_mfma_f32_16x16x32_bf16 v[248:251], a[52:55], a[80:83], v[248:251]
  v_mfma_f32_16x16x32_bf16 v[252:255], a[52:55], a[84:87], v[252:255]
  s_waitcnt vmcnt(36) lgkmcnt(10)
  v_mfma_f32_16x16x32_bf16 v[32:35], a[0:3], a[88:91], v[32:35]
  ds_read_b64_tr_b16 a[28:29], v7 offset:14560
  v_mfma_f32_16x16x32_bf16 v[36:39], a[0:3], a[92:95], v[36:39]
  ds_read_b64_tr_b16 a[30:31], v7 offset:18144
  v_mfma_f32_16x16x32_bf16 v[40:43], a[0:3], a[96:99], v[40:43]
  buffer_load_dwordx4 v14, s[24:27], s34 offen offset:2048 lds
  v_mfma_f32_16x16x32_bf16 v[44:47], a[0:3], a[100:103], v[44:47]
  v_mfma_f32_16x16x32_bf16 v[48:51], a[4:7], a[88:91], v[48:51]
  ds_read_b64_tr_b16 a[32:33], v7 offset:128
  v_mfma_f32_16x16x32_bf16 v[52:55], a[4:7], a[92:95], v[52:55]
  ds_read_b64_tr_b16 a[34:35], v7 offset:3712
  v_mfma_f32_16x16x32_bf16 v[56:59], a[4:7], a[96:99], v[56:59]
  buffer_load_dwordx4 a[176:179], v15, s[28:31], s36 offen offset:2048 sc1
  v_mfma_f32_16x16x32_bf16 v[60:63], a[4:7], a[100:103], v[60:63]
  s_waitcnt lgkmcnt(10)
  v_mfma_f32_16x16x32_bf16 v[64:67], a[8:11], a[88:91], v[64:67]
  ds_read_b64_tr_b16 a[36:37], v7 offset:14592
  v_mfma_f32_16x16x32_bf16 v[68:71], a[8:11], a[92:95], v[68:71]
  ds_read_b64_tr_b16 a[38:39], v7 offset:18176
  v_mfma_f32_16x16x32_bf16 v[72:75], a[8:11], a[96:99], v[72:75]
  buffer_load_dwordx4 a[180:183], v15, s[28:31], s36 offen offset:3072 sc1
  v_mfma_f32_16x16x32_bf16 v[76:79], a[8:11], a[100:103], v[76:79]
  s_mov_b32 s34, 4128768
  s_add_u32 m0, s33, 57600
  v_mfma_f32_16x16x32_bf16 v[80:83], a[12:15], a[88:91], v[80:83]
  ds_read_b64_tr_b16 a[40:41], v7 offset:160
  v_mfma_f32_16x16x32_bf16 v[84:87], a[12:15], a[92:95], v[84:87]
  ds_read_b64_tr_b16 a[42:43], v7 offset:3744
  v_mfma_f32_16x16x32_bf16 v[88:91], a[12:15], a[96:99], v[88:91]
  buffer_load_dwordx4 v8, s[24:27], s34 offen offset:0 lds
  v_mfma_f32_16x16x32_bf16 v[92:95], a[12:15], a[100:103], v[92:95]
  s_waitcnt lgkmcnt(10)
  v_mfma_f32_16x16x32_bf16 v[96:99], a[16:19], a[88:91], v[96:99]
  ds_read_b64_tr_b16 a[44:45], v7 offset:14624
  v_mfma_f32_16x16x32_bf16 v[100:103], a[16:19], a[92:95], v[100:103]
  ds_read_b64_tr_b16 a[46:47], v7 offset:18208
  v_mfma_f32_16x16x32_bf16 v[104:107], a[16:19], a[96:99], v[104:107]
  global_load_dword v20, v[28:29], off
  v_mfma_f32_16x16x32_bf16 v[108:111], a[16:19], a[100:103], v[108:111]
  v_mfma_f32_16x16x32_bf16 v[112:115], a[20:23], a[88:91], v[112:115]
  ds_read_b64_tr_b16 a[48:49], v7 offset:192
  v_mfma_f32_16x16x32_bf16 v[116:119], a[20:23], a[92:95], v[116:119]
  ds_read_b64_tr_b16 a[50:51], v7 offset:3776
  v_mfma_f32_16x16x32_bf16 v[120:123], a[20:23], a[96:99], v[120:123]
  v_mfma_f32_16x16x32_bf16 v[124:127], a[20:23], a[100:103], v[124:127]
  s_waitcnt lgkmcnt(10)
  v_mfma_f32_16x16x32_bf16 v[128:131], a[24:27], a[88:91], v[128:131]
  ds_read_b64_tr_b16 a[52:53], v7 offset:14656
  v_mfma_f32_16x16x32_bf16 v[132:135], a[24:27], a[92:95], v[132:135]
  ds_read_b64_tr_b16 a[54:55], v7 offset:18240
  v_mfma_f32_16x16x32_bf16 v[136:139], a[24:27], a[96:99], v[136:139]
  v_mfma_f32_16x16x32_bf16 v[140:143], a[24:27], a[100:103], v[140:143]
  v_mfma_f32_16x16x32_bf16 v[144:147], a[28:31], a[88:91], v[144:147]
  ds_read_b64_tr_b16 a[0:1], v7 offset:7168
  v_mfma_f32_16x16x32_bf16 v[148:151], a[28:31], a[92:95], v[148:151]
  ds_read_b64_tr_b16 a[2:3], v7 offset:10752
  v_mfma_f32_16x16x32_bf16 v[152:155], a[28:31], a[96:99], v[152:155]
  buffer_load_dwordx4 v9, s[24:27], s34 offen offset:1024 lds
  v_mfma_f32_16x16x32_bf16 v[156:159], a[28:31], a[100:103], v[156:159]
  s_mov_b32 s36, 65536
  s_waitcnt lgkmcnt(10)
  v_mfma_f32_16x16x32_bf16 v[160:163], a[32:35], a[88:91], v[160:163]
  ds_read_b64_tr_b16 a[4:5], v7 offset:21632
  v_mfma_f32_16x16x32_bf16 v[164:167], a[32:35], a[92:95], v[164:167]
  ds_read_b64_tr_b16 a[6:7], v7 offset:25216
  v_mfma_f32_16x16x32_bf16 v[168:171], a[32:35], a[96:99], v[168:171]
  buffer_load_dwordx4 a[56:59], v15, s[28:31], s36 offen offset:0 sc1
  v_mfma_f32_16x16x32_bf16 v[172:175], a[32:35], a[100:103], v[172:175]
  v_mfma_f32_16x16x32_bf16 v[176:179], a[36:39], a[88:91], v[176:179]
  ds_read_b64_tr_b16 a[8:9], v7 offset:7200
  v_mfma_f32_16x16x32_bf16 v[180:183], a[36:39], a[92:95], v[180:183]
  ds_read_b64_tr_b16 a[10:11], v7 offset:10784
  v_mfma_f32_16x16x32_bf16 v[184:187], a[36:39], a[96:99], v[184:187]
  buffer_load_dwordx4 v10, s[24:27], s34 offen offset:2048 lds
  v_mfma_f32_16x16x32_bf16 v[188:191], a[36:39], a[100:103], v[188:191]
  s_waitcnt lgkmcnt(10)
  v_mfma_f32_16x16x32_bf16 v[192:195], a[40:43], a[88:91], v[192:195]
  ds_read_b64_tr_b16 a[12:13], v7 offset:21664
  v_mfma_f32_16x16x32_bf16 v[196:199], a[40:43], a[92:95], v[196:199]
  ds_read_b64_tr_b16 a[14:15], v7 offset:25248
  v_mfma_f32_16x16x32_bf16 v[200:203], a[40:43], a[96:99], v[200:203]
  buffer_load_dwordx4 a[60:63], v15, s[28:31], s36 offen offset:1024 sc1
  v_mfma_f32_16x16x32_bf16 v[204:207], a[40:43], a[100:103], v[204:207]
  s_cmp_eq_u32 s75, 1
  s_cselect_b32 s39, s74, 1073741824
  v_mfma_f32_16x16x32_bf16 v[208:211], a[44:47], a[88:91], v[208:211]
  ds_read_b64_tr_b16 a[16:17], v7 offset:7232
  v_mfma_f32_16x16x32_bf16 v[212:215], a[44:47], a[92:95], v[212:215]
  ds_read_b64_tr_b16 a[18:19], v7 offset:10816
  v_mfma_f32_16x16x32_bf16 v[216:219], a[44:47], a[96:99], v[216:219]
  buffer_load_dword v20, v19, s[52:55], s39 offen
  v_mfma_f32_16x16x32_bf16 v[220:223], a[44:47], a[100:103], v[220:223]
  s_waitcnt lgkmcnt(10)
  v_mfma_f32_16x16x32_bf16 v[224:227], a[48:51], a[88:91], v[224:227]
  ds_read_b64_tr_b16 a[20:21], v7 offset:21696
  v_mfma_f32_16x16x32_bf16 v[228:231], a[48:51], a[92:95], v[228:231]
  ds_read_b64_tr_b16 a[22:23], v7 offset:25280
  v_mfma_f32_16x16x32_bf16 v[232:235], a[48:51], a[96:99], v[232:235]
  v_mfma_f32_16x16x32_bf16 v[236:239], a[48:51], a[100:103], v[236:239]
  v_mfma_f32_16x16x32_bf16 v[240:243], a[52:55], a[88:91], v[240:243]
  ds_read_b64_tr_b16 a[24:25], v7 offset:7264
  v_mfma_f32_16x16x32_bf16 v[244:247], a[52:55], a[92:95], v[244:247]
  ds_read_b64_tr_b16 a[26:27], v7 offset:10848
  v_mfma_f32_16x16x32_bf16 v[248:251], a[52:55], a[96:99], v[248:251]
  v_mfma_f32_16x16x32_bf16 v[252:255], a[52:55], a[100:103], v[252:255]
  s_waitcnt vmcnt(39) lgkmcnt(10)
  v_mfma_f32_16x16x32_bf16 v[32:35], a[0:3], a[104:107], v[32:35]
  ds_read_b64_tr_b16 a[28:29], v7 offset:21728
  v_mfma_f32_16x16x32_bf16 v[36:39], a[0:3], a[108:111], v[36:39]
  ds_read_b64_tr_b16 a[30:31], v7 offset:25312
  v_mfma_f32_16x16x32_bf16 v[40:43], a[0:3], a[112:115], v[40:43]
  buffer_load_dwordx4 a[64:67], v15, s[28:31], s36 offen offset:2048 sc1
  v_mfma_f32_16x16x32_bf16 v[44:47], a[0:3], a[116:119], v[44:47]
  v_mfma_f32_16x16x32_bf16 v[48:51], a[4:7], a[104:107], v[48:51]
  ds_read_b64_tr_b16 a[32:33], v7 offset:7296
  v_mfma_f32_16x16x32_bf16 v[52:55], a[4:7], a[108:111], v[52:55]
  ds_read_b64_tr_b16 a[34:35], v7 offset:10880
  v_mfma_f32_16x16x32_bf16 v[56:59], a[4:7], a[112:115], v[56:59]
  buffer_load_dwordx4 v11, s[24:27], s34 offen offset:3072 lds
  v_mfma_f32_16x16x32_bf16 v[60:63], a[4:7], a[116:119], v[60:63]
  s_waitcnt lgkmcnt(10)
  v_mfma_f32_16x16x32_bf16 v[64:67], a[8:11], a[104:107], v[64:67]
  ds_read_b64_tr_b16 a[36:37], v7 offset:21760
  v_mfma_f32_16x16x32_bf16 v[68:71], a[8:11], a[108:111], v[68:71]
  ds_read_b64_tr_b16 a[38:39], v7 offset:25344
  v_mfma_f32_16x16x32_bf16 v[72:75], a[8:11], a[112:115], v[72:75]
  buffer_load_dwordx4 a[68:71], v15, s[28:31], s36 offen offset:3072 sc1
  v_mfma_f32_16x16x32_bf16 v[76:79], a[8:11], a[116:119], v[76:79]
  s_add_u32 m0, s33, 61696
  v_mfma_f32_16x16x32_bf16 v[80:83], a[12:15], a[104:107], v[80:83]
  ds_read_b64_tr_b16 a[40:41], v7 offset:7328
  v_mfma_f32_16x16x32_bf16 v[84:87], a[12:15], a[108:111], v[84:87]
  ds_read_b64_tr_b16 a[42:43], v7 offset:10912
  v_mfma_f32_16x16x32_bf16 v[88:91], a[12:15], a[112:115], v[88:91]
  v_mfma_f32_16x16x32_bf16 v[92:95], a[12:15], a[116:119], v[92:95]
  s_waitcnt lgkmcnt(10)
  v_mfma_f32_16x16x32_bf16 v[96:99], a[16:19], a[104:107], v[96:99]
  ds_read_b64_tr_b16 a[44:45], v7 offset:21792
  v_mfma_f32_16x16x32_bf16 v[100:103], a[16:19], a[108:111], v[100:103]
  ds_read_b64_tr_b16 a[46:47], v7 offset:25376
  v_mfma_f32_16x16x32_bf16 v[104:107], a[16:19], a[112:115], v[104:107]
  buffer_load_dwordx4 v12, s[24:27], s34 offen offset:0 lds
  v_mfma_f32_16x16x32_bf16 v[108:111], a[16:19], a[116:119], v[108:111]
  v_mfma_f32_16x16x32_bf16 v[112:115], a[20:23], a[104:107], v[112:115]
  ds_read_b64_tr_b16 a[48:49], v7 offset:7360
  v_mfma_f32_16x16x32_bf16 v[116:119], a[20:23], a[108:111], v[116:119]
  ds_read_b64_tr_b16 a[50:51], v7 offset:10944
  v_mfma_f32_16x16x32_bf16 v[120:123], a[20:23], a[112:115], v[120:123]
  v_mfma_f32_16x16x32_bf16 v[124:127], a[20:23], a[116:119], v[124:127]
  s_waitcnt lgkmcnt(10)
  v_mfma_f32_16x16x32_bf16 v[128:131], a[24:27], a[104:107], v[128:131]
  ds_read_b64_tr_b16 a[52:53], v7 offset:21824
  v_mfma_f32_16x16x32_bf16 v[132:135], a[24:27], a[108:111], v[132:135]
  ds_read_b64_tr_b16 a[54:55], v7 offset:25408
  v_mfma_f32_16x16x32_bf16 v[136:139], a[24:27], a[112:115], v[136:139]
  v_mfma_f32_16x16x32_bf16 v[140:143], a[24:27], a[116:119], v[140:143]
  s_waitcnt vmcnt(45) lgkmcnt(0)
  s_barrier
  v_mfma_f32_16x16x32_bf16 v[144:147], a[28:31], a[104:107], v[144:147]
  ds_read_b64_tr_b16 a[0:1], v17 offset:0
  v_mfma_f32_16x16x32_bf16 v[148:151], a[28:31], a[108:111], v[148:151]
  ds_read_b64_tr_b16 a[2:3], v17 offset:3584
  v_mfma_f32_16x16x32_bf16 v[152:155], a[28:31], a[112:115], v[152:155]
  buffer_load_dwordx4 v13, s[24:27], s34 offen offset:1024 lds
  v_mfma_f32_16x16x32_bf16 v[156:159], a[28:31], a[116:119], v[156:159]
  s_mov_b32 s36, 69632
  s_waitcnt lgkmcnt(10)
  v_mfma_f32_16x16x32_bf16 v[160:163], a[32:35], a[104:107], v[160:163]
  ds_read_b64_tr_b16 a[4:5], v17 offset:14464
  v_mfma_f32_16x16x32_bf16 v[164:167], a[32:35], a[108:111], v[164:167]
  ds_read_b64_tr_b16 a[6:7], v17 offset:18048
  v_mfma_f32_16x16x32_bf16 v[168:171], a[32:35], a[112:115], v[168:171]
  buffer_load_dwordx4 a[72:75], v15, s[28:31], s36 offen offset:0 sc1
  v_mfma_f32_16x16x32_bf16 v[172:175], a[32:35], a[116:119], v[172:175]
  v_mfma_f32_16x16x32_bf16 v[176:179], a[36:39], a[104:107], v[176:179]
  ds_read_b64_tr_b16 a[8:9], v17 offset:32
  v_mfma_f32_16x16x32_bf16 v[180:183], a[36:39], a[108:111], v[180:183]
  ds_read_b64_tr_b16 a[10:11], v17 offset:3616
  v_mfma_f32_16x16x32_bf16 v[184:187], a[36:39], a[112:115], v[184:187]
  buffer_load_dwordx4 a[76:79], v15, s[28:31], s36 offen offset:1024 sc1
  v_mfma_f32_16x16x32_bf16 v[188:191], a[36:39], a[116:119], v[188:191]
  s_waitcnt lgkmcnt(10)
  v_mfma_f32_16x16x32_bf16 v[192:195], a[40:43], a[104:107], v[192:195]
  ds_read_b64_tr_b16 a[12:13], v17 offset:14496
  v_mfma_f32_16x16x32_bf16 v[196:199], a[40:43], a[108:111], v[196:199]
  ds_read_b64_tr_b16 a[14:15], v17 offset:18080
  v_mfma_f32_16x16x32_bf16 v[200:203], a[40:43], a[112:115], v[200:203]
  v_mfma_f32_16x16x32_bf16 v[204:207], a[40:43], a[116:119], v[204:207]
  v_mfma_f32_16x16x32_bf16 v[208:211], a[44:47], a[104:107], v[208:211]
  ds_read_b64_tr_b16 a[16:17], v17 offset:64
  v_mfma_f32_16x16x32_bf16 v[212:215], a[44:47], a[108:111], v[212:215]
  ds_read_b64_tr_b16 a[18:19], v17 offset:3648
  v_mfma_f32_16x16x32_bf16 v[216:219], a[44:47], a[112:115], v[216:219]
  buffer_load_dwordx4 v14, s[24:27], s34 offen offset:2048 lds
  v_mfma_f32_16x16x32_bf16 v[220:223], a[44:47], a[116:119], v[220:223]
  s_waitcnt lgkmcnt(10)
  v_mfma_f32_16x16x32_bf16 v[224:227], a[48:51], a[104:107], v[224:227]
  ds_read_b64_tr_b16 a[20:21], v17 offset:14528
  v_mfma_f32_16x16x32_bf16 v[228:231], a[48:51], a[108:111], v[228:231]
  ds_read_b64_tr_b16 a[22:23], v17 offset:18112
  v_mfma_f32_16x16x32_bf16 v[232:235], a[48:51], a[112:115], v[232:235]
  v_mfma_f32_16x16x32_bf16 v[236:239], a[48:51], a[116:119], v[236:239]
  v_mfma_f32_16x16x32_bf16 v[240:243], a[52:55], a[104:107], v[240:243]
  ds_read_b64_tr_b16 a[24:25], v17 offset:96
  v_mfma_f32_16x16x32_bf16 v[244:247], a[52:55], a[108:111], v[244:247]
  ds_read_b64_tr_b16 a[26:27], v17 offset:3680
  v_mfma_f32_16x16x32_bf16 v[248:251], a[52:55], a[112:115], v[248:251]
  v_mfma_f32_16x16x32_bf16 v[252:255], a[52:55], a[116:119], v[252:255]
  s_waitcnt vmcnt(38) lgkmcnt(10)
  v_mfma_f32_16x16x32_bf16 v[32:35], a[0:3], a[120:123], v[32:35]
  ds_read_b64_tr_b16 a[28:29], v17 offset:14560
  v_mfma_f32_16x16x32_bf16 v[36:39], a[0:3], a[124:127], v[36:39]
  ds_read_b64_tr_b16 a[30:31], v17 offset:18144
  v_mfma_f32_16x16x32_bf16 v[40:43], a[0:3], a[128:131], v[40:43]
  buffer_load_dwordx4 a[80:83], v15, s[28:31], s36 offen offset:2048 sc1
  v_mfma_f32_16x16x32_bf16 v[44:47], a[0:3], a[132:135], v[44:47]
  v_mfma_f32_16x16x32_bf16 v[48:51], a[4:7], a[120:123], v[48:51]
  ds_read_b64_tr_b16 a[32:33], v17 offset:128
  v_mfma_f32_16x16x32_bf16 v[52:55], a[4:7], a[124:127], v[52:55]
  ds_read_b64_tr_b16 a[34:35], v17 offset:3712
  v_mfma_f32_16x16x32_bf16 v[56:59], a[4:7], a[128:131], v[56:59]
  buffer_load_dwordx4 a[84:87], v15, s[28:31], s36 offen offset:3072 sc1
  v_mfma_f32_16x16x32_bf16 v[60:63], a[4:7], a[132:135], v[60:63]
  s_mov_b32 s34, 4587520
  s_add_u32 m0, s33, 86400
  s_waitcnt lgkmcnt(10)
  v_mfma_f32_16x16x32_bf16 v[64:67], a[8:11], a[120:123], v[64:67]
  ds_read_b64_tr_b16 a[36:37], v17 offset:14592
  v_mfma_f32_16x16x32_bf16 v[68:71], a[8:11], a[124:127], v[68:71]
  ds_read_b64_tr_b16 a[38:39], v17 offset:18176
  v_mfma_f32_16x16x32_bf16 v[72:75], a[8:11], a[128:131], v[72:75]
  buffer_load_dwordx4 v8, s[24:27], s34 offen offset:0 lds
  v_mfma_f32_16x16x32_bf16 v[76:79], a[8:11], a[132:135], v[76:79]
  v_mfma_f32_16x16x32_bf16 v[80:83], a[12:15], a[120:123], v[80:83]
  ds_read_b64_tr_b16 a[40:41], v17 offset:160
  v_mfma_f32_16x16x32_bf16 v[84:87], a[12:15], a[124:127], v[84:87]
  ds_read_b64_tr_b16 a[42:43], v17 offset:3744
  v_mfma_f32_16x16x32_bf16 v[88:91], a[12:15], a[128:131], v[88:91]
  v_mfma_f32_16x16x32_bf16 v[92:95], a[12:15], a[132:135], v[92:95]
  s_waitcnt lgkmcnt(10)
  v_mfma_f32_16x16x32_bf16 v[96:99], a[16:19], a[120:123], v[96:99]
  ds_read_b64_tr_b16 a[44:45], v17 offset:14624
  v_mfma_f32_16x16x32_bf16 v[100:103], a[16:19], a[124:127], v[100:103]
  ds_read_b64_tr_b16 a[46:47], v17 offset:18208
  v_mfma_f32_16x16x32_bf16 v[104:107], a[16:19], a[128:131], v[104:107]
  buffer_load_dwordx4 v9, s[24:27], s34 offen offset:1024 lds
  v_mfma_f32_16x16x32_bf16 v[108:111], a[16:19], a[132:135], v[108:111]
  v_mfma_f32_16x16x32_bf16 v[112:115], a[20:23], a[120:123], v[112:115]
  ds_read_b64_tr_b16 a[48:49], v17 offset:192
  v_mfma_f32_16x16x32_bf16 v[116:119], a[20:23], a[124:127], v[116:119]
  ds_read_b64_tr_b16 a[50:51], v17 offset:3776
  v_mfma_f32_16x16x32_bf16 v[120:123], a[20:23], a[128:131], v[120:123]
  v_mfma_f32_16x16x32_bf16 v[124:127], a[20:23], a[132:135], v[124:127]
  s_waitcnt lgkmcnt(10)
  v_mfma_f32_16x16x32_bf16 v[128:131], a[24:27], a[120:123], v[128:131]
  ds_read_b64_tr_b16 a[52:53], v17 offset:14656
  v_mfma_f32_16x16x32_bf16 v[132:135], a[24:27], a[124:127], v[132:135]
  ds_read_b64_tr_b16 a[54:55], v17 offset:18240
  v_mfma_f32_16x16x32_bf16 v[136:139], a[24:27], a[128:131], v[136:139]
  v_mfma_f32_16x16x32_bf16 v[140:143], a[24:27], a[132:135], v[140:143]
  v_mfma_f32_16x16x32_bf16 v[144:147], a[28:31], a[120:123], v[144:147]
  ds_read_b64_tr_b16 a[0:1], v17 offset:7168
  v_mfma_f32_16x16x32_bf16 v[148:151], a[28:31], a[124:127], v[148:151]
  ds_read_b64_tr_b16 a[2:3], v17 offset:10752
  s_mov_b32 s36, 73728
  v_mfma_f32_16x16x32_bf16 v[152:155], a[28:31], a[128:131], v[152:155]
  buffer_load_dwordx4 a[88:91], v15, s[28:31], s36 offen offset:0 sc1
  v_mfma_f32_16x16x32_bf16 v[156:159], a[28:31], a[132:135], v[156:159]
  s_waitcnt lgkmcnt(10)
  v_mfma_f32_16x16x32_bf16 v[160:163], a[32:35], a[120:123], v[160:163]
  ds_read_b64_tr_b16 a[4:5], v17 offset:21632
  v_mfma_f32_16x16x32_bf16 v[164:167], a[32:35], a[124:127], v[164:167]
  ds_read_b64_tr_b16 a[6:7], v17 offset:25216
  v_mfma_f32_16x16x32_bf16 v[168:171], a[32:35], a[128:131], v[168:171]
  buffer_load_dwordx4 v10, s[24:27], s34 offen offset:2048 lds
  v_mfma_f32_16x16x32_bf16 v[172:175], a[32:35], a[132:135], v[172:175]
  v_mfma_f32_16x16x32_bf16 v[176:179], a[36:39], a[120:123], v[176:179]
  ds_read_b64_tr_b16 a[8:9], v17 offset:7200
  v_mfma_f32_16x16x32_bf16 v[180:183], a[36:39], a[124:127], v[180:183]
  ds_read_b64_tr_b16 a[10:11], v17 offset:10784
  v_mfma_f32_16x16x32_bf16 v[184:187], a[36:39], a[128:131], v[184:187]
  buffer_load_dwordx4 a[92:95], v15, s[28:31], s36 offen offset:1024 sc1
  v_mfma_f32_16x16x32_bf16 v[188:191], a[36:39], a[132:135], v[188:191]
  s_waitcnt lgkmcnt(10)
  v_mfma_f32_16x16x32_bf16 v[192:195], a[40:43], a[120:123], v[192:195]
  ds_read_b64_tr_b16 a[12:13], v17 offset:21664
  v_mfma_f32_16x16x32_bf16 v[196:199], a[40:43], a[124:127], v[196:199]
  ds_read_b64_tr_b16 a[14:15], v17 offset:25248
  v_mfma_f32_16x16x32_bf16 v[200:203], a[40:43], a[128:131], v[200:203]
  buffer_load_dwordx4 a[96:99], v15, s[28:31], s36 offen offset:2048 sc1
  v_mfma_f32_16x16x32_bf16 v[204:207], a[40:43], a[132:135], v[204:207]
  s_cmp_eq_u32 s75, 2
  s_cselect_b32 s39, s74, 1073741824
  v_mfma_f32_16x16x32_bf16 v[208:211], a[44:47], a[120:123], v[208:211]
  ds_read_b64_tr_b16 a[16:17], v17 offset:7232
  v_mfma_f32_16x16x32_bf16 v[212:215], a[44:47], a[124:127], v[212:215]
  ds_read_b64_tr_b16 a[18:19], v17 offset:10816
  v_mfma_f32_16x16x32_bf16 v[216:219], a[44:47], a[128:131], v[216:219]
  buffer_load_dword v20, v19, s[52:55], s39 offen
  v_mfma_f32_16x16x32_bf16 v[220:223], a[44:47], a[132:135], v[220:223]
  s_waitcnt lgkmcnt(10)
  v_mfma_f32_16x16x32_bf16 v[224:227], a[48:51], a[120:123], v[224:227]
  ds_read_b64_tr_b16 a[20:21], v17 offset:21696
  v_mfma_f32_16x16x32_bf16 v[228:231], a[48:51], a[124:127], v[228:231]
  ds_read_b64_tr_b16 a[22:23], v17 offset:25280
  v_mfma_f32_16x16x32_bf16 v[232:235], a[48:51], a[128:131], v[232:235]
  v_mfma_f32_16x16x32_bf16 v[236:239], a[48:51], a[132:135], v[236:239]
  v_mfma_f32_16x16x32_bf16 v[240:243], a[52:55], a[120:123], v[240:243]
  ds_read_b64_tr_b16 a[24:25], v17 offset:7264
  v_mfma_f32_16x16x32_bf16 v[244:247], a[52:55], a[124:127], v[244:247]
  ds_read_b64_tr_b16 a[26:27], v17 offset:10848
  v_mfma_f32_16x16x32_bf16 v[248:251], a[52:55], a[128:131], v[248:251]
  v_mfma_f32_16x16x32_bf16 v[252:255], a[52:55], a[132:135], v[252:255]
  s_waitcnt vmcnt(40) lgkmcnt(10)
  v_mfma_f32_16x16x32_bf16 v[32:35], a[0:3], a[136:139], v[32:35]
  ds_read_b64_tr_b16 a[28:29], v17 offset:21728
  v_mfma_f32_16x16x32_bf16 v[36:39], a[0:3], a[140:143], v[36:39]
  ds_read_b64_tr_b16 a[30:31], v17 offset:25312
  v_mfma_f32_16x16x32_bf16 v[40:43], a[0:3], a[144:147], v[40:43]
  buffer_load_dwordx4 v11, s[24:27], s34 offen offset:3072 lds
  v_mfma_f32_16x16x32_bf16 v[44:47], a[0:3], a[148:151], v[44:47]
  v_mfma_f32_16x16x32_bf16 v[48:51], a[4:7], a[136:139], v[48:51]
  ds_read_b64_tr_b16 a[32:33], v17 offset:7296
  v_mfma_f32_16x16x32_bf16 v[52:55], a[4:7], a[140:143], v[52:55]
  ds_read_b64_tr_b16 a[34:35], v17 offset:10880
  v_mfma_f32_16x16x32_bf16 v[56:59], a[4:7], a[144:147], v[56:59]
  buffer_load_dwordx4 a[100:103], v15, s[28:31], s36 offen offset:3072 sc1
  v_mfma_f32_16x16x32_bf16 v[60:63], a[4:7], a[148:151], v[60:63]
  s_add_u32 m0, s33, 90496
  s_waitcnt lgkmcnt(10)
  v_mfma_f32_16x16x32_bf16 v[64:67], a[8:11], a[136:139], v[64:67]
  ds_read_b64_tr_b16 a[36:37], v17 offset:21760
  v_mfma_f32_16x16x32_bf16 v[68:71], a[8:11], a[140:143], v[68:71]
  ds_read_b64_tr_b16 a[38:39], v17 offset:25344
  v_mfma_f32_16x16x32_bf16 v[72:75], a[8:11], a[144:147], v[72:75]
  buffer_load_dwordx4 v12, s[24:27], s34 offen offset:0 lds
  v_mfma_f32_16x16x32_bf16 v[76:79], a[8:11], a[148:151], v[76:79]
  v_mfma_f32_16x16x32_bf16 v[80:83], a[12:15], a[136:139], v[80:83]
  ds_read_b64_tr_b16 a[40:41], v17 offset:7328
  v_mfma_f32_16x16x32_bf16 v[84:87], a[12:15], a[140:143], v[84:87]
  ds_read_b64_tr_b16 a[42:43], v17 offset:10912
  v_mfma_f32_16x16x32_bf16 v[88:91], a[12:15], a[144:147], v[88:91]
  v_mfma_f32_16x16x32_bf16 v[92:95], a[12:15], a[148:151], v[92:95]
  s_waitcnt lgkmcnt(10)
  v_mfma_f32_16x16x32_bf16 v[96:99], a[16:19], a[136:139], v[96:99]
  ds_read_b64_tr_b16 a[44:45], v17 offset:21792
  v_mfma_f32_16x16x32_bf16 v[100:103], a[16:19], a[140:143], v[100:103]
  ds_read_b64_tr_b16 a[46:47], v17 offset:25376
  v_mfma_f32_16x16x32_bf16 v[104:107], a[16:19], a[144:147], v[104:107]
  buffer_load_dwordx4 v13, s[24:27], s34 offen offset:1024 lds
  v_mfma_f32_16x16x32_bf16 v[108:111], a[16:19], a[148:151], v[108:111]
  v_mfma_f32_16x16x32_bf16 v[112:115], a[20:23], a[136:139], v[112:115]
  ds_read_b64_tr_b16 a[48:49], v17 offset:7360
  v_mfma_f32_16x16x32_bf16 v[116:119], a[20:23], a[140:143], v[116:119]
  ds_read_b64_tr_b16 a[50:51], v17 offset:10944
  v_mfma_f32_16x16x32_bf16 v[120:123], a[20:23], a[144:147], v[120:123]
  v_mfma_f32_16x16x32_bf16 v[124:127], a[20:23], a[148:151], v[124:127]
  s_waitcnt lgkmcnt(10)
  v_mfma_f32_16x16x32_bf16 v[128:131], a[24:27], a[136:139], v[128:131]
  ds_read_b64_tr_b16 a[52:53], v17 offset:21824
  v_mfma_f32_16x16x32_bf16 v[132:135], a[24:27], a[140:143], v[132:135]
  ds_read_b64_tr_b16 a[54:55], v17 offset:25408
  v_mfma_f32_16x16x32_bf16 v[136:139], a[24:27], a[144:147], v[136:139]
  v_mfma_f32_16x16x32_bf16 v[140:143], a[24:27], a[148:151], v[140:143]
  s_waitcnt vmcnt(46) lgkmcnt(0)
  s_barrier
  v_mfma_f32_16x16x32_bf16 v[144:147], a[28:31], a[136:139], v[144:147]
  ds_read_b64_tr_b16 a[0:1], v4 offset:0
  v_mfma_f32_16x16x32_bf16 v[148:151], a[28:31], a[140:143], v[148:151]
  ds_read_b64_tr_b16 a[2:3], v4 offset:3584
  s_mov_b32 s36, 77824
  v_mfma_f32_16x16x32_bf16 v[152:155], a[28:31], a[144:147], v[152:155]
  buffer_load_dwordx4 a[104:107], v15, s[28:31], s36 offen offset:0 sc1
  v_mfma_f32_16x16x32_bf16 v[156:159], a[28:31], a[148:151], v[156:159]
  s_waitcnt lgkmcnt(10)
  v_mfma_f32_16x16x32_bf16 v[160:163], a[32:35], a[136:139], v[160:163]
  ds_read_b64_tr_b16 a[4:5], v4 offset:14464
  v_mfma_f32_16x16x32_bf16 v[164:167], a[32:35], a[140:143], v[164:167]
  ds_read_b64_tr_b16 a[6:7], v4 offset:18048
  v_mfma_f32_16x16x32_bf16 v[168:171], a[32:35], a[144:147], v[168:171]
  buffer_load_dwordx4 a[108:111], v15, s[28:31], s36 offen offset:1024 sc1
  v_mfma_f32_16x16x32_bf16 v[172:175], a[32:35], a[148:151], v[172:175]
  v_mfma_f32_16x16x32_bf16 v[176:179], a[36:39], a[136:139], v[176:179]
  ds_read_b64_tr_b16 a[8:9], v4 offset:32
  v_mfma_f32_16x16x32_bf16 v[180:183], a[36:39], a[140:143], v[180:183]
  ds_read_b64_tr_b16 a[10:11], v4 offset:3616
  v_mfma_f32_16x16x32_bf16 v[184:187], a[36:39], a[144:147], v[184:187]
  buffer_load_dwordx4 v14, s[24:27], s34 offen offset:2048 lds
  v_mfma_f32_16x16x32_bf16 v[188:191], a[36:39], a[148:151], v[188:191]
  s_waitcnt lgkmcnt(10)
  v_mfma_f32_16x16x32_bf16 v[192:195], a[40:43], a[136:139], v[192:195]
  ds_read_b64_tr_b16 a[12:13], v4 offset:14496
  v_mfma_f32_16x16x32_bf16 v[196:199], a[40:43], a[140:143], v[196:199]
  ds_read_b64_tr_b16 a[14:15], v4 offset:18080
  v_mfma_f32_16x16x32_bf16 v[200:203], a[40:43], a[144:147], v[200:203]
  v_mfma_f32_16x16x32_bf16 v[204:207], a[40:43], a[148:151], v[204:207]
  v_mfma_f32_16x16x32_bf16 v[208:211], a[44:47], a[136:139], v[208:211]
  ds_read_b64_tr_b16 a[16:17], v4 offset:64
  v_mfma_f32_16x16x32_bf16 v[212:215], a[44:47], a[140:143], v[212:215]
  ds_read_b64_tr_b16 a[18:19], v4 offset:3648
  v_mfma_f32_16x16x32_bf16 v[216:219], a[44:47], a[144:147], v[216:219]
  buffer_load_dwordx4 a[112:115], v15, s[28:31], s36 offen offset:2048 sc1
  v_mfma_f32_16x16x32_bf16 v[220:223], a[44:47], a[148:151], v[220:223]
  s_waitcnt lgkmcnt(10)
  v_mfma_f32_16x16x32_bf16 v[224:227], a[48:51], a[136:139], v[224:227]
  ds_read_b64_tr_b16 a[20:21], v4 offset:14528
  v_mfma_f32_16x16x32_bf16 v[228:231], a[48:51], a[140:143], v[228:231]
  ds_read_b64_tr_b16 a[22:23], v4 offset:18112
  v_mfma_f32_16x16x32_bf16 v[232:235], a[48:51], a[144:147], v[232:235]
  v_mfma_f32_16x16x32_bf16 v[236:239], a[48:51], a[148:151], v[236:239]
  v_mfma_f32_16x16x32_bf16 v[240:243], a[52:55], a[136:139], v[240:243]
  ds_read_b64_tr_b16 a[24:25], v4 offset:96
  v_mfma_f32_16x16x32_bf16 v[244:247], a[52:55], a[140:143], v[244:247]
  ds_read_b64_tr_b16 a[26:27], v4 offset:3680
  v_mfma_f32_16x16x32_bf16 v[248:251], a[52:55], a[144:147], v[248:251]
  v_mfma_f32_16x16x32_bf16 v[252:255], a[52:55], a[148:151], v[252:255]
  s_waitcnt vmcnt(39) lgkmcnt(10)
  v_mfma_f32_16x16x32_bf16 v[32:35], a[0:3], a[152:155], v[32:35]
  ds_read_b64_tr_b16 a[28:29], v4 offset:14560
  v_mfma_f32_16x16x32_bf16 v[36:39], a[0:3], a[156:159], v[36:39]
  ds_read_b64_tr_b16 a[30:31], v4 offset:18144
  v_mfma_f32_16x16x32_bf16 v[40:43], a[0:3], a[160:163], v[40:43]
  buffer_load_dwordx4 a[116:119], v15, s[28:31], s36 offen offset:3072 sc1
  v_mfma_f32_16x16x32_bf16 v[44:47], a[0:3], a[164:167], v[44:47]
  s_mov_b32 s34, 5046272
  s_add_u32 m0, s33, 115200
  v_mfma_f32_16x16x32_bf16 v[48:51], a[4:7], a[152:155], v[48:51]
  ds_read_b64_tr_b16 a[32:33], v4 offset:128
  v_mfma_f32_16x16x32_bf16 v[52:55], a[4:7], a[156:159], v[52:55]
  ds_read_b64_tr_b16 a[34:35], v4 offset:3712
  v_mfma_f32_16x16x32_bf16 v[56:59], a[4:7], a[160:163], v[56:59]
  buffer_load_dwordx4 v8, s[24:27], s34 offen offset:0 lds
  v_mfma_f32_16x16x32_bf16 v[60:63], a[4:7], a[164:167], v[60:63]
  s_waitcnt lgkmcnt(10)
  v_mfma_f32_16x16x32_bf16 v[64:67], a[8:11], a[152:155], v[64:67]
  ds_read_b64_tr_b16 a[36:37], v4 offset:14592
  v_mfma_f32_16x16x32_bf16 v[68:71], a[8:11], a[156:159], v[68:71]
  ds_read_b64_tr_b16 a[38:39], v4 offset:18176
  v_mfma_f32_16x16x32_bf16 v[72:75], a[8:11], a[160:163], v[72:75]
  buffer_load_dwordx4 v9, s[24:27], s34 offen offset:1024 lds
  v_mfma_f32_16x16x32_bf16 v[76:79], a[8:11], a[164:167], v[76:79]
  s_mov_b32 s36, 81920
  v_mfma_f32_16x16x32_bf16 v[80:83], a[12:15], a[152:155], v[80:83]
  ds_read_b64_tr_b16 a[40:41], v4 offset:160
  v_mfma_f32_16x16x32_bf16 v[84:87], a[12:15], a[156:159], v[84:87]
  ds_read_b64_tr_b16 a[42:43], v4 offset:3744
  v_mfma_f32_16x16x32_bf16 v[88:91], a[12:15], a[160:163], v[88:91]
  v_mfma_f32_16x16x32_bf16 v[92:95], a[12:15], a[164:167], v[92:95]
  s_waitcnt lgkmcnt(10)
  v_mfma_f32_16x16x32_bf16 v[96:99], a[16:19], a[152:155], v[96:99]
  ds_read_b64_tr_b16 a[44:45], v4 offset:14624
  v_mfma_f32_16x16x32_bf16 v[100:103], a[16:19], a[156:159], v[100:103]
  ds_read_b64_tr_b16 a[46:47], v4 offset:18208
  v_mfma_f32_16x16x32_bf16 v[104:107], a[16:19], a[160:163], v[104:107]
  buffer_load_dwordx4 a[120:123], v15, s[28:31], s36 offen offset:0 sc1
  v_mfma_f32_16x16x32_bf16 v[108:111], a[16:19], a[164:167], v[108:111]
  v_mfma_f32_16x16x32_bf16 v[112:115], a[20:23], a[152:155], v[112:115]
  ds_read_b64_tr_b16 a[48:49], v4 offset:192
  v_mfma_f32_16x16x32_bf16 v[116:119], a[20:23], a[156:159], v[116:119]
  ds_read_b64_tr_b16 a[50:51], v4 offset:3776
  v_mfma_f32_16x16x32_bf16 v[120:123], a[20:23], a[160:163], v[120:123]
  v_mfma_f32_16x16x32_bf16 v[124:127], a[20:23], a[164:167], v[124:127]
  s_waitcnt lgkmcnt(10)
  v_mfma_f32_16x16x32_bf16 v[128:131], a[24:27], a[152:155], v[128:131]
  ds_read_b64_tr_b16 a[52:53], v4 offset:14656
  v_mfma_f32_16x16x32_bf16 v[132:135], a[24:27], a[156:159], v[132:135]
  ds_read_b64_tr_b16 a[54:55], v4 offset:18240
  v_mfma_f32_16x16x32_bf16 v[136:139], a[24:27], a[160:163], v[136:139]
  v_mfma_f32_16x16x32_bf16 v[140:143], a[24:27], a[164:167], v[140:143]
  v_mfma_f32_16x16x32_bf16 v[144:147], a[28:31], a[152:155], v[144:147]
  ds_read_b64_tr_b16 a[0:1], v4 offset:7168
  v_mfma_f32_16x16x32_bf16 v[148:151], a[28:31], a[156:159], v[148:151]
  ds_read_b64_tr_b16 a[2:3], v4 offset:10752
  v_mfma_f32_16x16x32_bf16 v[152:155], a[28:31], a[160:163], v[152:155]
  buffer_load_dwordx4 v10, s[24:27], s34 offen offset:2048 lds
  v_mfma_f32_16x16x32_bf16 v[156:159], a[28:31], a[164:167], v[156:159]
  s_waitcnt lgkmcnt(10)
  v_mfma_f32_16x16x32_bf16 v[160:163], a[32:35], a[152:155], v[160:163]
  ds_read_b64_tr_b16 a[4:5], v4 offset:21632
  v_mfma_f32_16x16x32_bf16 v[164:167], a[32:35], a[156:159], v[164:167]
  ds_read_b64_tr_b16 a[6:7], v4 offset:25216
  v_mfma_f32_16x16x32_bf16 v[168:171], a[32:35], a[160:163], v[168:171]
  buffer_load_dwordx4 a[124:127], v15, s[28:31], s36 offen offset:1024 sc1
  v_mfma_f32_16x16x32_bf16 v[172:175], a[32:35], a[164:167], v[172:175]
  v_mfma_f32_16x16x32_bf16 v[176:179], a[36:39], a[152:155], v[176:179]
  ds_read_b64_tr_b16 a[8:9], v4 offset:7200
  v_mfma_f32_16x16x32_bf16 v[180:183], a[36:39], a[156:159], v[180:183]
  ds_read_b64_tr_b16 a[10:11], v4 offset:10784
  v_mfma_f32_16x16x32_bf16 v[184:187], a[36:39], a[160:163], v[184:187]
  buffer_load_dwordx4 a[128:131], v15, s[28:31], s36 offen offset:2048 sc1
  v_mfma_f32_16x16x32_bf16 v[188:191], a[36:39], a[164:167], v[188:191]
  s_waitcnt lgkmcnt(10)
  v_mfma_f32_16x16x32_bf16 v[192:195], a[40:43], a[152:155], v[192:195]
  ds_read_b64_tr_b16 a[12:13], v4 offset:21664
  v_mfma_f32_16x16x32_bf16 v[196:199], a[40:43], a[156:159], v[196:199]
  ds_read_b64_tr_b16 a[14:15], v4 offset:25248
  v_mfma_f32_16x16x32_bf16 v[200:203], a[40:43], a[160:163], v[200:203]
  buffer_load_dwordx4 v11, s[24:27], s34 offen offset:3072 lds
  v_mfma_f32_16x16x32_bf16 v[204:207], a[40:43], a[164:167], v[204:207]
  s_cmp_eq_u32 s75, 3
  s_cselect_b32 s39, s74, 1073741824
  v_mfma_f32_16x16x32_bf16 v[208:211], a[44:47], a[152:155], v[208:211]
  ds_read_b64_tr_b16 a[16:17], v4 offset:7232
  v_mfma_f32_16x16x32_bf16 v[212:215], a[44:47], a[156:159], v[212:215]
  ds_read_b64_tr_b16 a[18:19], v4 offset:10816
  v_mfma_f32_16x16x32_bf16 v[216:219], a[44:47], a[160:163], v[216:219]
  buffer_load_dword v20, v19, s[52:55], s39 offen
  v_mfma_f32_16x16x32_bf16 v[220:223], a[44:47], a[164:167], v[220:223]
  s_waitcnt lgkmcnt(10)
  v_mfma_f32_16x16x32_bf16 v[224:227], a[48:51], a[152:155], v[224:227]
  ds_read_b64_tr_b16 a[20:21], v4 offset:21696
  v_mfma_f32_16x16x32_bf16 v[228:231], a[48:51], a[156:159], v[228:231]
  ds_read_b64_tr_b16 a[22:23], v4 offset:25280
  v_mfma_f32_16x16x32_bf16 v[232:235], a[48:51], a[160:163], v[232:235]
  v_mfma_f32_16x16x32_bf16 v[236:239], a[48:51], a[164:167], v[236:239]
  v_mfma_f32_16x16x32_bf16 v[240:243], a[52:55], a[152:155], v[240:243]
  ds_read_b64_tr_b16 a[24:25], v4 offset:7264
  v_mfma_f32_16x16x32_bf16 v[244:247], a[52:55], a[156:159], v[244:247]
  ds_read_b64_tr_b16 a[26:27], v4 offset:10848
  v_mfma_f32_16x16x32_bf16 v[248:251], a[52:55], a[160:163], v[248:251]
  v_mfma_f32_16x16x32_bf16 v[252:255], a[52:55], a[164:167], v[252:255]
  s_waitcnt vmcnt(41) lgkmcnt(10)
  v_mfma_f32_16x16x32_bf16 v[32:35], a[0:3], a[168:171], v[32:35]
  ds_read_b64_tr_b16 a[28:29], v4 offset:21728
  v_mfma_f32_16x16x32_bf16 v[36:39], a[0:3], a[172:175], v[36:39]
  ds_read_b64_tr_b16 a[30:31], v4 offset:25312
  v_mfma_f32_16x16x32_bf16 v[40:43], a[0:3], a[176:179], v[40:43]
  buffer_load_dwordx4 a[132:135], v15, s[28:31], s36 offen offset:3072 sc1
  v_mfma_f32_16x16x32_bf16 v[44:47], a[0:3], a[180:183], v[44:47]
  s_add_u32 m0, s33, 119296
  v_mfma_f32_16x16x32_bf16 v[48:51], a[4:7], a[168:171], v[48:51]
  ds_read_b64_tr_b16 a[32:33], v4 offset:7296
  v_mfma_f32_16x16x32_bf16 v[52:55], a[4:7], a[172:175], v[52:55]
  ds_read_b64_tr_b16 a[34:35], v4 offset:10880
  v_mfma_f32_16x16x32_bf16 v[56:59], a[4:7], a[176:179], v[56:59]
  buffer_load_dwordx4 v12, s[24:27], s34 offen offset:0 lds
  v_mfma_f32_16x16x32_bf16 v[60:63], a[4:7], a[180:183], v[60:63]
  s_waitcnt lgkmcnt(10)
  v_mfma_f32_16x16x32_bf16 v[64:67], a[8:11], a[168:171], v[64:67]
  ds_read_b64_tr_b16 a[36:37], v4 offset:21760
  v_mfma_f32_16x16x32_bf16 v[68:71], a[8:11], a[172:175], v[68:71]
  ds_read_b64_tr_b16 a[38:39], v4 offset:25344
  v_mfma_f32_16x16x32_bf16 v[72:75], a[8:11], a[176:179], v[72:75]
  buffer_load_dwordx4 v13, s[24:27], s34 offen offset:1024 lds
  v_mfma_f32_16x16x32_bf16 v[76:79], a[8:11], a[180:183], v[76:79]
  s_mov_b32 s36, 86016
  v_mfma_f32_16x16x32_bf16 v[80:83], a[12:15], a[168:171], v[80:83]
  ds_read_b64_tr_b16 a[40:41], v4 offset:7328
  v_mfma_f32_16x16x32_bf16 v[84:87], a[12:15], a[172:175], v[84:87]
  ds_read_b64_tr_b16 a[42:43], v4 offset:10912
  v_mfma_f32_16x16x32_bf16 v[88:91], a[12:15], a[176:179], v[88:91]
  v_mfma_f32_16x16x32_bf16 v[92:95], a[12:15], a[180:183], v[92:95]
  s_waitcnt lgkmcnt(10)
  v_mfma_f32_16x16x32_bf16 v[96:99], a[16:19], a[168:171], v[96:99]
  ds_read_b64_tr_b16 a[44:45], v4 offset:21792
  v_mfma_f32_16x16x32_bf16 v[100:103], a[16:19], a[172:175], v[100:103]
  ds_read_b64_tr_b16 a[46:47], v4 offset:25376
  v_mfma_f32_16x16x32_bf16 v[104:107], a[16:19], a[176:179], v[104:107]
  buffer_load_dwordx4 a[136:139], v15, s[28:31], s36 offen offset:0 sc1
  v_mfma_f32_16x16x32_bf16 v[108:111], a[16:19], a[180:183], v[108:111]
  v_mfma_f32_16x16x32_bf16 v[112:115], a[20:23], a[168:171], v[112:115]
  ds_read_b64_tr_b16 a[48:49], v4 offset:7360
  v_mfma_f32_16x16x32_bf16 v[116:119], a[20:23], a[172:175], v[116:119]
  ds_read_b64_tr_b16 a[50:51], v4 offset:10944
  v_mfma_f32_16x16x32_bf16 v[120:123], a[20:23], a[176:179], v[120:123]
  v_mfma_f32_16x16x32_bf16 v[124:127], a[20:23], a[180:183], v[124:127]
  s_waitcnt lgkmcnt(10)
  v_mfma_f32_16x16x32_bf16 v[128:131], a[24:27], a[168:171], v[128:131]
  ds_read_b64_tr_b16 a[52:53], v4 offset:21824
  v_mfma_f32_16x16x32_bf16 v[132:135], a[24:27], a[172:175], v[132:135]
  ds_read_b64_tr_b16 a[54:55], v4 offset:25408
  v_mfma_f32_16x16x32_bf16 v[136:139], a[24:27], a[176:179], v[136:139]
  v_mfma_f32_16x16x32_bf16 v[140:143], a[24:27], a[180:183], v[140:143]
  s_waitcnt vmcnt(47) lgkmcnt(0)
  s_barrier
  v_mfma_f32_16x16x32_bf16 v[144:147], a[28:31], a[168:171], v[144:147]
  ds_read_b64_tr_b16 a[0:1], v5 offset:0
  v_mfma_f32_16x16x32_bf16 v[148:151], a[28:31], a[172:175], v[148:151]
  ds_read_b64_tr_b16 a[2:3], v5 offset:3584
  v_mfma_f32_16x16x32_bf16 v[152:155], a[28:31], a[176:179], v[152:155]
  buffer_load_dwordx4 a[140:143], v15, s[28:31], s36 offen offset:1024 sc1
  v_mfma_f32_16x16x32_bf16 v[156:159], a[28:31], a[180:183], v[156:159]
  s_waitcnt lgkmcnt(10)
  v_mfma_f32_16x16x32_bf16 v[160:163], a[32:35], a[168:171], v[160:163]
  ds_read_b64_tr_b16 a[4:5], v5 offset:14464
  v_mfma_f32_16x16x32_bf16 v[164:167], a[32:35], a[172:175], v[164:167]
  ds_read_b64_tr_b16 a[6:7], v5 offset:18048
  v_mfma_f32_16x16x32_bf16 v[168:171], a[32:35], a[176:179], v[168:171]
  buffer_load_dwordx4 v14, s[24:27], s34 offen offset:2048 lds
  v_mfma_f32_16x16x32_bf16 v[172:175], a[32:35], a[180:183], v[172:175]
  v_mfma_f32_16x16x32_bf16 v[176:179], a[36:39], a[168:171], v[176:179]
  ds_read_b64_tr_b16 a[8:9], v5 offset:32
  v_mfma_f32_16x16x32_bf16 v[180:183], a[36:39], a[172:175], v[180:183]
  ds_read_b64_tr_b16 a[10:11], v5 offset:3616
  v_mfma_f32_16x16x32_bf16 v[184:187], a[36:39], a[176:179], v[184:187]
  buffer_load_dwordx4 a[144:147], v15, s[28:31], s36 offen offset:2048 sc1
  v_mfma_f32_16x16x32_bf16 v[188:191], a[36:39], a[180:183], v[188:191]
  s_waitcnt lgkmcnt(10)
  v_mfma_f32_16x16x32_bf16 v[192:195], a[40:43], a[168:171], v[192:195]
  ds_read_b64_tr_b16 a[12:13], v5 offset:14496
  v_mfma_f32_16x16x32_bf16 v[196:199], a[40:43], a[172:175], v[196:199]
  ds_read_b64_tr_b16 a[14:15], v5 offset:18080
  v_mfma_f32_16x16x32_bf16 v[200:203], a[40:43], a[176:179], v[200:203]
  v_mfma_f32_16x16x32_bf16 v[204:207], a[40:43], a[180:183], v[204:207]
  v_mfma_f32_16x16x32_bf16 v[208:211], a[44:47], a[168:171], v[208:211]
  ds_read_b64_tr_b16 a[16:17], v5 offset:64
  v_mfma_f32_16x16x32_bf16 v[212:215], a[44:47], a[172:175], v[212:215]
  ds_read_b64_tr_b16 a[18:19], v5 offset:3648
  v_mfma_f32_16x16x32_bf16 v[216:219], a[44:47], a[176:179], v[216:219]
  buffer_load_dwordx4 a[148:151], v15, s[28:31], s36 offen offset:3072 sc1
  v_mfma_f32_16x16x32_bf16 v[220:223], a[44:47], a[180:183], v[220:223]
  s_waitcnt lgkmcnt(10)
  v_mfma_f32_16x16x32_bf16 v[224:227], a[48:51], a[168:171], v[224:227]
  ds_read_b64_tr_b16 a[20:21], v5 offset:14528
  v_mfma_f32_16x16x32_bf16 v[228:231], a[48:51], a[172:175], v[228:231]
  ds_read_b64_tr_b16 a[22:23], v5 offset:18112
  v_mfma_f32_16x16x32_bf16 v[232:235], a[48:51], a[176:179], v[232:235]
  v_mfma_f32_16x16x32_bf16 v[236:239], a[48:51], a[180:183], v[236:239]
  v_mfma_f32_16x16x32_bf16 v[240:243], a[52:55], a[168:171], v[240:243]
  ds_read_b64_tr_b16 a[24:25], v5 offset:96
  v_mfma_f32_16x16x32_bf16 v[244:247], a[52:55], a[172:175], v[244:247]
  ds_read_b64_tr_b16 a[26:27], v5 offset:3680
  v_mfma_f32_16x16x32_bf16 v[248:251], a[52:55], a[176:179], v[248:251]
  v_mfma_f32_16x16x32_bf16 v[252:255], a[52:55], a[180:183], v[252:255]
  s_waitcnt vmcnt(39) lgkmcnt(10)
  v_mfma_f32_16x16x32_bf16 v[32:35], a[0:3], a[56:59], v[32:35]
  ds_read_b64_tr_b16 a[28:29], v5 offset:14560
  v_mfma_f32_16x16x32_bf16 v[36:39], a[0:3], a[60:63], v[36:39]
  ds_read_b64_tr_b16 a[30:31], v5 offset:18144
  s_mov_b32 s34, 5505024
  s_add_u32 m0, s33, 0
  v_mfma_f32_16x16x32_bf16 v[40:43], a[0:3], a[64:67], v[40:43]
  buffer_load_dwordx4 v8, s[24:27], s34 offen offset:0 lds
  v_mfma_f32_16x16x32_bf16 v[44:47], a[0:3], a[68:71], v[44:47]
  v_mfma_f32_16x16x32_bf16 v[48:51], a[4:7], a[56:59], v[48:51]
  ds_read_b64_tr_b16 a[32:33], v5 offset:128
  v_mfma_f32_16x16x32_bf16 v[52:55], a[4:7], a[60:63], v[52:55]
  ds_read_b64_tr_b16 a[34:35], v5 offset:3712
  v_mfma_f32_16x16x32_bf16 v[56:59], a[4:7], a[64:67], v[56:59]
  buffer_load_dwordx4 v9, s[24:27], s34 offen offset:1024 lds
  v_mfma_f32_16x16x32_bf16 v[60:63], a[4:7], a[68:71], v[60:63]
  s_mov_b32 s36, 90112
  s_waitcnt lgkmcnt(10)
  v_mfma_f32_16x16x32_bf16 v[64:67], a[8:11], a[56:59], v[64:67]
  ds_read_b64_tr_b16 a[36:37], v5 offset:14592
  v_mfma_f32_16x16x32_bf16 v[68:71], a[8:11], a[60:63], v[68:71]
  ds_read_b64_tr_b16 a[38:39], v5 offset:18176
  v_mfma_f32_16x16x32_bf16 v[72:75], a[8:11], a[64:67], v[72:75]
  buffer_load_dwordx4 a[152:155], v15, s[28:31], s36 offen offset:0 sc1
  v_mfma_f32_16x16x32_bf16 v[76:79], a[8:11], a[68:71], v[76:79]
  v_mfma_f32_16x16x32_bf16 v[80:83], a[12:15], a[56:59], v[80:83]
  ds_read_b64_tr_b16 a[40:41], v5 offset:160
  v_mfma_f32_16x16x32_bf16 v[84:87], a[12:15], a[60:63], v[84:87]
  ds_read_b64_tr_b16 a[42:43], v5 offset:3744
  v_mfma_f32_16x16x32_bf16 v[88:91], a[12:15], a[64:67], v[88:91]
  v_mfma_f32_16x16x32_bf16 v[92:95], a[12:15], a[68:71], v[92:95]
  s_waitcnt lgkmcnt(10)
  v_mfma_f32_16x16x32_bf16 v[96:99], a[16:19], a[56:59], v[96:99]
  ds_read_b64_tr_b16 a[44:45], v5 offset:14624
  v_mfma_f32_16x16x32_bf16 v[100:103], a[16:19], a[60:63], v[100:103]
  ds_read_b64_tr_b16 a[46:47], v5 offset:18208
  v_mfma_f32_16x16x32_bf16 v[104:107], a[16:19], a[64:67], v[104:107]
  buffer_load_dwordx4 v10, s[24:27], s34 offen offset:2048 lds
  v_mfma_f32_16x16x32_bf16 v[108:111], a[16:19], a[68:71], v[108:111]
  v_mfma_f32_16x16x32_bf16 v[112:115], a[20:23], a[56:59], v[112:115]
  ds_read_b64_tr_b16 a[48:49], v5 offset:192
  v_mfma_f32_16x16x32_bf16 v[116:119], a[20:23], a[60:63], v[116:119]
  ds_read_b64_tr_b16 a[50:51], v5 offset:3776
  v_mfma_f32_16x16x32_bf16 v[120:123], a[20:23], a[64:67], v[120:123]
  v_mfma_f32_16x16x32_bf16 v[124:127], a[20:23], a[68:71], v[124:127]
  s_waitcnt lgkmcnt(10)
  v_mfma_f32_16x16x32_bf16 v[128:131], a[24:27], a[56:59], v[128:131]
  ds_read_b64_tr_b16 a[52:53], v5 offset:14656
  v_mfma_f32_16x16x32_bf16 v[132:135], a[24:27], a[60:63], v[132:135]
  ds_read_b64_tr_b16 a[54:55], v5 offset:18240
  v_mfma_f32_16x16x32_bf16 v[136:139], a[24:27], a[64:67], v[136:139]
  v_mfma_f32_16x16x32_bf16 v[140:143], a[24:27], a[68:71], v[140:143]
  v_mfma_f32_16x16x32_bf16 v[144:147], a[28:31], a[56:59], v[144:147]
  ds_read_b64_tr_b16 a[0:1], v5 offset:7168
  v_mfma_f32_16x16x32_bf16 v[148:151], a[28:31], a[60:63], v[148:151]
  ds_read_b64_tr_b16 a[2:3], v5 offset:10752
  v_mfma_f32_16x16x32_bf16 v[152:155], a[28:31], a[64:67], v[152:155]
  buffer_load_dwordx4 a[156:159], v15, s[28:31], s36 offen offset:1024 sc1
  v_mfma_f32_16x16x32_bf16 v[156:159], a[28:31], a[68:71], v[156:159]
  s_waitcnt lgkmcnt(10)
  v_mfma_f32_16x16x32_bf16 v[160:163], a[32:35], a[56:59], v[160:163]
  ds_read_b64_tr_b16 a[4:5], v5 offset:21632
  v_mfma_f32_16x16x32_bf16 v[164:167], a[32:35], a[60:63], v[164:167]
  ds_read_b64_tr_b16 a[6:7], v5 offset:25216
  v_mfma_f32_16x16x32_bf16 v[168:171], a[32:35], a[64:67], v[168:171]
  buffer_load_dwordx4 a[160:163], v15, s[28:31], s36 offen offset:2048 sc1
  v_mfma_f32_16x16x32_bf16 v[172:175], a[32:35], a[68:71], v[172:175]
  v_mfma_f32_16x16x32_bf16 v[176:179], a[36:39], a[56:59], v[176:179]
  ds_read_b64_tr_b16 a[8:9], v5 offset:7200
  v_mfma_f32_16x16x32_bf16 v[180:183], a[36:39], a[60:63], v[180:183]
  ds_read_b64_tr_b16 a[10:11], v5 offset:10784
  v_mfma_f32_16x16x32_bf16 v[184:187], a[36:39], a[64:67], v[184:187]
  buffer_load_dwordx4 v11, s[24:27], s34 offen offset:3072 lds
  v_mfma_f32_16x16x32_bf16 v[188:191], a[36:39], a[68:71], v[188:191]
  s_waitcnt lgkmcnt(10)
  v_mfma_f32_16x16x32_bf16 v[192:195], a[40:43], a[56:59], v[192:195]
  ds_read_b64_tr_b16 a[12:13], v5 offset:21664
  v_mfma_f32_16x16x32_bf16 v[196:199], a[40:43], a[60:63], v[196:199]
  ds_read_b64_tr_b16 a[14:15], v5 offset:25248
  v_mfma_f32_16x16x32_bf16 v[200:203], a[40:43], a[64:67], v[200:203]
  buffer_load_dwordx4 a[164:167], v15, s[28:31], s36 offen offset:3072 sc1
  v_mfma_f32_16x16x32_bf16 v[204:207], a[40:43], a[68:71], v[204:207]
  s_cmp_eq_u32 s75, 4
  s_cselect_b32 s39, s74, 1073741824
  v_mfma_f32_16x16x32_bf16 v[208:211], a[44:47], a[56:59], v[208:211]
  ds_read_b64_tr_b16 a[16:17], v5 offset:7232
  v_mfma_f32_16x16x32_bf16 v[212:215], a[44:47], a[60:63], v[212:215]
  ds_read_b64_tr_b16 a[18:19], v5 offset:10816
  v_mfma_f32_16x16x32_bf16 v[216:219], a[44:47], a[64:67], v[216:219]
  buffer_load_dword v20, v19, s[52:55], s39 offen
  v_mfma_f32_16x16x32_bf16 v[220:223], a[44:47], a[68:71], v[220:223]
  s_waitcnt lgkmcnt(10)
  v_mfma_f32_16x16x32_bf16 v[224:227], a[48:51], a[56:59], v[224:227]
  ds_read_b64_tr_b16 a[20:21], v5 offset:21696
  v_mfma_f32_16x16x32_bf16 v[228:231], a[48:51], a[60:63], v[228:231]
  ds_read_b64_tr_b16 a[22:23], v5 offset:25280
  v_mfma_f32_16x16x32_bf16 v[232:235], a[48:51], a[64:67], v[232:235]
  v_mfma_f32_16x16x32_bf16 v[236:239], a[48:51], a[68:71], v[236:239]
  v_mfma_f32_16x16x32_bf16 v[240:243], a[52:55], a[56:59], v[240:243]
  ds_read_b64_tr_b16 a[24:25], v5 offset:7264
  v_mfma_f32_16x16x32_bf16 v[244:247], a[52:55], a[60:63], v[244:247]
  ds_read_b64_tr_b16 a[26:27], v5 offset:10848
  v_mfma_f32_16x16x32_bf16 v[248:251], a[52:55], a[64:67], v[248:251]
  v_mfma_f32_16x16x32_bf16 v[252:255], a[52:55], a[68:71], v[252:255]
  s_waitcnt vmcnt(41) lgkmcnt(10)
  v_mfma_f32_16x16x32_bf16 v[32:35], a[0:3], a[72:75], v[32:35]
  ds_read_b64_tr_b16 a[28:29], v5 offset:21728
  v_mfma_f32_16x16x32_bf16 v[36:39], a[0:3], a[76:79], v[36:39]
  ds_read_b64_tr_b16 a[30:31], v5 offset:25312
  s_add_u32 m0, s33, 4096
  v_mfma_f32_16x16x32_bf16 v[40:43], a[0:3], a[80:83], v[40:43]
  buffer_load_dwordx4 v12, s[24:27], s34 offen offset:0 lds
  v_mfma_f32_16x16x32_bf16 v[44:47], a[0:3], a[84:87], v[44:47]
  v_mfma_f32_16x16x32_bf16 v[48:51], a[4:7], a[72:75], v[48:51]
  ds_read_b64_tr_b16 a[32:33], v5 offset:7296
  v_mfma_f32_16x16x32_bf16 v[52:55], a[4:7], a[76:79], v[52:55]
  ds_read_b64_tr_b16 a[34:35], v5 offset:10880
  v_mfma_f32_16x16x32_bf16 v[56:59], a[4:7], a[80:83], v[56:59]
  buffer_load_dwordx4 v13, s[24:27], s34 offen offset:1024 lds
  v_mfma_f32_16x16x32_bf16 v[60:63], a[4:7], a[84:87], v[60:63]
  s_mov_b32 s36, 94208
  s_waitcnt lgkmcnt(10)
  v_mfma_f32_16x16x32_bf16 v[64:67], a[8:11], a[72:75], v[64:67]
  ds_read_b64_tr_b16 a[36:37], v5 offset:21760
  v_mfma_f32_16x16x32_bf16 v[68:71], a[8:11], a[76:79], v[68:71]
  ds_read_b64_tr_b16 a[38:39], v5 offset:25344
  v_mfma_f32_16x16x32_bf16 v[72:75], a[8:11], a[80:83], v[72:75]
  buffer_load_dwordx4 a[168:171], v15, s[28:31], s36 offen offset:0 sc1
  v_mfma_f32_16x16x32_bf16 v[76:79], a[8:11], a[84:87], v[76:79]
  v_mfma_f32_16x16x32_bf16 v[80:83], a[12:15], a[72:75], v[80:83]
  ds_read_b64_tr_b16 a[40:41], v5 offset:7328
  v_mfma_f32_16x16x32_bf16 v[84:87], a[12:15], a[76:79], v[84:87]
  ds_read_b64_tr_b16 a[42:43], v5 offset:10912
  v_mfma_f32_16x16x32_bf16 v[88:91], a[12:15], a[80:83], v[88:91]
  v_mfma_f32_16x16x32_bf16 v[92:95], a[12:15], a[84:87], v[92:95]
  s_waitcnt lgkmcnt(10)
  v_mfma_f32_16x16x32_bf16 v[96:99], a[16:19], a[72:75], v[96:99]
  ds_read_b64_tr_b16 a[44:45], v5 offset:21792
  v_mfma_f32_16x16x32_bf16 v[100:103], a[16:19], a[76:79], v[100:103]
  ds_read_b64_tr_b16 a[46:47], v5 offset:25376
  v_mfma_f32_16x16x32_bf16 v[104:107], a[16:19], a[80:83], v[104:107]
  buffer_load_dwordx4 a[172:175], v15, s[28:31], s36 offen offset:1024 sc1
  v_mfma_f32_16x16x32_bf16 v[108:111], a[16:19], a[84:87], v[108:111]
  v_mfma_f32_16x16x32_bf16 v[112:115], a[20:23], a[72:75], v[112:115]
  ds_read_b64_tr_b16 a[48:49], v5 offset:7360
  v_mfma_f32_16x16x32_bf16 v[116:119], a[20:23], a[76:79], v[116:119]
  ds_read_b64_tr_b16 a[50:51], v5 offset:10944
  v_mfma_f32_16x16x32_bf16 v[120:123], a[20:23], a[80:83], v[120:123]
  v_mfma_f32_16x16x32_bf16 v[124:127], a[20:23], a[84:87], v[124:127]
  s_waitcnt lgkmcnt(10)
  v_mfma_f32_16x16x32_bf16 v[128:131], a[24:27], a[72:75], v[128:131]
  ds_read_b64_tr_b16 a[52:53], v5 offset:21824
  v_mfma_f32_16x16x32_bf16 v[132:135], a[24:27], a[76:79], v[132:135]
  ds_read_b64_tr_b16 a[54:55], v5 offset:25408
  v_mfma_f32_16x16x32_bf16 v[136:139], a[24:27], a[80:83], v[136:139]
  v_mfma_f32_16x16x32_bf16 v[140:143], a[24:27], a[84:87], v[140:143]
  s_waitcnt vmcnt(47) lgkmcnt(0)
  s_barrier
  v_mfma_f32_16x16x32_bf16 v[144:147], a[28:31], a[72:75], v[144:147]
  ds_read_b64_tr_b16 a[0:1], v6 offset:0
  v_mfma_f32_16x16x32_bf16 v[148:151], a[28:31], a[76:79], v[148:151]
  ds_read_b64_tr_b16 a[2:3], v6 offset:3584
  v_mfma_f32_16x16x32_bf16 v[152:155], a[28:31], a[80:83], v[152:155]
  buffer_load_dwordx4 v14, s[24:27], s34 offen offset:2048 lds
  v_mfma_f32_16x16x32_bf16 v[156:159], a[28:31], a[84:87], v[156:159]
  s_waitcnt lgkmcnt(10)
  v_mfma_f32_16x16x32_bf16 v[160:163], a[32:35], a[72:75], v[160:163]
  ds_read_b64_tr_b16 a[4:5], v6 offset:14464
  v_mfma_f32_16x16x32_bf16 v[164:167], a[32:35], a[76:79], v[164:167]
  ds_read_b64_tr_b16 a[6:7], v6 offset:18048
  v_mfma_f32_16x16x32_bf16 v[168:171], a[32:35], a[80:83], v[168:171]
  buffer_load_dwordx4 a[176:179], v15, s[28:31], s36 offen offset:2048 sc1
  v_mfma_f32_16x16x32_bf16 v[172:175], a[32:35], a[84:87], v[172:175]
  v_mfma_f32_16x16x32_bf16 v[176:179], a[36:39], a[72:75], v[176:179]
  ds_read_b64_tr_b16 a[8:9], v6 offset:32
  v_mfma_f32_16x16x32_bf16 v[180:183], a[36:39], a[76:79], v[180:183]
  ds_read_b64_tr_b16 a[10:11], v6 offset:3616
  v_mfma_f32_16x16x32_bf16 v[184:187], a[36:39], a[80:83], v[184:187]
  buffer_load_dwordx4 a[180:183], v15, s[28:31], s36 offen offset:3072 sc1
  v_mfma_f32_16x16x32_bf16 v[188:191], a[36:39], a[84:87], v[188:191]
  s_mov_b32 s36, 98304
  s_waitcnt lgkmcnt(10)
  v_mfma_f32_16x16x32_bf16 v[192:195], a[40:43], a[72:75], v[192:195]
  ds_read_b64_tr_b16 a[12:13], v6 offset:14496
  v_mfma_f32_16x16x32_bf16 v[196:199], a[40:43], a[76:79], v[196:199]
  ds_read_b64_tr_b16 a[14:15], v6 offset:18080
  v_mfma_f32_16x16x32_bf16 v[200:203], a[40:43], a[80:83], v[200:203]
  v_mfma_f32_16x16x32_bf16 v[204:207], a[40:43], a[84:87], v[204:207]
  v_mfma_f32_16x16x32_bf16 v[208:211], a[44:47], a[72:75], v[208:211]
  ds_read_b64_tr_b16 a[16:17], v6 offset:64
  v_mfma_f32_16x16x32_bf16 v[212:215], a[44:47], a[76:79], v[212:215]
  ds_read_b64_tr_b16 a[18:19], v6 offset:3648
  v_mfma_f32_16x16x32_bf16 v[216:219], a[44:47], a[80:83], v[216:219]
  buffer_load_dwordx4 a[56:59], v15, s[28:31], s36 offen offset:0 sc1
  v_mfma_f32_16x16x32_bf16 v[220:223], a[44:47], a[84:87], v[220:223]
  s_waitcnt lgkmcnt(10)
  v_mfma_f32_16x16x32_bf16 v[224:227], a[48:51], a[72:75], v[224:227]
  ds_read_b64_tr_b16 a[20:21], v6 offset:14528
  v_mfma_f32_16x16x32_bf16 v[228:231], a[48:51], a[76:79], v[228:231]
  ds_read_b64_tr_b16 a[22:23], v6 offset:18112
  v_mfma_f32_16x16x32_bf16 v[232:235], a[48:51], a[80:83], v[232:235]
  v_mfma_f32_16x16x32_bf16 v[236:239], a[48:51], a[84:87], v[236:239]
  v_mfma_f32_16x16x32_bf16 v[240:243], a[52:55], a[72:75], v[240:243]
  ds_read_b64_tr_b16 a[24:25], v6 offset:96
  v_mfma_f32_16x16x32_bf16 v[244:247], a[52:55], a[76:79], v[244:247]
  ds_read_b64_tr_b16 a[26:27], v6 offset:3680
  v_mfma_f32_16x16x32_bf16 v[248:251], a[52:55], a[80:83], v[248:251]
  v_mfma_f32_16x16x32_bf16 v[252:255], a[52:55], a[84:87], v[252:255]
  s_waitcnt vmcnt(40) lgkmcnt(10)
  v_mfma_f32_16x16x32_bf16 v[32:35], a[0:3], a[88:91], v[32:35]
  ds_read_b64_tr_b16 a[28:29], v6 offset:14560
  v_mfma_f32_16x16x32_bf16 v[36:39], a[0:3], a[92:95], v[36:39]
  ds_read_b64_tr_b16 a[30:31], v6 offset:18144
  s_mov_b32 s34, 5963776
  s_add_u32 m0, s33, 28800
  v_mfma_f32_16x16x32_bf16 v[40:43], a[0:3], a[96:99], v[40:43]
  buffer_load_dwordx4 v8, s[24:27], s34 offen offset:0 lds
  v_mfma_f32_16x16x32_bf16 v[44:47], a[0:3], a[100:103], v[44:47]
  v_mfma_f32_16x16x32_bf16 v[48:51], a[4:7], a[88:91], v[48:51]
  ds_read_b64_tr_b16 a[32:33], v6 offset:128
  v_mfma_f32_16x16x32_bf16 v[52:55], a[4:7], a[92:95], v[52:55]
  ds_read_b64_tr_b16 a[34:35], v6 offset:3712
  v_mfma_f32_16x16x32_bf16 v[56:59], a[4:7], a[96:99], v[56:59]
  buffer_load_dwordx4 v9, s[24:27], s34 offen offset:1024 lds
  v_mfma_f32_16x16x32_bf16 v[60:63], a[4:7], a[100:103], v[60:63]
  s_waitcnt lgkmcnt(10)
  v_mfma_f32_16x16x32_bf16 v[64:67], a[8:11], a[88:91], v[64:67]
  ds_read_b64_tr_b16 a[36:37], v6 offset:14592
  v_mfma_f32_16x16x32_bf16 v[68:71], a[8:11], a[92:95], v[68:71]
  ds_read_b64_tr_b16 a[38:39], v6 offset:18176
  v_mfma_f32_16x16x32_bf16 v[72:75], a[8:11], a[96:99], v[72:75]
  buffer_load_dwordx4 v10, s[24:27], s34 offen offset:2048 lds
  v_mfma_f32_16x16x32_bf16 v[76:79], a[8:11], a[100:103], v[76:79]
  v_mfma_f32_16x16x32_bf16 v[80:83], a[12:15], a[88:91], v[80:83]
  ds_read_b64_tr_b16 a[40:41], v6 offset:160
  v_mfma_f32_16x16x32_bf16 v[84:87], a[12:15], a[92:95], v[84:87]
  ds_read_b64_tr_b16 a[42:43], v6 offset:3744
  v_mfma_f32_16x16x32_bf16 v[88:91], a[12:15], a[96:99], v[88:91]
  v_mfma_f32_16x16x32_bf16 v[92:95], a[12:15], a[100:103], v[92:95]
  s_waitcnt lgkmcnt(10)
  v_mfma_f32_16x16x32_bf16 v[96:99], a[16:19], a[88:91], v[96:99]
  ds_read_b64_tr_b16 a[44:45], v6 offset:14624
  v_mfma_f32_16x16x32_bf16 v[100:103], a[16:19], a[92:95], v[100:103]
  ds_read_b64_tr_b16 a[46:47], v6 offset:18208
  v_mfma_f32_16x16x32_bf16 v[104:107], a[16:19], a[96:99], v[104:107]
  buffer_load_dwordx4 a[60:63], v15, s[28:31], s36 offen offset:1024 sc1
  v_mfma_f32_16x16x32_bf16 v[108:111], a[16:19], a[100:103], v[108:111]
  v_mfma_f32_16x16x32_bf16 v[112:115], a[20:23], a[88:91], v[112:115]
  ds_read_b64_tr_b16 a[48:49], v6 offset:192
  v_mfma_f32_16x16x32_bf16 v[116:119], a[20:23], a[92:95], v[116:119]
  ds_read_b64_tr_b16 a[50:51], v6 offset:3776
  v_mfma_f32_16x16x32_bf16 v[120:123], a[20:23], a[96:99], v[120:123]
  v_mfma_f32_16x16x32_bf16 v[124:127], a[20:23], a[100:103], v[124:127]
  s_waitcnt lgkmcnt(10)
  v_mfma_f32_16x16x32_bf16 v[128:131], a[24:27], a[88:91], v[128:131]
  ds_read_b64_tr_b16 a[52:53], v6 offset:14656
  v_mfma_f32_16x16x32_bf16 v[132:135], a[24:27], a[92:95], v[132:135]
  ds_read_b64_tr_b16 a[54:55], v6 offset:18240
  v_mfma_f32_16x16x32_bf16 v[136:139], a[24:27], a[96:99], v[136:139]
  v_mfma_f32_16x16x32_bf16 v[140:143], a[24:27], a[100:103], v[140:143]
  v_mfma_f32_16x16x32_bf16 v[144:147], a[28:31], a[88:91], v[144:147]
  ds_read_b64_tr_b16 a[0:1], v6 offset:7168
  v_mfma_f32_16x16x32_bf16 v[148:151], a[28:31], a[92:95], v[148:151]
  ds_read_b64_tr_b16 a[2:3], v6 offset:10752
  v_mfma_f32_16x16x32_bf16 v[152:155], a[28:31], a[96:99], v[152:155]
  buffer_load_dwordx4 a[64:67], v15, s[28:31], s36 offen offset:2048 sc1
  v_mfma_f32_16x16x32_bf16 v[156:159], a[28:31], a[100:103], v[156:159]
  s_waitcnt lgkmcnt(10)
  v_mfma_f32_16x16x32_bf16 v[160:163], a[32:35], a[88:91], v[160:163]
  ds_read_b64_tr_b16 a[4:5], v6 offset:21632
  v_mfma_f32_16x16x32_bf16 v[164:167], a[32:35], a[92:95], v[164:167]
  ds_read_b64_tr_b16 a[6:7], v6 offset:25216
  v_mfma_f32_16x16x32_bf16 v[168:171], a[32:35], a[96:99], v[168:171]
  buffer_load_dwordx4 v11, s[24:27], s34 offen offset:3072 lds
  v_mfma_f32_16x16x32_bf16 v[172:175], a[32:35], a[100:103], v[172:175]
  v_mfma_f32_16x16x32_bf16 v[176:179], a[36:39], a[88:91], v[176:179]
  ds_read_b64_tr_b16 a[8:9], v6 offset:7200
  v_mfma_f32_16x16x32_bf16 v[180:183], a[36:39], a[92:95], v[180:183]
  ds_read_b64_tr_b16 a[10:11], v6 offset:10784
  v_mfma_f32_16x16x32_bf16 v[184:187], a[36:39], a[96:99], v[184:187]
  buffer_load_dwordx4 a[68:71], v15, s[28:31], s36 offen offset:3072 sc1
  v_mfma_f32_16x16x32_bf16 v[188:191], a[36:39], a[100:103], v[188:191]
  s_add_u32 m0, s33, 32896
  s_waitcnt lgkmcnt(10)
  v_mfma_f32_16x16x32_bf16 v[192:195], a[40:43], a[88:91], v[192:195]
  ds_read_b64_tr_b16 a[12:13], v6 offset:21664
  v_mfma_f32_16x16x32_bf16 v[196:199], a[40:43], a[92:95], v[196:199]
  ds_read_b64_tr_b16 a[14:15], v6 offset:25248
  v_mfma_f32_16x16x32_bf16 v[200:203], a[40:43], a[96:99], v[200:203]
  buffer_load_dwordx4 v12, s[24:27], s34 offen offset:0 lds
  v_mfma_f32_16x16x32_bf16 v[204:207], a[40:43], a[100:103], v[204:207]
  s_cmp_eq_u32 s75, 5
  s_cselect_b32 s39, s74, 1073741824
  v_mfma_f32_16x16x32_bf16 v[208:211], a[44:47], a[88:91], v[208:211]
  ds_read_b64_tr_b16 a[16:17], v6 offset:7232
  v_mfma_f32_16x16x32_bf16 v[212:215], a[44:47], a[92:95], v[212:215]
  ds_read_b64_tr_b16 a[18:19], v6 offset:10816
  v_mfma_f32_16x16x32_bf16 v[216:219], a[44:47], a[96:99], v[216:219]
  buffer_load_dword v20, v19, s[52:55], s39 offen
  v_mfma_f32_16x16x32_bf16 v[220:223], a[44:47], a[100:103], v[220:223]
  s_waitcnt lgkmcnt(10)
  v_mfma_f32_16x16x32_bf16 v[224:227], a[48:51], a[88:91], v[224:227]
  ds_read_b64_tr_b16 a[20:21], v6 offset:21696
  v_mfma_f32_16x16x32_bf16 v[228:231], a[48:51], a[92:95], v[228:231]
  ds_read_b64_tr_b16 a[22:23], v6 offset:25280
  v_mfma_f32_16x16x32_bf16 v[232:235], a[48:51], a[96:99], v[232:235]
  v_mfma_f32_16x16x32_bf16 v[236:239], a[48:51], a[100:103], v[236:239]
  v_mfma_f32_16x16x32_bf16 v[240:243], a[52:55], a[88:91], v[240:243]
  ds_read_b64_tr_b16 a[24:25], v6 offset:7264
  v_mfma_f32_16x16x32_bf16 v[244:247], a[52:55], a[92:95], v[244:247]
  ds_read_b64_tr_b16 a[26:27], v6 offset:10848
  v_mfma_f32_16x16x32_bf16 v[248:251], a[52:55], a[96:99], v[248:251]
  v_mfma_f32_16x16x32_bf16 v[252:255], a[52:55], a[100:103], v[252:255]
  s_waitcnt vmcnt(42) lgkmcnt(10)
  v_mfma_f32_16x16x32_bf16 v[32:35], a[0:3], a[104:107], v[32:35]
  ds_read_b64_tr_b16 a[28:29], v6 offset:21728
  v_mfma_f32_16x16x32_bf16 v[36:39], a[0:3], a[108:111], v[36:39]
  ds_read_b64_tr_b16 a[30:31], v6 offset:25312
  v_mfma_f32_16x16x32_bf16 v[40:43], a[0:3], a[112:115], v[40:43]
  buffer_load_dwordx4 v13, s[24:27], s34 offen offset:1024 lds
  v_mfma_f32_16x16x32_bf16 v[44:47], a[0:3], a[116:119], v[44:47]
  s_mov_b32 s36, 102400
  v_mfma_f32_16x16x32_bf16 v[48:51], a[4:7], a[104:107], v[48:51]
  ds_read_b64_tr_b16 a[32:33], v6 offset:7296
  v_mfma_f32_16x16x32_bf16 v[52:55], a[4:7], a[108:111], v[52:55]
  ds_read_b64_tr_b16 a[34:35], v6 offset:10880
  v_mfma_f32_16x16x32_bf16 v[56:59], a[4:7], a[112:115], v[56:59]
  buffer_load_dwordx4 a[72:75], v15, s[28:31], s36 offen offset:0 sc1
  v_mfma_f32_16x16x32_bf16 v[60:63], a[4:7], a[116:119], v[60:63]
  s_waitcnt lgkmcnt(10)
  v_mfma_f32_16x16x32_bf16 v[64:67], a[8:11], a[104:107], v[64:67]
  ds_read_b64_tr_b16 a[36:37], v6 offset:21760
  v_mfma_f32_16x16x32_bf16 v[68:71], a[8:11], a[108:111], v[68:71]
  ds_read_b64_tr_b16 a[38:39], v6 offset:25344
  v_mfma_f32_16x16x32_bf16 v[72:75], a[8:11], a[112:115], v[72:75]
  buffer_load_dwordx4 a[76:79], v15, s[28:31], s36 offen offset:1024 sc1
  v_mfma_f32_16x16x32_bf16 v[76:79], a[8:11], a[116:119], v[76:79]
  v_mfma_f32_16x16x32_bf16 v[80:83], a[12:15], a[104:107], v[80:83]
  ds_read_b64_tr_b16 a[40:41], v6 offset:7328
  v_mfma_f32_16x16x32_bf16 v[84:87], a[12:15], a[108:111], v[84:87]
  ds_read_b64_tr_b16 a[42:43], v6 offset:10912
  v_mfma_f32_16x16x32_bf16 v[88:91], a[12:15], a[112:115], v[88:91]
  v_mfma_f32_16x16x32_bf16 v[92:95], a[12:15], a[116:119], v[92:95]
  s_waitcnt lgkmcnt(10)
  v_mfma_f32_16x16x32_bf16 v[96:99], a[16:19], a[104:107], v[96:99]
  ds_read_b64_tr_b16 a[44:45], v6 offset:21792
  v_mfma_f32_16x16x32_bf16 v[100:103], a[16:19], a[108:111], v[100:103]
  ds_read_b64_tr_b16 a[46:47], v6 offset:25376
  v_mfma_f32_16x16x32_bf16 v[104:107], a[16:19], a[112:115], v[104:107]
  buffer_load_dwordx4 v14, s[24:27], s34 offen offset:2048 lds
  v_mfma_f32_16x16x32_bf16 v[108:111], a[16:19], a[116:119], v[108:111]
  v_mfma_f32_16x16x32_bf16 v[112:115], a[20:23], a[104:107], v[112:115]
  ds_read_b64_tr_b16 a[48:49], v6 offset:7360
  v_mfma_f32_16x16x32_bf16 v[116:119], a[20:23], a[108:111], v[116:119]
  ds_read_b64_tr_b16 a[50:51], v6 offset:10944
  v_mfma_f32_16x16x32_bf16 v[120:123], a[20:23], a[112:115], v[120:123]
  v_mfma_f32_16x16x32_bf16 v[124:127], a[20:23], a[116:119], v[124:127]
  s_waitcnt lgkmcnt(10)
  v_mfma_f32_16x16x32_bf16 v[128:131], a[24:27], a[104:107], v[128:131]
  ds_read_b64_tr_b16 a[52:53], v6 offset:21824
  v_mfma_f32_16x16x32_bf16 v[132:135], a[24:27], a[108:111], v[132:135]
  ds_read_b64_tr_b16 a[54:55], v6 offset:25408
  v_mfma_f32_16x16x32_bf16 v[136:139], a[24:27], a[112:115], v[136:139]
  v_mfma_f32_16x16x32_bf16 v[140:143], a[24:27], a[116:119], v[140:143]
  s_waitcnt vmcnt(48) lgkmcnt(0)
  s_barrier
  v_mfma_f32_16x16x32_bf16 v[144:147], a[28:31], a[104:107], v[144:147]
  ds_read_b64_tr_b16 a[0:1], v7 offset:0
  v_mfma_f32_16x16x32_bf16 v[148:151], a[28:31], a[108:111], v[148:151]
  ds_read_b64_tr_b16 a[2:3], v7 offset:3584
  v_mfma_f32_16x16x32_bf16 v[152:155], a[28:31], a[112:115], v[152:155]
  buffer_load_dwordx4 a[80:83], v15, s[28:31], s36 offen offset:2048 sc1
  v_mfma_f32_16x16x32_bf16 v[156:159], a[28:31], a[116:119], v[156:159]
  s_waitcnt lgkmcnt(10)
  v_mfma_f32_16x16x32_bf16 v[160:163], a[32:35], a[104:107], v[160:163]
  ds_read_b64_tr_b16 a[4:5], v7 offset:14464
  v_mfma_f32_16x16x32_bf16 v[164:167], a[32:35], a[108:111], v[164:167]
  ds_read_b64_tr_b16 a[6:7], v7 offset:18048
  v_mfma_f32_16x16x32_bf16 v[168:171], a[32:35], a[112:115], v[168:171]
  buffer_load_dwordx4 a[84:87], v15, s[28:31], s36 offen offset:3072 sc1
  v_mfma_f32_16x16x32_bf16 v[172:175], a[32:35], a[116:119], v[172:175]
  s_mov_b32 s36, 106496
  v_mfma_f32_16x16x32_bf16 v[176:179], a[36:39], a[104:107], v[176:179]
  ds_read_b64_tr_b16 a[8:9], v7 offset:32
  v_mfma_f32_16x16x32_bf16 v[180:183], a[36:39], a[108:111], v[180:183]
  ds_read_b64_tr_b16 a[10:11], v7 offset:3616
  v_mfma_f32_16x16x32_bf16 v[184:187], a[36:39], a[112:115], v[184:187]
  buffer_load_dwordx4 a[88:91], v15, s[28:31], s36 offen offset:0 sc1
  v_mfma_f32_16x16x32_bf16 v[188:191], a[36:39], a[116:119], v[188:191]
  s_waitcnt lgkmcnt(10)
  v_mfma_f32_16x16x32_bf16 v[192:195], a[40:43], a[104:107], v[192:195]
  ds_read_b64_tr_b16 a[12:13], v7 offset:14496
  v_mfma_f32_16x16x32_bf16 v[196:199], a[40:43], a[108:111], v[196:199]
  ds_read_b64_tr_b16 a[14:15], v7 offset:18080
  v_mfma_f32_16x16x32_bf16 v[200:203], a[40:43], a[112:115], v[200:203]
  v_mfma_f32_16x16x32_bf16 v[204:207], a[40:43], a[116:119], v[204:207]
  v_mfma_f32_16x16x32_bf16 v[208:211], a[44:47], a[104:107], v[208:211]
  ds_read_b64_tr_b16 a[16:17], v7 offset:64
  v_mfma_f32_16x16x32_bf16 v[212:215], a[44:47], a[108:111], v[212:215]
  ds_read_b64_tr_b16 a[18:19], v7 offset:3648
  v_mfma_f32_16x16x32_bf16 v[216:219], a[44:47], a[112:115], v[216:219]
  buffer_load_dwordx4 a[92:95], v15, s[28:31], s36 offen offset:1024 sc1
  v_mfma_f32_16x16x32_bf16 v[220:223], a[44:47], a[116:119], v[220:223]
  s_waitcnt lgkmcnt(10)
  v_mfma_f32_16x16x32_bf16 v[224:227], a[48:51], a[104:107], v[224:227]
  ds_read_b64_tr_b16 a[20:21], v7 offset:14528
  v_mfma_f32_16x16x32_bf16 v[228:231], a[48:51], a[108:111], v[228:231]
  ds_read_b64_tr_b16 a[22:23], v7 offset:18112
  v_mfma_f32_16x16x32_bf16 v[232:235], a[48:51], a[112:115], v[232:235]
  v_mfma_f32_16x16x32_bf16 v[236:239], a[48:51], a[116:119], v[236:239]
  v_mfma_f32_16x16x32_bf16 v[240:243], a[52:55], a[104:107], v[240:243]
  ds_read_b64_tr_b16 a[24:25], v7 offset:96
  v_mfma_f32_16x16x32_bf16 v[244:247], a[52:55], a[108:111], v[244:247]
  ds_read_b64_tr_b16 a[26:27], v7 offset:3680
  v_mfma_f32_16x16x32_bf16 v[248:251], a[52:55], a[112:115], v[248:251]
  v_mfma_f32_16x16x32_bf16 v[252:255], a[52:55], a[116:119], v[252:255]
  s_waitcnt vmcnt(41) lgkmcnt(10)
  v_mfma_f32_16x16x32_bf16 v[32:35], a[0:3], a[120:123], v[32:35]
  ds_read_b64_tr_b16 a[28:29], v7 offset:14560
  v_mfma_f32_16x16x32_bf16 v[36:39], a[0:3], a[124:127], v[36:39]
  ds_read_b64_tr_b16 a[30:31], v7 offset:18144
  s_mov_b32 s34, 6422528
  s_add_u32 m0, s33, 57600
  v_mfma_f32_16x16x32_bf16 v[40:43], a[0:3], a[128:131], v[40:43]
  buffer_load_dwordx4 v8, s[24:27], s34 offen offset:0 lds
  v_mfma_f32_16x16x32_bf16 v[44:47], a[0:3], a[132:135], v[44:47]
  v_mfma_f32_16x16x32_bf16 v[48:51], a[4:7], a[120:123], v[48:51]
  ds_read_b64_tr_b16 a[32:33], v7 offset:128
  v_mfma_f32_16x16x32_bf16 v[52:55], a[4:7], a[124:127], v[52:55]
  ds_read_b64_tr_b16 a[34:35], v7 offset:3712
  v_mfma_f32_16x16x32_bf16 v[56:59], a[4:7], a[128:131], v[56:59]
  buffer_load_dwordx4 v9, s[24:27], s34 offen offset:1024 lds
  v_mfma_f32_16x16x32_bf16 v[60:63], a[4:7], a[132:135], v[60:63]
  s_waitcnt lgkmcnt(10)
  v_mfma_f32_16x16x32_bf16 v[64:67], a[8:11], a[120:123], v[64:67]
  ds_read_b64_tr_b16 a[36:37], v7 offset:14592
  v_mfma_f32_16x16x32_bf16 v[68:71], a[8:11], a[124:127], v[68:71]
  ds_read_b64_tr_b16 a[38:39], v7 offset:18176
  v_mfma_f32_16x16x32_bf16 v[72:75], a[8:11], a[128:131], v[72:75]
  buffer_load_dwordx4 v10, s[24:27], s34 offen offset:2048 lds
  v_mfma_f32_16x16x32_bf16 v[76:79], a[8:11], a[132:135], v[76:79]
  v_mfma_f32_16x16x32_bf16 v[80:83], a[12:15], a[120:123], v[80:83]
  ds_read_b64_tr_b16 a[40:41], v7 offset:160
  v_mfma_f32_16x16x32_bf16 v[84:87], a[12:15], a[124:127], v[84:87]
  ds_read_b64_tr_b16 a[42:43], v7 offset:3744
  v_mfma_f32_16x16x32_bf16 v[88:91], a[12:15], a[128:131], v[88:91]
  buffer_load_dwordx4 a[96:99], v15, s[28:31], s36 offen offset:2048 sc1
  v_mfma_f32_16x16x32_bf16 v[92:95], a[12:15], a[132:135], v[92:95]
  s_waitcnt lgkmcnt(10)
  v_mfma_f32_16x16x32_bf16 v[96:99], a[16:19], a[120:123], v[96:99]
  ds_read_b64_tr_b16 a[44:45], v7 offset:14624
  v_mfma_f32_16x16x32_bf16 v[100:103], a[16:19], a[124:127], v[100:103]
  ds_read_b64_tr_b16 a[46:47], v7 offset:18208
  v_mfma_f32_16x16x32_bf16 v[104:107], a[16:19], a[128:131], v[104:107]
  global_load_dword v20, v[28:29], off
  v_mfma_f32_16x16x32_bf16 v[108:111], a[16:19], a[132:135], v[108:111]
  v_mfma_f32_16x16x32_bf16 v[112:115], a[20:23], a[120:123], v[112:115]
  ds_read_b64_tr_b16 a[48:49], v7 offset:192
  v_mfma_f32_16x16x32_bf16 v[116:119], a[20:23], a[124:127], v[116:119]
  ds_read_b64_tr_b16 a[50:51], v7 offset:3776
  v_mfma_f32_16x16x32_bf16 v[120:123], a[20:23], a[128:131], v[120:123]
  v_mfma_f32_16x16x32_bf16 v[124:127], a[20:23], a[132:135], v[124:127]
  s_waitcnt lgkmcnt(10)
  v_mfma_f32_16x16x32_bf16 v[128:131], a[24:27], a[120:123], v[128:131]
  ds_read_b64_tr_b16 a[52:53], v7 offset:14656
  v_mfma_f32_16x16x32_bf16 v[132:135], a[24:27], a[124:127], v[132:135]
  ds_read_b64_tr_b16 a[54:55], v7 offset:18240
  v_mfma_f32_16x16x32_bf16 v[136:139], a[24:27], a[128:131], v[136:139]
  v_mfma_f32_16x16x32_bf16 v[140:143], a[24:27], a[132:135], v[140:143]
  v_mfma_f32_16x16x32_bf16 v[144:147], a[28:31], a[120:123], v[144:147]
  ds_read_b64_tr_b16 a[0:1], v7 offset:7168
  v_mfma_f32_16x16x32_bf16 v[148:151], a[28:31], a[124:127], v[148:151]
  ds_read_b64_tr_b16 a[2:3], v7 offset:10752
  v_mfma_f32_16x16x32_bf16 v[152:155], a[28:31], a[128:131], v[152:155]
  buffer_load_dwordx4 v11, s[24:27], s34 offen offset:3072 lds
  v_mfma_f32_16x16x32_bf16 v[156:159], a[28:31], a[132:135], v[156:159]
  s_waitcnt lgkmcnt(10)
  v_mfma_f32_16x16x32_bf16 v[160:163], a[32:35], a[120:123], v[160:163]
  ds_read_b64_tr_b16 a[4:5], v7 offset:21632
  v_mfma_f32_16x16x32_bf16 v[164:167], a[32:35], a[124:127], v[164:167]
  ds_read_b64_tr_b16 a[6:7], v7 offset:25216
  v_mfma_f32_16x16x32_bf16 v[168:171], a[32:35], a[128:131], v[168:171]
  buffer_load_dwordx4 a[100:103], v15, s[28:31], s36 offen offset:3072 sc1
  v_mfma_f32_16x16x32_bf16 v[172:175], a[32:35], a[132:135], v[172:175]
  s_add_u32 m0, s33, 61696
  v_mfma_f32_16x16x32_bf16 v[176:179], a[36:39], a[120:123], v[176:179]
  ds_read_b64_tr_b16 a[8:9], v7 offset:7200
  v_mfma_f32_16x16x32_bf16 v[180:183], a[36:39], a[124:127], v[180:183]
  ds_read_b64_tr_b16 a[10:11], v7 offset:10784
  v_mfma_f32_16x16x32_bf16 v[184:187], a[36:39], a[128:131], v[184:187]
  buffer_load_dwordx4 v12, s[24:27], s34 offen offset:0 lds
  v_mfma_f32_16x16x32_bf16 v[188:191], a[36:39], a[132:135], v[188:191]
  s_waitcnt lgkmcnt(10)
  v_mfma_f32_16x16x32_bf16 v[192:195], a[40:43], a[120:123], v[192:195]
  ds_read_b64_tr_b16 a[12:13], v7 offset:21664
  v_mfma_f32_16x16x32_bf16 v[196:199], a[40:43], a[124:127], v[196:199]
  ds_read_b64_tr_b16 a[14:15], v7 offset:25248
  v_mfma_f32_16x16x32_bf16 v[200:203], a[40:43], a[128:131], v[200:203]
  buffer_load_dwordx4 v13, s[24:27], s34 offen offset:1024 lds
  v_mfma_f32_16x16x32_bf16 v[204:207], a[40:43], a[132:135], v[204:207]
  s_cmp_eq_u32 s75, 6
  s_cselect_b32 s39, s74, 1073741824
  v_mfma_f32_16x16x32_bf16 v[208:211], a[44:47], a[120:123], v[208:211]
  ds_read_b64_tr_b16 a[16:17], v7 offset:7232
  v_mfma_f32_16x16x32_bf16 v[212:215], a[44:47], a[124:127], v[212:215]
  ds_read_b64_tr_b16 a[18:19], v7 offset:10816
  v_mfma_f32_16x16x32_bf16 v[216:219], a[44:47], a[128:131], v[216:219]
  buffer_load_dword v20, v19, s[52:55], s39 offen
  v_mfma_f32_16x16x32_bf16 v[220:223], a[44:47], a[132:135], v[220:223]
  s_waitcnt lgkmcnt(10)
  v_mfma_f32_16x16x32_bf16 v[224:227], a[48:51], a[120:123], v[224:227]
  ds_read_b64_tr_b16 a[20:21], v7 offset:21696
  v_mfma_f32_16x16x32_bf16 v[228:231], a[48:51], a[124:127], v[228:231]
  ds_read_b64_tr_b16 a[22:23], v7 offset:25280
  v_mfma_f32_16x16x32_bf16 v[232:235], a[48:51], a[128:131], v[232:235]
  v_mfma_f32_16x16x32_bf16 v[236:239], a[48:51], a[132:135], v[236:239]
  v_mfma_f32_16x16x32_bf16 v[240:243], a[52:55], a[120:123], v[240:243]
  ds_read_b64_tr_b16 a[24:25], v7 offset:7264
  v_mfma_f32_16x16x32_bf16 v[244:247], a[52:55], a[124:127], v[244:247]
  ds_read_b64_tr_b16 a[26:27], v7 offset:10848
  v_mfma_f32_16x16x32_bf16 v[248:251], a[52:55], a[128:131], v[248:251]
  v_mfma_f32_16x16x32_bf16 v[252:255], a[52:55], a[132:135], v[252:255]
  s_waitcnt vmcnt(44) lgkmcnt(10)
  v_mfma_f32_16x16x32_bf16 v[32:35], a[0:3], a[136:139], v[32:35]
  ds_read_b64_tr_b16 a[28:29], v7 offset:21728
  v_mfma_f32_16x16x32_bf16 v[36:39], a[0:3], a[140:143], v[36:39]
  ds_read_b64_tr_b16 a[30:31], v7 offset:25312
  s_mov_b32 s36, 110592
  v_mfma_f32_16x16x32_bf16 v[40:43], a[0:3], a[144:147], v[40:43]
  buffer_load_dwordx4 a[104:107], v15, s[28:31], s36 offen offset:0 sc1
  v_mfma_f32_16x16x32_bf16 v[44:47], a[0:3], a[148:151], v[44:47]
  v_mfma_f32_16x16x32_bf16 v[48:51], a[4:7], a[136:139], v[48:51]
  ds_read_b64_tr_b16 a[32:33], v7 offset:7296
  v_mfma_f32_16x16x32_bf16 v[52:55], a[4:7], a[140:143], v[52:55]
  ds_read_b64_tr_b16 a[34:35], v7 offset:10880
  v_mfma_f32_16x16x32_bf16 v[56:59], a[4:7], a[144:147], v[56:59]
  buffer_load_dwordx4 a[108:111], v15, s[28:31], s36 offen offset:1024 sc1
  v_mfma_f32_16x16x32_bf16 v[60:63], a[4:7], a[148:151], v[60:63]
  s_waitcnt lgkmcnt(10)
  v_mfma_f32_16x16x32_bf16 v[64:67], a[8:11], a[136:139], v[64:67]
  ds_read_b64_tr_b16 a[36:37], v7 offset:21760
  v_mfma_f32_16x16x32_bf16 v[68:71], a[8:11], a[140:143], v[68:71]
  ds_read_b64_tr_b16 a[38:39], v7 offset:25344
  v_mfma_f32_16x16x32_bf16 v[72:75], a[8:11], a[144:147], v[72:75]
  buffer_load_dwordx4 v14, s[24:27], s34 offen offset:2048 lds
  v_mfma_f32_16x16x32_bf16 v[76:79], a[8:11], a[148:151], v[76:79]
  v_mfma_f32_16x16x32_bf16 v[80:83], a[12:15], a[136:139], v[80:83]
  ds_read_b64_tr_b16 a[40:41], v7 offset:7328
  v_mfma_f32_16x16x32_bf16 v[84:87], a[12:15], a[140:143], v[84:87]
  ds_read_b64_tr_b16 a[42:43], v7 offset:10912
  v_mfma_f32_16x16x32_bf16 v[88:91], a[12:15], a[144:147], v[88:91]
  v_mfma_f32_16x16x32_bf16 v[92:95], a[12:15], a[148:151], v[92:95]
  s_waitcnt lgkmcnt(10)
  v_mfma_f32_16x16x32_bf16 v[96:99], a[16:19], a[136:139], v[96:99]
  ds_read_b64_tr_b16 a[44:45], v7 offset:21792
  v_mfma_f32_16x16x32_bf16 v[100:103], a[16:19], a[140:143], v[100:103]
  ds_read_b64_tr_b16 a[46:47], v7 offset:25376
  v_mfma_f32_16x16x32_bf16 v[104:107], a[16:19], a[144:147], v[104:107]
  buffer_load_dwordx4 a[112:115], v15, s[28:31], s36 offen offset:2048 sc1
  v_mfma_f32_16x16x32_bf16 v[108:111], a[16:19], a[148:151], v[108:111]
  v_mfma_f32_16x16x32_bf16 v[112:115], a[20:23], a[136:139], v[112:115]
  ds_read_b64_tr_b16 a[48:49], v7 offset:7360
  v_mfma_f32_16x16x32_bf16 v[116:119], a[20:23], a[140:143], v[116:119]
  ds_read_b64_tr_b16 a[50:51], v7 offset:10944
  v_mfma_f32_16x16x32_bf16 v[120:123], a[20:23], a[144:147], v[120:123]
  v_mfma_f32_16x16x32_bf16 v[124:127], a[20:23], a[148:151], v[124:127]
  s_waitcnt lgkmcnt(10)
  v_mfma_f32_16x16x32_bf16 v[128:131], a[24:27], a[136:139], v[128:131]
  ds_read_b64_tr_b16 a[52:53], v7 offset:21824
  v_mfma_f32_16x16x32_bf16 v[132:135], a[24:27], a[140:143], v[132:135]
  ds_read_b64_tr_b16 a[54:55], v7 offset:25408
  v_mfma_f32_16x16x32_bf16 v[136:139], a[24:27], a[144:147], v[136:139]
  v_mfma_f32_16x16x32_bf16 v[140:143], a[24:27], a[148:151], v[140:143]
  s_waitcnt vmcnt(50) lgkmcnt(0)
  s_barrier
  v_mfma_f32_16x16x32_bf16 v[144:147], a[28:31], a[136:139], v[144:147]
  ds_read_b64_tr_b16 a[0:1], v17 offset:0
  v_mfma_f32_16x16x32_bf16 v[148:151], a[28:31], a[140:143], v[148:151]
  ds_read_b64_tr_b16 a[2:3], v17 offset:3584
  v_mfma_f32_16x16x32_bf16 v[152:155], a[28:31], a[144:147], v[152:155]
  buffer_load_dwordx4 a[116:119], v15, s[28:31], s36 offen offset:3072 sc1
  v_mfma_f32_16x16x32_bf16 v[156:159], a[28:31], a[148:151], v[156:159]
  s_mov_b32 s36, 114688
  s_waitcnt lgkmcnt(10)
  v_mfma_f32_16x16x32_bf16 v[160:163], a[32:35], a[136:139], v[160:163]
  ds_read_b64_tr_b16 a[4:5], v17 offset:14464
  v_mfma_f32_16x16x32_bf16 v[164:167], a[32:35], a[140:143], v[164:167]
  ds_read_b64_tr_b16 a[6:7], v17 offset:18048
  v_mfma_f32_16x16x32_bf16 v[168:171], a[32:35], a[144:147], v[168:171]
  buffer_load_dwordx4 a[120:123], v15, s[28:31], s36 offen offset:0 sc1
  v_mfma_f32_16x16x32_bf16 v[172:175], a[32:35], a[148:151], v[172:175]
  v_mfma_f32_16x16x32_bf16 v[176:179], a[36:39], a[136:139], v[176:179]
  ds_read_b64_tr_b16 a[8:9], v17 offset:32
  v_mfma_f32_16x16x32_bf16 v[180:183], a[36:39], a[140:143], v[180:183]
  ds_read_b64_tr_b16 a[10:11], v17 offset:3616
  v_mfma_f32_16x16x32_bf16 v[184:187], a[36:39], a[144:147], v[184:187]
  buffer_load_dwordx4 a[124:127], v15, s[28:31], s36 offen offset:1024 sc1
  v_mfma_f32_16x16x32_bf16 v[188:191], a[36:39], a[148:151], v[188:191]
  s_waitcnt lgkmcnt(10)
  v_mfma_f32_16x16x32_bf16 v[192:195], a[40:43], a[136:139], v[192:195]
  ds_read_b64_tr_b16 a[12:13], v17 offset:14496
  v_mfma_f32_16x16x32_bf16 v[196:199], a[40:43], a[140:143], v[196:199]
  ds_read_b64_tr_b16 a[14:15], v17 offset:18080
  v_mfma_f32_16x16x32_bf16 v[200:203], a[40:43], a[144:147], v[200:203]
  v_mfma_f32_16x16x32_bf16 v[204:207], a[40:43], a[148:151], v[204:207]
  v_mfma_f32_16x16x32_bf16 v[208:211], a[44:47], a[136:139], v[208:211]
  ds_read_b64_tr_b16 a[16:17], v17 offset:64
  v_mfma_f32_16x16x32_bf16 v[212:215], a[44:47], a[140:143], v[212:215]
  ds_read_b64_tr_b16 a[18:19], v17 offset:3648
  v_mfma_f32_16x16x32_bf16 v[216:219], a[44:47], a[144:147], v[216:219]
  buffer_load_dwordx4 a[128:131], v15, s[28:31], s36 offen offset:2048 sc1
  v_mfma_f32_16x16x32_bf16 v[220:223], a[44:47], a[148:151], v[220:223]
  s_waitcnt lgkmcnt(10)
  v_mfma_f32_16x16x32_bf16 v[224:227], a[48:51], a[136:139], v[224:227]
  ds_read_b64_tr_b16 a[20:21], v17 offset:14528
  v_mfma_f32_16x16x32_bf16 v[228:231], a[48:51], a[140:143], v[228:231]
  ds_read_b64_tr_b16 a[22:23], v17 offset:18112
  v_mfma_f32_16x16x32_bf16 v[232:235], a[48:51], a[144:147], v[232:235]
  v_mfma_f32_16x16x32_bf16 v[236:239], a[48:51], a[148:151], v[236:239]
  v_mfma_f32_16x16x32_bf16 v[240:243], a[52:55], a[136:139], v[240:243]
  ds_read_b64_tr_b16 a[24:25], v17 offset:96
  v_mfma_f32_16x16x32_bf16 v[244:247], a[52:55], a[140:143], v[244:247]
  ds_read_b64_tr_b16 a[26:27], v17 offset:3680
  v_mfma_f32_16x16x32_bf16 v[248:251], a[52:55], a[144:147], v[248:251]
  v_mfma_f32_16x16x32_bf16 v[252:255], a[52:55], a[148:151], v[252:255]
  s_waitcnt vmcnt(44) lgkmcnt(10)
  v_mfma_f32_16x16x32_bf16 v[32:35], a[0:3], a[152:155], v[32:35]
  ds_read_b64_tr_b16 a[28:29], v17 offset:14560
  v_mfma_f32_16x16x32_bf16 v[36:39], a[0:3], a[156:159], v[36:39]
  ds_read_b64_tr_b16 a[30:31], v17 offset:18144
  s_mov_b32 s34, 6881280
  s_add_u32 m0, s33, 86400
  v_mfma_f32_16x16x32_bf16 v[40:43], a[0:3], a[160:163], v[40:43]
  buffer_load_dwordx4 v8, s[24:27], s34 offen offset:0 lds
  v_mfma_f32_16x16x32_bf16 v[44:47], a[0:3], a[164:167], v[44:47]
  v_mfma_f32_16x16x32_bf16 v[48:51], a[4:7], a[152:155], v[48:51]
  ds_read_b64_tr_b16 a[32:33], v17 offset:128
  v_mfma_f32_16x16x32_bf16 v[52:55], a[4:7], a[156:159], v[52:55]
  ds_read_b64_tr_b16 a[34:35], v17 offset:3712
  v_mfma_f32_16x16x32_bf16 v[56:59], a[4:7], a[160:163], v[56:59]
  buffer_load_dwordx4 v9, s[24:27], s34 offen offset:1024 lds
  v_mfma_f32_16x16x32_bf16 v[60:63], a[4:7], a[164:167], v[60:63]
  s_waitcnt lgkmcnt(10)
  v_mfma_f32_16x16x32_bf16 v[64:67], a[8:11], a[152:155], v[64:67]
  ds_read_b64_tr_b16 a[36:37], v17 offset:14592
  v_mfma_f32_16x16x32_bf16 v[68:71], a[8:11], a[156:159], v[68:71]
  ds_read_b64_tr_b16 a[38:39], v17 offset:18176
  v_mfma_f32_16x16x32_bf16 v[72:75], a[8:11], a[160:163], v[72:75]
  buffer_load_dwordx4 v10, s[24:27], s34 offen offset:2048 lds
  v_mfma_f32_16x16x32_bf16 v[76:79], a[8:11], a[164:167], v[76:79]
  v_mfma_f32_16x16x32_bf16 v[80:83], a[12:15], a[152:155], v[80:83]
  ds_read_b64_tr_b16 a[40:41], v17 offset:160
  v_mfma_f32_16x16x32_bf16 v[84:87], a[12:15], a[156:159], v[84:87]
  ds_read_b64_tr_b16 a[42:43], v17 offset:3744
  v_mfma_f32_16x16x32_bf16 v[88:91], a[12:15], a[160:163], v[88:91]
  v_mfma_f32_16x16x32_bf16 v[92:95], a[12:15], a[164:167], v[92:95]
  s_waitcnt lgkmcnt(10)
  v_mfma_f32_16x16x32_bf16 v[96:99], a[16:19], a[152:155], v[96:99]
  ds_read_b64_tr_b16 a[44:45], v17 offset:14624
  v_mfma_f32_16x16x32_bf16 v[100:103], a[16:19], a[156:159], v[100:103]
  ds_read_b64_tr_b16 a[46:47], v17 offset:18208
  v_mfma_f32_16x16x32_bf16 v[104:107], a[16:19], a[160:163], v[104:107]
  buffer_load_dwordx4 v11, s[24:27], s34 offen offset:3072 lds
  v_mfma_f32_16x16x32_bf16 v[108:111], a[16:19], a[164:167], v[108:111]
  v_mfma_f32_16x16x32_bf16 v[112:115], a[20:23], a[152:155], v[112:115]
  ds_read_b64_tr_b16 a[48:49], v17 offset:192
  v_mfma_f32_16x16x32_bf16 v[116:119], a[20:23], a[156:159], v[116:119]
  ds_read_b64_tr_b16 a[50:51], v17 offset:3776
  v_mfma_f32_16x16x32_bf16 v[120:123], a[20:23], a[160:163], v[120:123]
  v_mfma_f32_16x16x32_bf16 v[124:127], a[20:23], a[164:167], v[124:127]
  s_waitcnt lgkmcnt(10)
  v_mfma_f32_16x16x32_bf16 v[128:131], a[24:27], a[152:155], v[128:131]
  ds_read_b64_tr_b16 a[52:53], v17 offset:14656
  v_mfma_f32_16x16x32_bf16 v[132:135], a[24:27], a[156:159], v[132:135]
  ds_read_b64_tr_b16 a[54:55], v17 offset:18240
  v_mfma_f32_16x16x32_bf16 v[136:139], a[24:27], a[160:163], v[136:139]
  v_mfma_f32_16x16x32_bf16 v[140:143], a[24:27], a[164:167], v[140:143]
  v_mfma_f32_16x16x32_bf16 v[144:147], a[28:31], a[152:155], v[144:147]
  ds_read_b64_tr_b16 a[0:1], v17 offset:7168
  v_mfma_f32_16x16x32_bf16 v[148:151], a[28:31], a[156:159], v[148:151]
  ds_read_b64_tr_b16 a[2:3], v17 offset:10752
  v_mfma_f32_16x16x32_bf16 v[152:155], a[28:31], a[160:163], v[152:155]
  buffer_load_dwordx4 a[132:135], v15, s[28:31], s36 offen offset:3072 sc1
  v_mfma_f32_16x16x32_bf16 v[156:159], a[28:31], a[164:167], v[156:159]
  s_add_u32 m0, s33, 90496
  s_waitcnt lgkmcnt(10)
  v_mfma_f32_16x16x32_bf16 v[160:163], a[32:35], a[152:155], v[160:163]
  ds_read_b64_tr_b16 a[4:5], v17 offset:21632
  v_mfma_f32_16x16x32_bf16 v[164:167], a[32:35], a[156:159], v[164:167]
  ds_read_b64_tr_b16 a[6:7], v17 offset:25216
  v_mfma_f32_16x16x32_bf16 v[168:171], a[32:35], a[160:163], v[168:171]
  buffer_load_dwordx4 v12, s[24:27], s34 offen offset:0 lds
  v_mfma_f32_16x16x32_bf16 v[172:175], a[32:35], a[164:167], v[172:175]
  v_mfma_f32_16x16x32_bf16 v[176:179], a[36:39], a[152:155], v[176:179]
  ds_read_b64_tr_b16 a[8:9], v17 offset:7200
  v_mfma_f32_16x16x32_bf16 v[180:183], a[36:39], a[156:159], v[180:183]
  ds_read_b64_tr_b16 a[10:11], v17 offset:10784
  v_mfma_f32_16x16x32_bf16 v[184:187], a[36:39], a[160:163], v[184:187]
  buffer_load_dwordx4 v13, s[24:27], s34 offen offset:1024 lds
  v_mfma_f32_16x16x32_bf16 v[188:191], a[36:39], a[164:167], v[188:191]
  s_mov_b32 s36, 118784
  s_waitcnt lgkmcnt(10)
  v_mfma_f32_16x16x32_bf16 v[192:195], a[40:43], a[152:155], v[192:195]
  ds_read_b64_tr_b16 a[12:13], v17 offset:21664
  v_mfma_f32_16x16x32_bf16 v[196:199], a[40:43], a[156:159], v[196:199]
  ds_read_b64_tr_b16 a[14:15], v17 offset:25248
  v_mfma_f32_16x16x32_bf16 v[200:203], a[40:43], a[160:163], v[200:203]
  buffer_load_dwordx4 a[136:139], v15, s[28:31], s36 offen offset:0 sc1
  v_mfma_f32_16x16x32_bf16 v[204:207], a[40:43], a[164:167], v[204:207]
  s_cmp_eq_u32 s75, 7
  s_cselect_b32 s39, s74, 1073741824
  v_mfma_f32_16x16x32_bf16 v[208:211], a[44:47], a[152:155], v[208:211]
  ds_read_b64_tr_b16 a[16:17], v17 offset:7232
  v_mfma_f32_16x16x32_bf16 v[212:215], a[44:47], a[156:159], v[212:215]
  ds_read_b64_tr_b16 a[18:19], v17 offset:10816
  v_mfma_f32_16x16x32_bf16 v[216:219], a[44:47], a[160:163], v[216:219]
  buffer_load_dword v20, v19, s[52:55], s39 offen
  v_mfma_f32_16x16x32_bf16 v[220:223], a[44:47], a[164:167], v[220:223]
  s_waitcnt lgkmcnt(10)
  v_mfma_f32_16x16x32_bf16 v[224:227], a[48:51], a[152:155], v[224:227]
  ds_read_b64_tr_b16 a[20:21], v17 offset:21696
  v_mfma_f32_16x16x32_bf16 v[228:231], a[48:51], a[156:159], v[228:231]
  ds_read_b64_tr_b16 a[22:23], v17 offset:25280
  v_mfma_f32_16x16x32_bf16 v[232:235], a[48:51], a[160:163], v[232:235]
  v_mfma_f32_16x16x32_bf16 v[236:239], a[48:51], a[164:167], v[236:239]
  v_mfma_f32_16x16x32_bf16 v[240:243], a[52:55], a[152:155], v[240:243]
  ds_read_b64_tr_b16 a[24:25], v17 offset:7264
  v_mfma_f32_16x16x32_bf16 v[244:247], a[52:55], a[156:159], v[244:247]
  ds_read_b64_tr_b16 a[26:27], v17 offset:10848
  v_mfma_f32_16x16x32_bf16 v[248:251], a[52:55], a[160:163], v[248:251]
  v_mfma_f32_16x16x32_bf16 v[252:255], a[52:55], a[164:167], v[252:255]
  s_waitcnt vmcnt(45) lgkmcnt(10)
  v_mfma_f32_16x16x32_bf16 v[32:35], a[0:3], a[168:171], v[32:35]
  ds_read_b64_tr_b16 a[28:29], v17 offset:21728
  v_mfma_f32_16x16x32_bf16 v[36:39], a[0:3], a[172:175], v[36:39]
  ds_read_b64_tr_b16 a[30:31], v17 offset:25312
  v_mfma_f32_16x16x32_bf16 v[40:43], a[0:3], a[176:179], v[40:43]
  buffer_load_dwordx4 a[140:143], v15, s[28:31], s36 offen offset:1024 sc1
  v_mfma_f32_16x16x32_bf16 v[44:47], a[0:3], a[180:183], v[44:47]
  v_mfma_f32_16x16x32_bf16 v[48:51], a[4:7], a[168:171], v[48:51]
  ds_read_b64_tr_b16 a[32:33], v17 offset:7296
  v_mfma_f32_16x16x32_bf16 v[52:55], a[4:7], a[172:175], v[52:55]
  ds_read_b64_tr_b16 a[34:35], v17 offset:10880
  v_mfma_f32_16x16x32_bf16 v[56:59], a[4:7], a[176:179], v[56:59]
  buffer_load_dwordx4 v14, s[24:27], s34 offen offset:2048 lds
  v_mfma_f32_16x16x32_bf16 v[60:63], a[4:7], a[180:183], v[60:63]
  s_waitcnt lgkmcnt(10)
  v_mfma_f32_16x16x32_bf16 v[64:67], a[8:11], a[168:171], v[64:67]
  ds_read_b64_tr_b16 a[36:37], v17 offset:21760
  v_mfma_f32_16x16x32_bf16 v[68:71], a[8:11], a[172:175], v[68:71]
  ds_read_b64_tr_b16 a[38:39], v17 offset:25344
  v_mfma_f32_16x16x32_bf16 v[72:75], a[8:11], a[176:179], v[72:75]
  buffer_load_dwordx4 a[144:147], v15, s[28:31], s36 offen offset:2048 sc1
  v_mfma_f32_16x16x32_bf16 v[76:79], a[8:11], a[180:183], v[76:79]
  v_mfma_f32_16x16x32_bf16 v[80:83], a[12:15], a[168:171], v[80:83]
  ds_read_b64_tr_b16 a[40:41], v17 offset:7328
  v_mfma_f32_16x16x32_bf16 v[84:87], a[12:15], a[172:175], v[84:87]
  ds_read_b64_tr_b16 a[42:43], v17 offset:10912
  v_mfma_f32_16x16x32_bf16 v[88:91], a[12:15], a[176:179], v[88:91]
  v_mfma_f32_16x16x32_bf16 v[92:95], a[12:15], a[180:183], v[92:95]
  s_waitcnt lgkmcnt(10)
  v_mfma_f32_16x16x32_bf16 v[96:99], a[16:19], a[168:171], v[96:99]
  ds_read_b64_tr_b16 a[44:45], v17 offset:21792
  v_mfma_f32_16x16x32_bf16 v[100:103], a[16:19], a[172:175], v[100:103]
  ds_read_b64_tr_b16 a[46:47], v17 offset:25376
  v_mfma_f32_16x16x32_bf16 v[104:107], a[16:19], a[176:179], v[104:107]
  buffer_load_dwordx4 a[148:151], v15, s[28:31], s36 offen offset:3072 sc1
  v_mfma_f32_16x16x32_bf16 v[108:111], a[16:19], a[180:183], v[108:111]
  v_mfma_f32_16x16x32_bf16 v[112:115], a[20:23], a[168:171], v[112:115]
  ds_read_b64_tr_b16 a[48:49], v17 offset:7360
  v_mfma_f32_16x16x32_bf16 v[116:119], a[20:23], a[172:175], v[116:119]
  ds_read_b64_tr_b16 a[50:51], v17 offset:10944
  v_mfma_f32_16x16x32_bf16 v[120:123], a[20:23], a[176:179], v[120:123]
  v_mfma_f32_16x16x32_bf16 v[124:127], a[20:23], a[180:183], v[124:127]
  s_waitcnt lgkmcnt(10)
  v_mfma_f32_16x16x32_bf16 v[128:131], a[24:27], a[168:171], v[128:131]
  ds_read_b64_tr_b16 a[52:53], v17 offset:21824
  v_mfma_f32_16x16x32_bf16 v[132:135], a[24:27], a[172:175], v[132:135]
  ds_read_b64_tr_b16 a[54:55], v17 offset:25408
  v_mfma_f32_16x16x32_bf16 v[136:139], a[24:27], a[176:179], v[136:139]
  v_mfma_f32_16x16x32_bf16 v[140:143], a[24:27], a[180:183], v[140:143]
  s_waitcnt vmcnt(51) lgkmcnt(0)
  s_barrier
  v_mfma_f32_16x16x32_bf16 v[144:147], a[28:31], a[168:171], v[144:147]
  ds_read_b64_tr_b16 a[0:1], v4 offset:0
  v_mfma_f32_16x16x32_bf16 v[148:151], a[28:31], a[172:175], v[148:151]
  ds_read_b64_tr_b16 a[2:3], v4 offset:3584
  s_mov_b32 s36, 122880
  v_mfma_f32_16x16x32_bf16 v[152:155], a[28:31], a[176:179], v[152:155]
  buffer_load_dwordx4 a[152:155], v15, s[28:31], s36 offen offset:0 sc1
  v_mfma_f32_16x16x32_bf16 v[156:159], a[28:31], a[180:183], v[156:159]
  s_waitcnt lgkmcnt(10)
  v_mfma_f32_16x16x32_bf16 v[160:163], a[32:35], a[168:171], v[160:163]
  ds_read_b64_tr_b16 a[4:5], v4 offset:14464
  v_mfma_f32_16x16x32_bf16 v[164:167], a[32:35], a[172:175], v[164:167]
  ds_read_b64_tr_b16 a[6:7], v4 offset:18048
  v_mfma_f32_16x16x32_bf16 v[168:171], a[32:35], a[176:179], v[168:171]
  buffer_load_dwordx4 a[156:159], v15, s[28:31], s36 offen offset:1024 sc1
  v_mfma_f32_16x16x32_bf16 v[172:175], a[32:35], a[180:183], v[172:175]
  v_mfma_f32_16x16x32_bf16 v[176:179], a[36:39], a[168:171], v[176:179]
  ds_read_b64_tr_b16 a[8:9], v4 offset:7168
  v_mfma_f32_16x16x32_bf16 v[180:183], a[36:39], a[172:175], v[180:183]
  ds_read_b64_tr_b16 a[10:11], v4 offset:10752
  v_mfma_f32_16x16x32_bf16 v[184:187], a[36:39], a[176:179], v[184:187]
  buffer_load_dwordx4 a[160:163], v15, s[28:31], s36 offen offset:2048 sc1
  v_mfma_f32_16x16x32_bf16 v[188:191], a[36:39], a[180:183], v[188:191]
  s_waitcnt lgkmcnt(10)
  v_mfma_f32_16x16x32_bf16 v[192:195], a[40:43], a[168:171], v[192:195]
  ds_read_b64_tr_b16 a[12:13], v4 offset:21632
  v_mfma_f32_16x16x32_bf16 v[196:199], a[40:43], a[172:175], v[196:199]
  ds_read_b64_tr_b16 a[14:15], v4 offset:25216
  v_mfma_f32_16x16x32_bf16 v[200:203], a[40:43], a[176:179], v[200:203]
  v_mfma_f32_16x16x32_bf16 v[204:207], a[40:43], a[180:183], v[204:207]
  s_waitcnt vmcnt(38) lgkmcnt(0)
  s_barrier
  v_mfma_f32_16x16x32_bf16 v[208:211], a[44:47], a[168:171], v[208:211]
  ds_read_b64_tr_b16 a[16:17], v5 offset:0
  v_mfma_f32_16x16x32_bf16 v[212:215], a[44:47], a[172:175], v[212:215]
  ds_read_b64_tr_b16 a[18:19], v5 offset:3584
  v_mfma_f32_16x16x32_bf16 v[216:219], a[44:47], a[176:179], v[216:219]
  buffer_load_dwordx4 a[164:167], v15, s[28:31], s36 offen offset:3072 sc1
  v_mfma_f32_16x16x32_bf16 v[220:223], a[44:47], a[180:183], v[220:223]
  s_waitcnt lgkmcnt(10)
  v_mfma_f32_16x16x32_bf16 v[224:227], a[48:51], a[168:171], v[224:227]
  ds_read_b64_tr_b16 a[20:21], v5 offset:14464
  v_mfma_f32_16x16x32_bf16 v[228:231], a[48:51], a[172:175], v[228:231]
  ds_read_b64_tr_b16 a[22:23], v5 offset:18048
  v_mfma_f32_16x16x32_bf16 v[232:235], a[48:51], a[176:179], v[232:235]
  v_mfma_f32_16x16x32_bf16 v[236:239], a[48:51], a[180:183], v[236:239]
  v_mfma_f32_16x16x32_bf16 v[240:243], a[52:55], a[168:171], v[240:243]
  ds_read_b64_tr_b16 a[24:25], v5 offset:7168
  v_mfma_f32_16x16x32_bf16 v[244:247], a[52:55], a[172:175], v[244:247]
  ds_read_b64_tr_b16 a[26:27], v5 offset:10752
  v_mfma_f32_16x16x32_bf16 v[248:251], a[52:55], a[176:179], v[248:251]
  v_mfma_f32_16x16x32_bf16 v[252:255], a[52:55], a[180:183], v[252:255]
  s_waitcnt vmcnt(45) lgkmcnt(10)
  v_mfma_f32_16x16x32_bf16 v[32:35], a[0:3], a[56:59], v[32:35]
  ds_read_b64_tr_b16 a[28:29], v5 offset:21632
  v_mfma_f32_16x16x32_bf16 v[36:39], a[0:3], a[60:63], v[36:39]
  ds_read_b64_tr_b16 a[30:31], v5 offset:25216
  s_mov_b32 s36, 126976
  v_mfma_f32_16x16x32_bf16 v[40:43], a[0:3], a[64:67], v[40:43]
  buffer_load_dwordx4 a[168:171], v15, s[28:31], s36 offen offset:0 sc1
  v_mfma_f32_16x16x32_bf16 v[44:47], a[0:3], a[68:71], v[44:47]
  s_waitcnt vmcnt(23) lgkmcnt(0)
  s_barrier
  v_mfma_f32_16x16x32_bf16 v[48:51], a[4:7], a[56:59], v[48:51]
  ds_read_b64_tr_b16 a[32:33], v6 offset:0
  v_mfma_f32_16x16x32_bf16 v[52:55], a[4:7], a[60:63], v[52:55]
  ds_read_b64_tr_b16 a[34:35], v6 offset:3584
  v_mfma_f32_16x16x32_bf16 v[56:59], a[4:7], a[64:67], v[56:59]
  buffer_load_dwordx4 a[172:175], v15, s[28:31], s36 offen offset:1024 sc1
  v_mfma_f32_16x16x32_bf16 v[60:63], a[4:7], a[68:71], v[60:63]
  s_waitcnt vmcnt(39) lgkmcnt(10)
  v_mfma_f32_16x16x32_bf16 v[32:35], a[8:11], a[72:75], v[32:35]
  ds_read_b64_tr_b16 a[36:37], v6 offset:14464
  v_mfma_f32_16x16x32_bf16 v[36:39], a[8:11], a[76:79], v[36:39]
  ds_read_b64_tr_b16 a[38:39], v6 offset:18048
  v_mfma_f32_16x16x32_bf16 v[40:43], a[8:11], a[80:83], v[40:43]
  buffer_load_dwordx4 a[176:179], v15, s[28:31], s36 offen offset:2048 sc1
  v_mfma_f32_16x16x32_bf16 v[44:47], a[8:11], a[84:87], v[44:47]
  v_mfma_f32_16x16x32_bf16 v[48:51], a[12:15], a[72:75], v[48:51]
  ds_read_b64_tr_b16 a[40:41], v6 offset:7168
  v_mfma_f32_16x16x32_bf16 v[52:55], a[12:15], a[76:79], v[52:55]
  ds_read_b64_tr_b16 a[42:43], v6 offset:10752
  v_mfma_f32_16x16x32_bf16 v[56:59], a[12:15], a[80:83], v[56:59]
  buffer_load_dwordx4 a[180:183], v15, s[28:31], s36 offen offset:3072 sc1
  s_mov_b32 s100, s76
  v_lshrrev_b32 v3, 4, v2
  v_lshlrev_b32 v17, 1, v3
  v_and_b32 v8, 15, v2
  v_xor_b32 v17, v17, v8
  v_lshlrev_b32 v17, 4, v17
  v_lshl_add_u32 v17, v3, 11, v17
  s_lshl_b32 s76, s72, 8
  s_mul_i32 s77, s17, 229376
  s_add_u32 s76, s76, s77
  v_add_u32 v8, s76, v17
  v_add_u32 v9, 7168, v8
  v_xor_b32 v10, 128, v8
  v_add_u32 v10, 14336, v10
  v_add_u32 v11, 7168, v10
  s_lshl_b32 s33, s17, 12
  v_mfma_f32_16x16x32_bf16 v[60:63], a[12:15], a[84:87], v[60:63]
  s_mul_i32 s32, s70, 1835008
  s_waitcnt vmcnt(32) lgkmcnt(10)
  v_mfma_f32_16x16x32_bf16 v[32:35], a[16:19], a[88:91], v[32:35]
  ds_read_b64_tr_b16 a[44:45], v6 offset:21632
  s_lshl_b32 s16, s71, 2
  s_add_u32 s16, s16, s17
  v_mfma_f32_16x16x32_bf16 v[36:39], a[16:19], a[92:95], v[36:39]
  ds_read_b64_tr_b16 a[46:47], v6 offset:25216
  s_mul_i32 s76, s16, 458752
  v_mfma_f32_16x16x32_bf16 v[40:43], a[16:19], a[96:99], v[40:43]
  s_mul_i32 s77, s70, 114688
  v_mfma_f32_16x16x32_bf16 v[44:47], a[16:19], a[100:103], v[44:47]
  s_add_u32 s76, s76, s77
  s_waitcnt vmcnt(10) lgkmcnt(0)
  s_barrier
  v_mfma_f32_16x16x32_bf16 v[48:51], a[20:23], a[88:91], v[48:51]
  ds_read_b64_tr_b16 a[48:49], v7 offset:0
  s_add_u32 s76, s76, 12582912
  s_add_u32 s28, s6, s76
  s_addc_u32 s29, s7, 0
  v_mfma_f32_16x16x32_bf16 v[52:55], a[20:23], a[92:95], v[52:55]
  ds_read_b64_tr_b16 a[50:51], v7 offset:3584
  s_mov_b32 s30, 114688
  v_mfma_f32_16x16x32_bf16 v[56:59], a[20:23], a[96:99], v[56:59]
  s_lshl_b32 s76, s71, 5
  v_mfma_f32_16x16x32_bf16 v[60:63], a[20:23], a[100:103], v[60:63]
  s_lshl_b32 s77, s70, 1
  s_add_u32 s76, s76, s77
  s_waitcnt vmcnt(24) lgkmcnt(10)
  v_mfma_f32_16x16x32_bf16 v[32:35], a[24:27], a[104:107], v[32:35]
  ds_read_b64_tr_b16 a[52:53], v7 offset:14464
  s_lshl_b32 s76, s76, 7
  v_mfma_f32_16x16x32_bf16 v[36:39], a[24:27], a[108:111], v[36:39]
  ds_read_b64_tr_b16 a[54:55], v7 offset:18048
  s_add_u32 s77, s17, 2
  v_mfma_f32_16x16x32_bf16 v[40:43], a[24:27], a[112:115], v[40:43]
  s_lshl_b32 s77, s77, 17
  s_add_u32 s76, s76, s77
  v_mfma_f32_16x16x32_bf16 v[44:47], a[24:27], a[116:119], v[44:47]
  v_bfe_u32 v21, v2, 1, 2
  v_mfma_f32_16x16x32_bf16 v[48:51], a[28:31], a[104:107], v[48:51]
  ds_read_b64_tr_b16 a[0:1], v7 offset:7168
  v_lshlrev_b32 v21, 3, v21
  v_mfma_f32_16x16x32_bf16 v[52:55], a[28:31], a[108:111], v[52:55]
  ds_read_b64_tr_b16 a[2:3], v7 offset:10752
  v_and_b32 v17, 1, v2
  v_mfma_f32_16x16x32_bf16 v[56:59], a[28:31], a[112:115], v[56:59]
  v_add_u32 v21, v21, v17
  v_lshlrev_b32 v21, 7, v21
  v_mfma_f32_16x16x32_bf16 v[60:63], a[28:31], a[116:119], v[60:63]
  v_add_u32 v21, s76, v21
  s_waitcnt vmcnt(16) lgkmcnt(10)
  v_mfma_f32_16x16x32_bf16 v[32:35], a[32:35], a[120:123], v[32:35]
  ds_read_b64_tr_b16 a[4:5], v7 offset:21632
  s_add_u32 s77, s77, s101
  v_mfma_f32_16x16x32_bf16 v[36:39], a[32:35], a[124:127], v[36:39]
  ds_read_b64_tr_b16 a[6:7], v7 offset:25216
  s_lshl_b32 s76, s16, 10
  s_lshr_b32 s78, s72, 1
  v_mfma_f32_16x16x32_bf16 v[40:43], a[32:35], a[128:131], v[40:43]
  s_add_u32 s78, s78, 2
  v_mfma_f32_16x16x32_bf16 v[44:47], a[32:35], a[132:135], v[44:47]
  s_lshl_b32 s78, s78, 17
  v_mfma_f32_16x16x32_bf16 v[48:51], a[36:39], a[120:123], v[48:51]
  ds_read_b64_tr_b16 a[8:9], v4 offset:32
  s_add_u32 s76, s76, s78
  v_mfma_f32_16x16x32_bf16 v[52:55], a[36:39], a[124:127], v[52:55]
  ds_read_b64_tr_b16 a[10:11], v4 offset:3616
  v_and_b32 v17, 7, v2
  v_lshlrev_b32 v17, 7, v17
  v_mfma_f32_16x16x32_bf16 v[56:59], a[36:39], a[128:131], v[56:59]
  v_add_u32 v17, s76, v17
  v_mfma_f32_16x16x32_bf16 v[60:63], a[36:39], a[132:135], v[60:63]
  v_and_b32 v1, 8, v2
  s_waitcnt vmcnt(8) lgkmcnt(10)
  v_mfma_f32_16x16x32_bf16 v[32:35], a[40:43], a[136:139], v[32:35]
  ds_read_b64_tr_b16 a[12:13], v4 offset:14496
  v_cmp_ne_u32 vcc, 0, v1
  s_nop 1
  v_cndmask_b32 v21, v21, v17, vcc
  v_and_b32 v17, 3, v2
  v_mfma_f32_16x16x32_bf16 v[36:39], a[40:43], a[140:143], v[36:39]
  ds_read_b64_tr_b16 a[14:15], v4 offset:18080
  v_lshlrev_b32 v17, 8, v17
  v_mfma_f32_16x16x32_bf16 v[40:43], a[40:43], a[144:147], v[40:43]
  v_xor_b32 v17, s77, v17
  v_mfma_f32_16x16x32_bf16 v[44:47], a[40:43], a[148:151], v[44:47]
  v_and_b32 v1, 0, v2
  v_cmp_ne_u32 vcc, 0, v1
  s_nop 1
  v_cndmask_b32 v21, v21, v17, vcc
  v_mfma_f32_16x16x32_bf16 v[48:51], a[44:47], a[136:139], v[48:51]
  ds_read_b64_tr_b16 a[16:17], v4 offset:7200
  v_bfe_u32 v18, v2, 2, 2
  v_mfma_f32_16x16x32_bf16 v[52:55], a[44:47], a[140:143], v[52:55]
  ds_read_b64_tr_b16 a[18:19], v4 offset:10784
  v_lshlrev_b32 v17, 3, v3
  v_mfma_f32_16x16x32_bf16 v[56:59], a[44:47], a[144:147], v[56:59]
  v_add_u32 v17, v17, v18
  v_mfma_f32_16x16x32_bf16 v[60:63], a[44:47], a[148:151], v[60:63]
  v_lshlrev_b32 v16, 8, v17
  v_lshl_add_u32 v16, v18, 5, v16
  s_waitcnt vmcnt(4) lgkmcnt(10)
  v_mfma_f32_16x16x32_bf16 v[32:35], a[48:51], a[152:155], v[32:35]
  ds_read_b64_tr_b16 a[20:21], v4 offset:21664
  v_and_b32 v17, 1, v3
  v_mfma_f32_16x16x32_bf16 v[36:39], a[48:51], a[156:159], v[36:39]
  ds_read_b64_tr_b16 a[22:23], v4 offset:25248
  v_lshl_add_u32 v16, v17, 7, v16
  v_mfma_f32_16x16x32_bf16 v[40:43], a[48:51], a[160:163], v[40:43]
  v_and_b32 v18, 3, v2
  v_lshl_add_u32 v16, v18, 3, v16
  v_mfma_f32_16x16x32_bf16 v[44:47], a[48:51], a[164:167], v[44:47]
  v_and_b32 v18, 15, v2
  v_mfma_f32_16x16x32_bf16 v[48:51], a[52:55], a[152:155], v[48:51]
  ds_read_b64_tr_b16 a[24:25], v5 offset:32
  v_lshlrev_b32 v18, 4, v18
  v_mfma_f32_16x16x32_bf16 v[52:55], a[52:55], a[156:159], v[52:55]
  ds_read_b64_tr_b16 a[26:27], v5 offset:3616
  v_lshl_add_u32 v18, v17, 9, v18
  v_lshrrev_b32 v17, 1, v3
  v_mfma_f32_16x16x32_bf16 v[56:59], a[52:55], a[160:163], v[56:59]
  v_lshl_add_u32 v18, v17, 11, v18
  v_mfma_f32_16x16x32_bf16 v[60:63], a[52:55], a[164:167], v[60:63]
  s_lshl_b32 s76, s70, 6
  s_waitcnt vmcnt(0) lgkmcnt(10)
  v_mfma_f32_16x16x32_bf16 v[32:35], a[0:3], a[168:171], v[32:35]
  ds_read_b64_tr_b16 a[28:29], v5 offset:14496
  v_xor_b32 v16, s76, v16
  v_mfma_f32_16x16x32_bf16 v[36:39], a[0:3], a[172:175], v[36:39]
  ds_read_b64_tr_b16 a[30:31], v5 offset:18080
  s_lshl_b32 s79, s16, 17
  s_lshl_b32 s78, s72, 13
  v_mfma_f32_16x16x32_bf16 v[40:43], a[0:3], a[176:179], v[40:43]
  s_add_u32 s79, s79, s78
  v_mfma_f32_16x16x32_bf16 v[44:47], a[0:3], a[180:183], v[44:47]
  s_lshl_b32 s78, s70, 11
  v_mfma_f32_16x16x32_bf16 v[48:51], a[4:7], a[168:171], v[48:51]
  ds_read_b64_tr_b16 a[32:33], v5 offset:7200
  s_add_u32 s79, s79, s78
  v_mfma_f32_16x16x32_bf16 v[52:55], a[4:7], a[172:175], v[52:55]
  ds_read_b64_tr_b16 a[34:35], v5 offset:10784
  v_mfma_f32_16x16x32_bf16 v[56:59], a[4:7], a[176:179], v[56:59]
  buffer_store_dwordx4 a[184:187], v23, s[20:23], s100 offen sc1
  s_add_u32 s100, s100, 4096
  v_mfma_f32_16x16x32_bf16 v[60:63], a[4:7], a[180:183], v[60:63]
  buffer_store_dwordx4 a[188:191], v23, s[20:23], s100 offen sc1
  s_add_u32 s100, s100, 4096
  buffer_store_dwordx4 a[192:195], v23, s[20:23], s100 offen sc1
  s_add_u32 s100, s100, 4096
  buffer_store_dwordx4 a[196:199], v23, s[20:23], s100 offen sc1
  s_add_u32 s100, s100, 4096
  s_waitcnt lgkmcnt(10)
  v_mfma_f32_16x16x32_bf16 v[64:67], a[8:11], a[56:59], v[64:67]
  ds_read_b64_tr_b16 a[36:37], v5 offset:21664
  v_mfma_f32_16x16x32_bf16 v[68:71], a[8:11], a[60:63], v[68:71]
  ds_read_b64_tr_b16 a[38:39], v5 offset:25248
  v_mfma_f32_16x16x32_bf16 v[72:75], a[8:11], a[64:67], v[72:75]
  v_mfma_f32_16x16x32_bf16 v[76:79], a[8:11], a[68:71], v[76:79]
  v_mfma_f32_16x16x32_bf16 v[80:83], a[12:15], a[56:59], v[80:83]
  ds_read_b64_tr_b16 a[40:41], v6 offset:32
  v_mfma_f32_16x16x32_bf16 v[84:87], a[12:15], a[60:63], v[84:87]
  ds_read_b64_tr_b16 a[42:43], v6 offset:3616
  v_mfma_f32_16x16x32_bf16 v[88:91], a[12:15], a[64:67], v[88:91]
  v_mul_f32 v22, v32, v32
  v_mul_f32 v23, v33, v33
  v_mul_f32 v24, v34, v34
  v_mul_f32 v25, v35, v35
  v_mfma_f32_16x16x32_bf16 v[92:95], a[12:15], a[68:71], v[92:95]
  v_mul_f32 v26, v36, v36
  v_mul_f32 v27, v37, v37
  v_mul_f32 v28, v38, v38
  s_waitcnt lgkmcnt(10)
  v_mfma_f32_16x16x32_bf16 v[64:67], a[16:19], a[72:75], v[64:67]
  ds_read_b64_tr_b16 a[44:45], v6 offset:14496
  v_mul_f32 v29, v39, v39
  v_fma_f32 v22, v22, s44, v30
  v_fma_f32 v23, v23, s44, v30
  v_mfma_f32_16x16x32_bf16 v[68:71], a[16:19], a[76:79], v[68:71]
  ds_read_b64_tr_b16 a[46:47], v6 offset:18080
  v_fma_f32 v24, v24, s44, v30
  v_fma_f32 v25, v25, s44, v30
  v_fma_f32 v26, v26, s44, v30
  v_mfma_f32_16x16x32_bf16 v[72:75], a[16:19], a[80:83], v[72:75]
  v_fma_f32 v27, v27, s44, v30
  v_fma_f32 v28, v28, s44, v30
  v_fma_f32 v29, v29, s44, v30
  v_mfma_f32_16x16x32_bf16 v[76:79], a[16:19], a[84:87], v[76:79]
  v_mul_f32 v22, v22, v32
  v_mul_f32 v23, v23, v33
  v_mul_f32 v24, v24, v34
  v_mfma_f32_16x16x32_bf16 v[80:83], a[20:23], a[72:75], v[80:83]
  ds_read_b64_tr_b16 a[48:49], v6 offset:7200
  v_mul_f32 v25, v25, v35
  v_mul_f32 v26, v26, v36
  v_mul_f32 v27, v27, v37
  v_mfma_f32_16x16x32_bf16 v[84:87], a[20:23], a[76:79], v[84:87]
  ds_read_b64_tr_b16 a[50:51], v6 offset:10784
  v_mul_f32 v28, v28, v38
  v_mul_f32 v29, v29, v39
  v_exp_f32 v22, v22
  v_mfma_f32_16x16x32_bf16 v[88:91], a[20:23], a[80:83], v[88:91]
  v_mul_f32 v48, v48, v32
  v_exp_f32 v23, v23
  v_mfma_f32_16x16x32_bf16 v[92:95], a[20:23], a[84:87], v[92:95]
  v_mul_f32 v49, v49, v33
  v_exp_f32 v24, v24
  s_waitcnt lgkmcnt(10)
  v_mfma_f32_16x16x32_bf16 v[64:67], a[24:27], a[88:91], v[64:67]
  ds_read_b64_tr_b16 a[52:53], v6 offset:21664
  v_mul_f32 v50, v50, v34
  v_exp_f32 v25, v25
  v_mfma_f32_16x16x32_bf16 v[68:71], a[24:27], a[92:95], v[68:71]
  ds_read_b64_tr_b16 a[54:55], v6 offset:25248
  v_mul_f32 v51, v51, v35
  v_exp_f32 v26, v26
  v_mfma_f32_16x16x32_bf16 v[72:75], a[24:27], a[96:99], v[72:75]
  v_mul_f32 v52, v52, v36
  v_exp_f32 v27, v27
  v_mfma_f32_16x16x32_bf16 v[76:79], a[24:27], a[100:103], v[76:79]
  v_mul_f32 v53, v53, v37
  v_exp_f32 v28, v28
  v_mfma_f32_16x16x32_bf16 v[80:83], a[28:31], a[88:91], v[80:83]
  ds_read_b64_tr_b16 a[0:1], v7 offset:32
  v_mul_f32 v54, v54, v38
  v_exp_f32 v29, v29
  v_mfma_f32_16x16x32_bf16 v[84:87], a[28:31], a[92:95], v[84:87]
  ds_read_b64_tr_b16 a[2:3], v7 offset:3616
  v_mul_f32 v55, v55, v39
  v_add_f32 v22, 1.0, v22
  v_mfma_f32_16x16x32_bf16 v[88:91], a[28:31], a[96:99], v[88:91]
  v_add_f32 v23, 1.0, v23
  v_add_f32 v24, 1.0, v24
  v_add_f32 v25, 1.0, v25
  v_mfma_f32_16x16x32_bf16 v[92:95], a[28:31], a[100:103], v[92:95]
  v_add_f32 v26, 1.0, v26
  v_add_f32 v27, 1.0, v27
  v_add_f32 v28, 1.0, v28
  s_waitcnt lgkmcnt(10)
  v_mfma_f32_16x16x32_bf16 v[64:67], a[32:35], a[104:107], v[64:67]
  ds_read_b64_tr_b16 a[4:5], v7 offset:14496
  v_add_f32 v29, 1.0, v29
  v_rcp_f32 v22, v22
  v_mfma_f32_16x16x32_bf16 v[68:71], a[32:35], a[108:111], v[68:71]
  ds_read_b64_tr_b16 a[6:7], v7 offset:18080
  v_rcp_f32 v23, v23
  v_rcp_f32 v24, v24
  v_mfma_f32_16x16x32_bf16 v[72:75], a[32:35], a[112:115], v[72:75]
  v_rcp_f32 v25, v25
  v_mfma_f32_16x16x32_bf16 v[76:79], a[32:35], a[116:119], v[76:79]
  v_rcp_f32 v26, v26
  v_rcp_f32 v27, v27
  v_mfma_f32_16x16x32_bf16 v[80:83], a[36:39], a[104:107], v[80:83]
  ds_read_b64_tr_b16 a[8:9], v7 offset:7200
  v_rcp_f32 v28, v28
  v_mfma_f32_16x16x32_bf16 v[84:87], a[36:39], a[108:111], v[84:87]
  ds_read_b64_tr_b16 a[10:11], v7 offset:10784
  v_rcp_f32 v29, v29
  v_mul_f32 v48, v48, v22
  v_mfma_f32_16x16x32_bf16 v[88:91], a[36:39], a[112:115], v[88:91]
  v_mul_f32 v49, v49, v23
  v_mul_f32 v50, v50, v24
  v_mul_f32 v51, v51, v25
  v_mfma_f32_16x16x32_bf16 v[92:95], a[36:39], a[116:119], v[92:95]
  v_mul_f32 v52, v52, v26
  v_mul_f32 v53, v53, v27
  v_mul_f32 v54, v54, v28
  s_waitcnt lgkmcnt(10)
  v_mfma_f32_16x16x32_bf16 v[64:67], a[40:43], a[120:123], v[64:67]
  ds_read_b64_tr_b16 a[12:13], v7 offset:21664
  v_mul_f32 v55, v55, v29
  v_cvt_pk_bf16_f32 v32, v48, v49
  v_cvt_pk_bf16_f32 v34, v52, v53
  v_mfma_f32_16x16x32_bf16 v[68:71], a[40:43], a[124:127], v[68:71]
  ds_read_b64_tr_b16 a[14:15], v7 offset:25248
  v_cvt_pk_bf16_f32 v33, v50, v51
  v_cvt_pk_bf16_f32 v35, v54, v55
  v_permlane16_swap_b32 v32, v34
  v_mfma_f32_16x16x32_bf16 v[72:75], a[40:43], a[128:131], v[72:75]
  s_nop 0
  v_permlane16_swap_b32 v33, v35
  buffer_store_dwordx4 v[32:35], v15, s[40:43], s46 offen sc1
  s_add_u32 s46, s46, 16384
  v_mfma_f32_16x16x32_bf16 v[76:79], a[40:43], a[132:135], v[76:79]
  v_mul_f32 v22, v40, v40
  v_mul_f32 v23, v41, v41
  v_mul_f32 v24, v42, v42
  v_mul_f32 v25, v43, v43
  v_mfma_f32_16x16x32_bf16 v[80:83], a[44:47], a[120:123], v[80:83]
  ds_read_b64_tr_b16 a[16:17], v4 offset:64
  v_mul_f32 v26, v44, v44
  v_mul_f32 v27, v45, v45
  v_mul_f32 v28, v46, v46
  v_mfma_f32_16x16x32_bf16 v[84:87], a[44:47], a[124:127], v[84:87]
  ds_read_b64_tr_b16 a[18:19], v4 offset:3648
  v_mul_f32 v29, v47, v47
  v_fma_f32 v22, v22, s44, v30
  v_fma_f32 v23, v23, s44, v30
  v_mfma_f32_16x16x32_bf16 v[88:91], a[44:47], a[128:131], v[88:91]
  v_fma_f32 v24, v24, s44, v30
  v_fma_f32 v25, v25, s44, v30
  v_fma_f32 v26, v26, s44, v30
  v_mfma_f32_16x16x32_bf16 v[92:95], a[44:47], a[132:135], v[92:95]
  v_fma_f32 v27, v27, s44, v30
  v_fma_f32 v28, v28, s44, v30
  v_fma_f32 v29, v29, s44, v30
  s_waitcnt lgkmcnt(10)
  v_mfma_f32_16x16x32_bf16 v[64:67], a[48:51], a[136:139], v[64:67]
  ds_read_b64_tr_b16 a[20:21], v4 offset:14528
  v_mul_f32 v22, v22, v40
  v_mul_f32 v23, v23, v41
  v_mul_f32 v24, v24, v42
  v_mfma_f32_16x16x32_bf16 v[68:71], a[48:51], a[140:143], v[68:71]
  ds_read_b64_tr_b16 a[22:23], v4 offset:18112
  v_mul_f32 v25, v25, v43
  v_mul_f32 v26, v26, v44
  v_mul_f32 v27, v27, v45
  v_mfma_f32_16x16x32_bf16 v[72:75], a[48:51], a[144:147], v[72:75]
  v_mul_f32 v28, v28, v46
  v_mul_f32 v29, v29, v47
  v_exp_f32 v22, v22
  v_mfma_f32_16x16x32_bf16 v[76:79], a[48:51], a[148:151], v[76:79]
  v_mul_f32 v56, v56, v40
  v_exp_f32 v23, v23
  v_mfma_f32_16x16x32_bf16 v[80:83], a[52:55], a[136:139], v[80:83]
  ds_read_b64_tr_b16 a[24:25], v4 offset:7232
  v_mul_f32 v57, v57, v41
  v_exp_f32 v24, v24
  v_mfma_f32_16x16x32_bf16 v[84:87], a[52:55], a[140:143], v[84:87]
  ds_read_b64_tr_b16 a[26:27], v4 offset:10816
  v_mul_f32 v58, v58, v42
  v_exp_f32 v25, v25
  v_mfma_f32_16x16x32_bf16 v[88:91], a[52:55], a[144:147], v[88:91]
  v_mul_f32 v59, v59, v43
  v_exp_f32 v26, v26
  v_mfma_f32_16x16x32_bf16 v[92:95], a[52:55], a[148:151], v[92:95]
  v_mul_f32 v60, v60, v44
  v_exp_f32 v27, v27
  s_waitcnt lgkmcnt(10)
  v_mfma_f32_16x16x32_bf16 v[64:67], a[0:3], a[152:155], v[64:67]
  ds_read_b64_tr_b16 a[28:29], v4 offset:21696
  v_mul_f32 v61, v61, v45
  v_exp_f32 v28, v28
  v_mfma_f32_16x16x32_bf16 v[68:71], a[0:3], a[156:159], v[68:71]
  ds_read_b64_tr_b16 a[30:31], v4 offset:25280
  v_mul_f32 v62, v62, v46
  v_exp_f32 v29, v29
  v_mfma_f32_16x16x32_bf16 v[72:75], a[0:3], a[160:163], v[72:75]
  v_mul_f32 v63, v63, v47
  v_add_f32 v22, 1.0, v22
  v_mfma_f32_16x16x32_bf16 v[76:79], a[0:3], a[164:167], v[76:79]
  v_add_f32 v23, 1.0, v23
  v_add_f32 v24, 1.0, v24
  v_add_f32 v25, 1.0, v25
  v_mfma_f32_16x16x32_bf16 v[80:83], a[4:7], a[152:155], v[80:83]
  ds_read_b64_tr_b16 a[32:33], v5 offset:64
  v_add_f32 v26, 1.0, v26
  v_add_f32 v27, 1.0, v27
  v_add_f32 v28, 1.0, v28
  v_mfma_f32_16x16x32_bf16 v[84:87], a[4:7], a[156:159], v[84:87]
  ds_read_b64_tr_b16 a[34:35], v5 offset:3648
  v_add_f32 v29, 1.0, v29
  v_rcp_f32 v22, v22
  v_mfma_f32_16x16x32_bf16 v[88:91], a[4:7], a[160:163], v[88:91]
  v_rcp_f32 v23, v23
  v_rcp_f32 v24, v24
  v_mfma_f32_16x16x32_bf16 v[92:95], a[4:7], a[164:167], v[92:95]
  v_rcp_f32 v25, v25
  s_waitcnt lgkmcnt(10)
  v_mfma_f32_16x16x32_bf16 v[64:67], a[8:11], a[168:171], v[64:67]
  ds_read_b64_tr_b16 a[36:37], v5 offset:14528
  v_rcp_f32 v26, v26
  v_rcp_f32 v27, v27
  v_mfma_f32_16x16x32_bf16 v[68:71], a[8:11], a[172:175], v[68:71]
  ds_read_b64_tr_b16 a[38:39], v5 offset:18112
  v_rcp_f32 v28, v28
  v_mfma_f32_16x16x32_bf16 v[72:75], a[8:11], a[176:179], v[72:75]
  v_rcp_f32 v29, v29
  v_mul_f32 v56, v56, v22
  v_mfma_f32_16x16x32_bf16 v[76:79], a[8:11], a[180:183], v[76:79]
  v_mul_f32 v57, v57, v23
  v_mul_f32 v58, v58, v24
  v_mul_f32 v59, v59, v25
  v_mfma_f32_16x16x32_bf16 v[80:83], a[12:15], a[168:171], v[80:83]
  ds_read_b64_tr_b16 a[40:41], v5 offset:7232
  v_mul_f32 v60, v60, v26
  v_mul_f32 v61, v61, v27
  v_mul_f32 v62, v62, v28
  v_mfma_f32_16x16x32_bf16 v[84:87], a[12:15], a[172:175], v[84:87]
  ds_read_b64_tr_b16 a[42:43], v5 offset:10816
  v_mul_f32 v63, v63, v29
  v_cvt_pk_bf16_f32 v40, v56, v57
  v_cvt_pk_bf16_f32 v42, v60, v61
  v_mfma_f32_16x16x32_bf16 v[88:91], a[12:15], a[176:179], v[88:91]
  v_cvt_pk_bf16_f32 v41, v58, v59
  v_cvt_pk_bf16_f32 v43, v62, v63
  v_permlane16_swap_b32 v40, v42
  v_mfma_f32_16x16x32_bf16 v[92:95], a[12:15], a[180:183], v[92:95]
  s_nop 0
  v_permlane16_swap_b32 v41, v43
  buffer_store_dwordx4 v[40:43], v15, s[40:43], s47 offen sc1
  s_add_u32 s47, s47, 16384
  s_waitcnt lgkmcnt(10)
  v_mfma_f32_16x16x32_bf16 v[96:99], a[16:19], a[56:59], v[96:99]
  ds_read_b64_tr_b16 a[44:45], v5 offset:21696
  v_mfma_f32_16x16x32_bf16 v[100:103], a[16:19], a[60:63], v[100:103]
  ds_read_b64_tr_b16 a[46:47], v5 offset:25280
  v_mfma_f32_16x16x32_bf16 v[104:107], a[16:19], a[64:67], v[104:107]
  v_mfma_f32_16x16x32_bf16 v[108:111], a[16:19], a[68:71], v[108:111]
  v_mfma_f32_16x16x32_bf16 v[112:115], a[20:23], a[56:59], v[112:115]
  ds_read_b64_tr_b16 a[48:49], v6 offset:64
  v_mfma_f32_16x16x32_bf16 v[116:119], a[20:23], a[60:63], v[116:119]
  ds_read_b64_tr_b16 a[50:51], v6 offset:3648
  v_mfma_f32_16x16x32_bf16 v[120:123], a[20:23], a[64:67], v[120:123]
  v_mul_f32 v22, v64, v64
  v_mul_f32 v23, v65, v65
  v_mul_f32 v24, v66, v66
  v_mul_f32 v25, v67, v67
  v_mfma_f32_16x16x32_bf16 v[124:127], a[20:23], a[68:71], v[124:127]
  v_mul_f32 v26, v68, v68
  v_mul_f32 v27, v69, v69
  v_mul_f32 v28, v70, v70
  s_waitcnt lgkmcnt(10)
  v_mfma_f32_16x16x32_bf16 v[96:99], a[24:27], a[72:75], v[96:99]
  ds_read_b64_tr_b16 a[52:53], v6 offset:14528
  v_mul_f32 v29, v71, v71
  v_fma_f32 v22, v22, s44, v30
  v_fma_f32 v23, v23, s44, v30
  v_mfma_f32_16x16x32_bf16 v[100:103], a[24:27], a[76:79], v[100:103]
  ds_read_b64_tr_b16 a[54:55], v6 offset:18112
  v_fma_f32 v24, v24, s44, v30
  v_fma_f32 v25, v25, s44, v30
  v_fma_f32 v26, v26, s44, v30
  v_mfma_f32_16x16x32_bf16 v[104:107], a[24:27], a[80:83], v[104:107]
  v_fma_f32 v27, v27, s44, v30
  v_fma_f32 v28, v28, s44, v30
  v_fma_f32 v29, v29, s44, v30
  v_mfma_f32_16x16x32_bf16 v[108:111], a[24:27], a[84:87], v[108:111]
  v_mul_f32 v22, v22, v64
  v_mul_f32 v23, v23, v65
  v_mul_f32 v24, v24, v66
  v_mfma_f32_16x16x32_bf16 v[112:115], a[28:31], a[72:75], v[112:115]
  ds_read_b64_tr_b16 a[0:1], v6 offset:7232
  v_mul_f32 v25, v25, v67
  v_mul_f32 v26, v26, v68
  v_mul_f32 v27, v27, v69
  v_mfma_f32_16x16x32_bf16 v[116:119], a[28:31], a[76:79], v[116:119]
  ds_read_b64_tr_b16 a[2:3], v6 offset:10816
  v_mul_f32 v28, v28, v70
  v_mul_f32 v29, v29, v71
  v_exp_f32 v22, v22
  v_mfma_f32_16x16x32_bf16 v[120:123], a[28:31], a[80:83], v[120:123]
  v_mul_f32 v80, v80, v64
  v_exp_f32 v23, v23
  v_mfma_f32_16x16x32_bf16 v[124:127], a[28:31], a[84:87], v[124:127]
  v_mul_f32 v81, v81, v65
  v_exp_f32 v24, v24
  s_waitcnt lgkmcnt(10)
  v_mfma_f32_16x16x32_bf16 v[96:99], a[32:35], a[88:91], v[96:99]
  ds_read_b64_tr_b16 a[4:5], v6 offset:21696
  v_mul_f32 v82, v82, v66
  v_exp_f32 v25, v25
  v_mfma_f32_16x16x32_bf16 v[100:103], a[32:35], a[92:95], v[100:103]
  ds_read_b64_tr_b16 a[6:7], v6 offset:25280
  v_mul_f32 v83, v83, v67
  v_exp_f32 v26, v26
  v_mfma_f32_16x16x32_bf16 v[104:107], a[32:35], a[96:99], v[104:107]
  v_mul_f32 v84, v84, v68
  v_exp_f32 v27, v27
  v_mfma_f32_16x16x32_bf16 v[108:111], a[32:35], a[100:103], v[108:111]
  v_mul_f32 v85, v85, v69
  v_exp_f32 v28, v28
  v_mfma_f32_16x16x32_bf16 v[112:115], a[36:39], a[88:91], v[112:115]
  ds_read_b64_tr_b16 a[8:9], v7 offset:64
  v_mul_f32 v86, v86, v70
  v_exp_f32 v29, v29
  v_mfma_f32_16x16x32_bf16 v[116:119], a[36:39], a[92:95], v[116:119]
  ds_read_b64_tr_b16 a[10:11], v7 offset:3648
  v_mul_f32 v87, v87, v71
  v_add_f32 v22, 1.0, v22
  v_mfma_f32_16x16x32_bf16 v[120:123], a[36:39], a[96:99], v[120:123]
  v_add_f32 v23, 1.0, v23
  v_add_f32 v24, 1.0, v24
  v_add_f32 v25, 1.0, v25
  v_mfma_f32_16x16x32_bf16 v[124:127], a[36:39], a[100:103], v[124:127]
  v_add_f32 v26, 1.0, v26
  v_add_f32 v27, 1.0, v27
  v_add_f32 v28, 1.0, v28
  s_waitcnt lgkmcnt(10)
  v_mfma_f32_16x16x32_bf16 v[96:99], a[40:43], a[104:107], v[96:99]
  ds_read_b64_tr_b16 a[12:13], v7 offset:14528
  v_add_f32 v29, 1.0, v29
  v_rcp_f32 v22, v22
  v_mfma_f32_16x16x32_bf16 v[100:103], a[40:43], a[108:111], v[100:103]
  ds_read_b64_tr_b16 a[14:15], v7 offset:18112
  v_rcp_f32 v23, v23
  v_rcp_f32 v24, v24
  v_mfma_f32_16x16x32_bf16 v[104:107], a[40:43], a[112:115], v[104:107]
  v_rcp_f32 v25, v25
  v_mfma_f32_16x16x32_bf16 v[108:111], a[40:43], a[116:119], v[108:111]
  v_rcp_f32 v26, v26
  v_rcp_f32 v27, v27
  v_mfma_f32_16x16x32_bf16 v[112:115], a[44:47], a[104:107], v[112:115]
  ds_read_b64_tr_b16 a[16:17], v7 offset:7232
  v_rcp_f32 v28, v28
  v_mfma_f32_16x16x32_bf16 v[116:119], a[44:47], a[108:111], v[116:119]
  ds_read_b64_tr_b16 a[18:19], v7 offset:10816
  v_rcp_f32 v29, v29
  v_mul_f32 v80, v80, v22
  v_mfma_f32_16x16x32_bf16 v[120:123], a[44:47], a[112:115], v[120:123]
  v_mul_f32 v81, v81, v23
  v_mul_f32 v82, v82, v24
  v_mul_f32 v83, v83, v25
  v_mfma_f32_16x16x32_bf16 v[124:127], a[44:47], a[116:119], v[124:127]
  v_mul_f32 v84, v84, v26
  v_mul_f32 v85, v85, v27
  v_mul_f32 v86, v86, v28
  s_waitcnt lgkmcnt(10)
  v_mfma_f32_16x16x32_bf16 v[96:99], a[48:51], a[120:123], v[96:99]
  ds_read_b64_tr_b16 a[20:21], v7 offset:21696
  v_mul_f32 v87, v87, v29
  v_cvt_pk_bf16_f32 v64, v80, v81
  v_cvt_pk_bf16_f32 v66, v84, v85
  v_mfma_f32_16x16x32_bf16 v[100:103], a[48:51], a[124:127], v[100:103]
  ds_read_b64_tr_b16 a[22:23], v7 offset:25280
  v_cvt_pk_bf16_f32 v65, v82, v83
  v_cvt_pk_bf16_f32 v67, v86, v87
  v_permlane16_swap_b32 v64, v66
  v_mfma_f32_16x16x32_bf16 v[104:107], a[48:51], a[128:131], v[104:107]
  s_nop 0
  v_permlane16_swap_b32 v65, v67
  buffer_store_dwordx4 v[64:67], v15, s[40:43], s46 offen sc1
  s_add_u32 s46, s46, 16384
  v_mfma_f32_16x16x32_bf16 v[108:111], a[48:51], a[132:135], v[108:111]
  v_mul_f32 v22, v72, v72
  v_mul_f32 v23, v73, v73
  v_mul_f32 v24, v74, v74
  v_mul_f32 v25, v75, v75
  v_mfma_f32_16x16x32_bf16 v[112:115], a[52:55], a[120:123], v[112:115]
  ds_read_b64_tr_b16 a[24:25], v4 offset:96
  v_mul_f32 v26, v76, v76
  v_mul_f32 v27, v77, v77
  v_mul_f32 v28, v78, v78
  v_mfma_f32_16x16x32_bf16 v[116:119], a[52:55], a[124:127], v[116:119]
  ds_read_b64_tr_b16 a[26:27], v4 offset:3680
  v_mul_f32 v29, v79, v79
  v_fma_f32 v22, v22, s44, v30
  v_fma_f32 v23, v23, s44, v30
  v_mfma_f32_16x16x32_bf16 v[120:123], a[52:55], a[128:131], v[120:123]
  v_fma_f32 v24, v24, s44, v30
  v_fma_f32 v25, v25, s44, v30
  v_fma_f32 v26, v26, s44, v30
  v_mfma_f32_16x16x32_bf16 v[124:127], a[52:55], a[132:135], v[124:127]
  v_fma_f32 v27, v27, s44, v30
  v_fma_f32 v28, v28, s44, v30
  v_fma_f32 v29, v29, s44, v30
  s_waitcnt lgkmcnt(10)
  v_mfma_f32_16x16x32_bf16 v[96:99], a[0:3], a[136:139], v[96:99]
  ds_read_b64_tr_b16 a[28:29], v4 offset:14560
  v_mul_f32 v22, v22, v72
  v_mul_f32 v23, v23, v73
  v_mul_f32 v24, v24, v74
  v_mfma_f32_16x16x32_bf16 v[100:103], a[0:3], a[140:143], v[100:103]
  ds_read_b64_tr_b16 a[30:31], v4 offset:18144
  v_mul_f32 v25, v25, v75
  v_mul_f32 v26, v26, v76
  v_mul_f32 v27, v27, v77
  v_mfma_f32_16x16x32_bf16 v[104:107], a[0:3], a[144:147], v[104:107]
  v_mul_f32 v28, v28, v78
  v_mul_f32 v29, v29, v79
  v_exp_f32 v22, v22
  v_mfma_f32_16x16x32_bf16 v[108:111], a[0:3], a[148:151], v[108:111]
  v_mul_f32 v88, v88, v72
  v_exp_f32 v23, v23
  v_mfma_f32_16x16x32_bf16 v[112:115], a[4:7], a[136:139], v[112:115]
  ds_read_b64_tr_b16 a[32:33], v4 offset:7264
  v_mul_f32 v89, v89, v73
  v_exp_f32 v24, v24
  v_mfma_f32_16x16x32_bf16 v[116:119], a[4:7], a[140:143], v[116:119]
  ds_read_b64_tr_b16 a[34:35], v4 offset:10848
  v_mul_f32 v90, v90, v74
  v_exp_f32 v25, v25
  v_mfma_f32_16x16x32_bf16 v[120:123], a[4:7], a[144:147], v[120:123]
  v_mul_f32 v91, v91, v75
  v_exp_f32 v26, v26
  v_mfma_f32_16x16x32_bf16 v[124:127], a[4:7], a[148:151], v[124:127]
  v_mul_f32 v92, v92, v76
  v_exp_f32 v27, v27
  s_waitcnt lgkmcnt(10)
  v_mfma_f32_16x16x32_bf16 v[96:99], a[8:11], a[152:155], v[96:99]
  ds_read_b64_tr_b16 a[36:37], v4 offset:21728
  v_mul_f32 v93, v93, v77
  v_exp_f32 v28, v28
  v_mfma_f32_16x16x32_bf16 v[100:103], a[8:11], a[156:159], v[100:103]
  ds_read_b64_tr_b16 a[38:39], v4 offset:25312
  v_mul_f32 v94, v94, v78
  v_exp_f32 v29, v29
  v_mfma_f32_16x16x32_bf16 v[104:107], a[8:11], a[160:163], v[104:107]
  v_mul_f32 v95, v95, v79
  v_add_f32 v22, 1.0, v22
  v_mfma_f32_16x16x32_bf16 v[108:111], a[8:11], a[164:167], v[108:111]
  v_add_f32 v23, 1.0, v23
  v_add_f32 v24, 1.0, v24
  v_add_f32 v25, 1.0, v25
  v_mfma_f32_16x16x32_bf16 v[112:115], a[12:15], a[152:155], v[112:115]
  ds_read_b64_tr_b16 a[40:41], v5 offset:96
  v_add_f32 v26, 1.0, v26
  v_add_f32 v27, 1.0, v27
  v_add_f32 v28, 1.0, v28
  v_mfma_f32_16x16x32_bf16 v[116:119], a[12:15], a[156:159], v[116:119]
  ds_read_b64_tr_b16 a[42:43], v5 offset:3680
  v_add_f32 v29, 1.0, v29
  v_rcp_f32 v22, v22
  v_mfma_f32_16x16x32_bf16 v[120:123], a[12:15], a[160:163], v[120:123]
  v_rcp_f32 v23, v23
  v_rcp_f32 v24, v24
  v_mfma_f32_16x16x32_bf16 v[124:127], a[12:15], a[164:167], v[124:127]
  v_rcp_f32 v25, v25
  s_waitcnt lgkmcnt(10)
  v_mfma_f32_16x16x32_bf16 v[96:99], a[16:19], a[168:171], v[96:99]
  ds_read_b64_tr_b16 a[44:45], v5 offset:14560
  v_rcp_f32 v26, v26
  v_rcp_f32 v27, v27
  v_mfma_f32_16x16x32_bf16 v[100:103], a[16:19], a[172:175], v[100:103]
  ds_read_b64_tr_b16 a[46:47], v5 offset:18144
  v_rcp_f32 v28, v28
  v_mfma_f32_16x16x32_bf16 v[104:107], a[16:19], a[176:179], v[104:107]
  v_rcp_f32 v29, v29
  v_mul_f32 v88, v88, v22
  v_mfma_f32_16x16x32_bf16 v[108:111], a[16:19], a[180:183], v[108:111]
  v_mul_f32 v89, v89, v23
  v_mul_f32 v90, v90, v24
  v_mul_f32 v91, v91, v25
  v_mfma_f32_16x16x32_bf16 v[112:115], a[20:23], a[168:171], v[112:115]
  ds_read_b64_tr_b16 a[48:49], v5 offset:7264
  v_mul_f32 v92, v92, v26
  v_mul_f32 v93, v93, v27
  v_mul_f32 v94, v94, v28
  v_mfma_f32_16x16x32_bf16 v[116:119], a[20:23], a[172:175], v[116:119]
  ds_read_b64_tr_b16 a[50:51], v5 offset:10848
  v_mul_f32 v95, v95, v29
  v_cvt_pk_bf16_f32 v72, v88, v89
  v_cvt_pk_bf16_f32 v74, v92, v93
  v_mfma_f32_16x16x32_bf16 v[120:123], a[20:23], a[176:179], v[120:123]
  v_cvt_pk_bf16_f32 v73, v90, v91
  v_cvt_pk_bf16_f32 v75, v94, v95
  v_permlane16_swap_b32 v72, v74
  v_mfma_f32_16x16x32_bf16 v[124:127], a[20:23], a[180:183], v[124:127]
  s_nop 0
  v_permlane16_swap_b32 v73, v75
  buffer_store_dwordx4 v[72:75], v15, s[40:43], s47 offen sc1
  s_add_u32 s47, s47, 16384
  s_waitcnt lgkmcnt(10)
  v_mfma_f32_16x16x32_bf16 v[128:131], a[24:27], a[56:59], v[128:131]
  ds_read_b64_tr_b16 a[52:53], v5 offset:21728
  v_mfma_f32_16x16x32_bf16 v[132:135], a[24:27], a[60:63], v[132:135]
  ds_read_b64_tr_b16 a[54:55], v5 offset:25312
  v_mfma_f32_16x16x32_bf16 v[136:139], a[24:27], a[64:67], v[136:139]
  v_mfma_f32_16x16x32_bf16 v[140:143], a[24:27], a[68:71], v[140:143]
  v_mfma_f32_16x16x32_bf16 v[144:147], a[28:31], a[56:59], v[144:147]
  ds_read_b64_tr_b16 a[0:1], v6 offset:96
  v_mfma_f32_16x16x32_bf16 v[148:151], a[28:31], a[60:63], v[148:151]
  ds_read_b64_tr_b16 a[2:3], v6 offset:3680
  v_mfma_f32_16x16x32_bf16 v[152:155], a[28:31], a[64:67], v[152:155]
  v_mul_f32 v22, v96, v96
  v_mul_f32 v23, v97, v97
  v_mul_f32 v24, v98, v98
  v_mul_f32 v25, v99, v99
  v_mfma_f32_16x16x32_bf16 v[156:159], a[28:31], a[68:71], v[156:159]
  v_mul_f32 v26, v100, v100
  v_mul_f32 v27, v101, v101
  v_mul_f32 v28, v102, v102
  s_waitcnt lgkmcnt(10)
  v_mfma_f32_16x16x32_bf16 v[128:131], a[32:35], a[72:75], v[128:131]
  ds_read_b64_tr_b16 a[4:5], v6 offset:14560
  v_mul_f32 v29, v103, v103
  v_fma_f32 v22, v22, s44, v30
  v_fma_f32 v23, v23, s44, v30
  v_mfma_f32_16x16x32_bf16 v[132:135], a[32:35], a[76:79], v[132:135]
  ds_read_b64_tr_b16 a[6:7], v6 offset:18144
  v_fma_f32 v24, v24, s44, v30
  v_fma_f32 v25, v25, s44, v30
  v_fma_f32 v26, v26, s44, v30
  v_mfma_f32_16x16x32_bf16 v[136:139], a[32:35], a[80:83], v[136:139]
  v_fma_f32 v27, v27, s44, v30
  v_fma_f32 v28, v28, s44, v30
  v_fma_f32 v29, v29, s44, v30
  v_mfma_f32_16x16x32_bf16 v[140:143], a[32:35], a[84:87], v[140:143]
  v_mul_f32 v22, v22, v96
  v_mul_f32 v23, v23, v97
  v_mul_f32 v24, v24, v98
  v_mfma_f32_16x16x32_bf16 v[144:147], a[36:39], a[72:75], v[144:147]
  ds_read_b64_tr_b16 a[8:9], v6 offset:7264
  v_mul_f32 v25, v25, v99
  v_mul_f32 v26, v26, v100
  v_mul_f32 v27, v27, v101
  v_mfma_f32_16x16x32_bf16 v[148:151], a[36:39], a[76:79], v[148:151]
  ds_read_b64_tr_b16 a[10:11], v6 offset:10848
  v_mul_f32 v28, v28, v102
  v_mul_f32 v29, v29, v103
  v_exp_f32 v22, v22
  v_mfma_f32_16x16x32_bf16 v[152:155], a[36:39], a[80:83], v[152:155]
  v_mul_f32 v112, v112, v96
  v_exp_f32 v23, v23
  v_mfma_f32_16x16x32_bf16 v[156:159], a[36:39], a[84:87], v[156:159]
  v_mul_f32 v113, v113, v97
  v_exp_f32 v24, v24
  s_waitcnt lgkmcnt(10)
  v_mfma_f32_16x16x32_bf16 v[128:131], a[40:43], a[88:91], v[128:131]
  ds_read_b64_tr_b16 a[12:13], v6 offset:21728
  v_mul_f32 v114, v114, v98
  v_exp_f32 v25, v25
  v_mfma_f32_16x16x32_bf16 v[132:135], a[40:43], a[92:95], v[132:135]
  ds_read_b64_tr_b16 a[14:15], v6 offset:25312
  v_mul_f32 v115, v115, v99
  v_exp_f32 v26, v26
  v_mfma_f32_16x16x32_bf16 v[136:139], a[40:43], a[96:99], v[136:139]
  v_mul_f32 v116, v116, v100
  v_exp_f32 v27, v27
  v_mfma_f32_16x16x32_bf16 v[140:143], a[40:43], a[100:103], v[140:143]
  v_mul_f32 v117, v117, v101
  v_exp_f32 v28, v28
  v_mfma_f32_16x16x32_bf16 v[144:147], a[44:47], a[88:91], v[144:147]
  ds_read_b64_tr_b16 a[16:17], v7 offset:96
  v_mul_f32 v118, v118, v102
  v_exp_f32 v29, v29
  v_mfma_f32_16x16x32_bf16 v[148:151], a[44:47], a[92:95], v[148:151]
  ds_read_b64_tr_b16 a[18:19], v7 offset:3680
  v_mul_f32 v119, v119, v103
  v_add_f32 v22, 1.0, v22
  v_mfma_f32_16x16x32_bf16 v[152:155], a[44:47], a[96:99], v[152:155]
  v_add_f32 v23, 1.0, v23
  v_add_f32 v24, 1.0, v24
  v_add_f32 v25, 1.0, v25
  v_mfma_f32_16x16x32_bf16 v[156:159], a[44:47], a[100:103], v[156:159]
  v_add_f32 v26, 1.0, v26
  v_add_f32 v27, 1.0, v27
  v_add_f32 v28, 1.0, v28
  s_waitcnt lgkmcnt(10)
  v_mfma_f32_16x16x32_bf16 v[128:131], a[48:51], a[104:107], v[128:131]
  ds_read_b64_tr_b16 a[20:21], v7 offset:14560
  v_add_f32 v29, 1.0, v29
  v_rcp_f32 v22, v22
  v_mfma_f32_16x16x32_bf16 v[132:135], a[48:51], a[108:111], v[132:135]
  ds_read_b64_tr_b16 a[22:23], v7 offset:18144
  v_rcp_f32 v23, v23
  v_rcp_f32 v24, v24
  v_mfma_f32_16x16x32_bf16 v[136:139], a[48:51], a[112:115], v[136:139]
  v_rcp_f32 v25, v25
  v_mfma_f32_16x16x32_bf16 v[140:143], a[48:51], a[116:119], v[140:143]
  v_rcp_f32 v26, v26
  v_rcp_f32 v27, v27
  v_mfma_f32_16x16x32_bf16 v[144:147], a[52:55], a[104:107], v[144:147]
  ds_read_b64_tr_b16 a[24:25], v7 offset:7264
  v_rcp_f32 v28, v28
  v_mfma_f32_16x16x32_bf16 v[148:151], a[52:55], a[108:111], v[148:151]
  ds_read_b64_tr_b16 a[26:27], v7 offset:10848
  v_rcp_f32 v29, v29
  v_mul_f32 v112, v112, v22
  v_mfma_f32_16x16x32_bf16 v[152:155], a[52:55], a[112:115], v[152:155]
  v_mul_f32 v113, v113, v23
  v_mul_f32 v114, v114, v24
  v_mul_f32 v115, v115, v25
  v_mfma_f32_16x16x32_bf16 v[156:159], a[52:55], a[116:119], v[156:159]
  v_mul_f32 v116, v116, v26
  v_mul_f32 v117, v117, v27
  v_mul_f32 v118, v118, v28
  s_waitcnt lgkmcnt(10)
  v_mfma_f32_16x16x32_bf16 v[128:131], a[0:3], a[120:123], v[128:131]
  ds_read_b64_tr_b16 a[28:29], v7 offset:21728
  v_mul_f32 v119, v119, v29
  v_cvt_pk_bf16_f32 v96, v112, v113
  v_cvt_pk_bf16_f32 v98, v116, v117
  v_mfma_f32_16x16x32_bf16 v[132:135], a[0:3], a[124:127], v[132:135]
  ds_read_b64_tr_b16 a[30:31], v7 offset:25312
  v_cvt_pk_bf16_f32 v97, v114, v115
  v_cvt_pk_bf16_f32 v99, v118, v119
  v_permlane16_swap_b32 v96, v98
  v_mfma_f32_16x16x32_bf16 v[136:139], a[0:3], a[128:131], v[136:139]
  s_nop 0
  v_permlane16_swap_b32 v97, v99
  buffer_store_dwordx4 v[96:99], v15, s[40:43], s46 offen sc1
  s_add_u32 s46, s46, 16384
  v_mfma_f32_16x16x32_bf16 v[140:143], a[0:3], a[132:135], v[140:143]
  v_mul_f32 v22, v104, v104
  v_mul_f32 v23, v105, v105
  v_mul_f32 v24, v106, v106
  v_mul_f32 v25, v107, v107
  v_mfma_f32_16x16x32_bf16 v[144:147], a[4:7], a[120:123], v[144:147]
  ds_read_b64_tr_b16 a[32:33], v4 offset:128
  v_mul_f32 v26, v108, v108
  v_mul_f32 v27, v109, v109
  v_mul_f32 v28, v110, v110
  v_mfma_f32_16x16x32_bf16 v[148:151], a[4:7], a[124:127], v[148:151]
  ds_read_b64_tr_b16 a[34:35], v4 offset:3712
  v_mul_f32 v29, v111, v111
  v_fma_f32 v22, v22, s44, v30
  v_fma_f32 v23, v23, s44, v30
  v_mfma_f32_16x16x32_bf16 v[152:155], a[4:7], a[128:131], v[152:155]
  v_fma_f32 v24, v24, s44, v30
  v_fma_f32 v25, v25, s44, v30
  v_fma_f32 v26, v26, s44, v30
  v_mfma_f32_16x16x32_bf16 v[156:159], a[4:7], a[132:135], v[156:159]
  v_fma_f32 v27, v27, s44, v30
  v_fma_f32 v28, v28, s44, v30
  v_fma_f32 v29, v29, s44, v30
  s_waitcnt lgkmcnt(10)
  v_mfma_f32_16x16x32_bf16 v[128:131], a[8:11], a[136:139], v[128:131]
  ds_read_b64_tr_b16 a[36:37], v4 offset:14592
  v_mul_f32 v22, v22, v104
  v_mul_f32 v23, v23, v105
  v_mul_f32 v24, v24, v106
  v_mfma_f32_16x16x32_bf16 v[132:135], a[8:11], a[140:143], v[132:135]
  ds_read_b64_tr_b16 a[38:39], v4 offset:18176
  v_mul_f32 v25, v25, v107
  v_mul_f32 v26, v26, v108
  v_mul_f32 v27, v27, v109
  v_mfma_f32_16x16x32_bf16 v[136:139], a[8:11], a[144:147], v[136:139]
  v_mul_f32 v28, v28, v110
  v_mul_f32 v29, v29, v111
  v_exp_f32 v22, v22
  v_mfma_f32_16x16x32_bf16 v[140:143], a[8:11], a[148:151], v[140:143]
  v_mul_f32 v120, v120, v104
  v_exp_f32 v23, v23
  v_mfma_f32_16x16x32_bf16 v[144:147], a[12:15], a[136:139], v[144:147]
  ds_read_b64_tr_b16 a[40:41], v4 offset:7296
  v_mul_f32 v121, v121, v105
  v_exp_f32 v24, v24
  v_mfma_f32_16x16x32_bf16 v[148:151], a[12:15], a[140:143], v[148:151]
  ds_read_b64_tr_b16 a[42:43], v4 offset:10880
  v_mul_f32 v122, v122, v106
  v_exp_f32 v25, v25
  v_mfma_f32_16x16x32_bf16 v[152:155], a[12:15], a[144:147], v[152:155]
  v_mul_f32 v123, v123, v107
  v_exp_f32 v26, v26
  v_mfma_f32_16x16x32_bf16 v[156:159], a[12:15], a[148:151], v[156:159]
  v_mul_f32 v124, v124, v108
  v_exp_f32 v27, v27
  s_waitcnt lgkmcnt(10)
  v_mfma_f32_16x16x32_bf16 v[128:131], a[16:19], a[152:155], v[128:131]
  ds_read_b64_tr_b16 a[44:45], v4 offset:21760
  v_mul_f32 v125, v125, v109
  v_exp_f32 v28, v28
  v_mfma_f32_16x16x32_bf16 v[132:135], a[16:19], a[156:159], v[132:135]
  ds_read_b64_tr_b16 a[46:47], v4 offset:25344
  v_mul_f32 v126, v126, v110
  v_exp_f32 v29, v29
  v_mfma_f32_16x16x32_bf16 v[136:139], a[16:19], a[160:163], v[136:139]
  v_mul_f32 v127, v127, v111
  v_add_f32 v22, 1.0, v22
  v_mfma_f32_16x16x32_bf16 v[140:143], a[16:19], a[164:167], v[140:143]
  v_add_f32 v23, 1.0, v23
  v_add_f32 v24, 1.0, v24
  v_add_f32 v25, 1.0, v25
  v_mfma_f32_16x16x32_bf16 v[144:147], a[20:23], a[152:155], v[144:147]
  ds_read_b64_tr_b16 a[48:49], v5 offset:128
  v_add_f32 v26, 1.0, v26
  v_add_f32 v27, 1.0, v27
  v_add_f32 v28, 1.0, v28
  v_mfma_f32_16x16x32_bf16 v[148:151], a[20:23], a[156:159], v[148:151]
  ds_read_b64_tr_b16 a[50:51], v5 offset:3712
  v_add_f32 v29, 1.0, v29
  v_rcp_f32 v22, v22
  v_mfma_f32_16x16x32_bf16 v[152:155], a[20:23], a[160:163], v[152:155]
  v_rcp_f32 v23, v23
  v_rcp_f32 v24, v24
  v_mfma_f32_16x16x32_bf16 v[156:159], a[20:23], a[164:167], v[156:159]
  v_rcp_f32 v25, v25
  s_waitcnt lgkmcnt(10)
  v_mfma_f32_16x16x32_bf16 v[128:131], a[24:27], a[168:171], v[128:131]
  ds_read_b64_tr_b16 a[52:53], v5 offset:14592
  v_rcp_f32 v26, v26
  v_rcp_f32 v27, v27
  v_mfma_f32_16x16x32_bf16 v[132:135], a[24:27], a[172:175], v[132:135]
  ds_read_b64_tr_b16 a[54:55], v5 offset:18176
  v_rcp_f32 v28, v28
  v_mfma_f32_16x16x32_bf16 v[136:139], a[24:27], a[176:179], v[136:139]
  v_rcp_f32 v29, v29
  v_mul_f32 v120, v120, v22
  v_mfma_f32_16x16x32_bf16 v[140:143], a[24:27], a[180:183], v[140:143]
  v_mul_f32 v121, v121, v23
  v_mul_f32 v122, v122, v24
  v_mul_f32 v123, v123, v25
  v_mfma_f32_16x16x32_bf16 v[144:147], a[28:31], a[168:171], v[144:147]
  ds_read_b64_tr_b16 a[0:1], v5 offset:7296
  v_mul_f32 v124, v124, v26
  v_mul_f32 v125, v125, v27
  v_mul_f32 v126, v126, v28
  v_mfma_f32_16x16x32_bf16 v[148:151], a[28:31], a[172:175], v[148:151]
  ds_read_b64_tr_b16 a[2:3], v5 offset:10880
  v_mul_f32 v127, v127, v29
  v_cvt_pk_bf16_f32 v104, v120, v121
  v_cvt_pk_bf16_f32 v106, v124, v125
  v_mfma_f32_16x16x32_bf16 v[152:155], a[28:31], a[176:179], v[152:155]
  v_cvt_pk_bf16_f32 v105, v122, v123
  v_cvt_pk_bf16_f32 v107, v126, v127
  v_permlane16_swap_b32 v104, v106
  v_mfma_f32_16x16x32_bf16 v[156:159], a[28:31], a[180:183], v[156:159]
  s_nop 0
  v_permlane16_swap_b32 v105, v107
  buffer_store_dwordx4 v[104:107], v15, s[40:43], s47 offen sc1
  s_add_u32 s47, s47, 16384
  s_waitcnt lgkmcnt(10)
  v_mfma_f32_16x16x32_bf16 v[160:163], a[32:35], a[56:59], v[160:163]
  ds_read_b64_tr_b16 a[4:5], v5 offset:21760
  v_mfma_f32_16x16x32_bf16 v[164:167], a[32:35], a[60:63], v[164:167]
  ds_read_b64_tr_b16 a[6:7], v5 offset:25344
  v_mfma_f32_16x16x32_bf16 v[168:171], a[32:35], a[64:67], v[168:171]
  v_mfma_f32_16x16x32_bf16 v[172:175], a[32:35], a[68:71], v[172:175]
  v_mfma_f32_16x16x32_bf16 v[176:179], a[36:39], a[56:59], v[176:179]
  ds_read_b64_tr_b16 a[8:9], v6 offset:128
  v_mfma_f32_16x16x32_bf16 v[180:183], a[36:39], a[60:63], v[180:183]
  ds_read_b64_tr_b16 a[10:11], v6 offset:3712
  v_mfma_f32_16x16x32_bf16 v[184:187], a[36:39], a[64:67], v[184:187]
  s_waitcnt vmcnt(2)
  v_mov_b32 v0, 0
  v_mov_b32 v1, 1
  s_mov_b64 exec, 1
  buffer_store_dword v1, v0, s[48:51], s77 offen sc1
  s_mov_b64 exec, -1
  v_mul_f32 v22, v128, v128
  v_mul_f32 v23, v129, v129
  v_mfma_f32_16x16x32_bf16 v[188:191], a[36:39], a[68:71], v[188:191]
  v_mul_f32 v24, v130, v130
  v_mul_f32 v25, v131, v131
  v_mul_f32 v26, v132, v132
  s_waitcnt lgkmcnt(10)
  v_mfma_f32_16x16x32_bf16 v[160:163], a[40:43], a[72:75], v[160:163]
  ds_read_b64_tr_b16 a[12:13], v6 offset:14592
  v_mul_f32 v27, v133, v133
  v_mul_f32 v28, v134, v134
  v_mul_f32 v29, v135, v135
  v_mfma_f32_16x16x32_bf16 v[164:167], a[40:43], a[76:79], v[164:167]
  ds_read_b64_tr_b16 a[14:15], v6 offset:18176
  v_fma_f32 v22, v22, s44, v30
  s_add_u32 s34, s32, 0
  s_add_u32 m0, s33, 131072
  v_mfma_f32_16x16x32_bf16 v[168:171], a[40:43], a[80:83], v[168:171]
  buffer_load_dwordx4 v8, s[52:55], s34 offen offset:0 lds
  v_fma_f32 v23, v23, s44, v30
  v_fma_f32 v24, v24, s44, v30
  v_fma_f32 v25, v25, s44, v30
  v_fma_f32 v26, v26, s44, v30
  v_fma_f32 v27, v27, s44, v30
  v_mfma_f32_16x16x32_bf16 v[172:175], a[40:43], a[84:87], v[172:175]
  v_fma_f32 v28, v28, s44, v30
  v_fma_f32 v29, v29, s44, v30
  v_mul_f32 v22, v22, v128
  v_mfma_f32_16x16x32_bf16 v[176:179], a[44:47], a[72:75], v[176:179]
  ds_read_b64_tr_b16 a[16:17], v6 offset:7296
  v_mul_f32 v23, v23, v129
  v_mul_f32 v24, v24, v130
  v_mul_f32 v25, v25, v131
  v_mfma_f32_16x16x32_bf16 v[180:183], a[44:47], a[76:79], v[180:183]
  ds_read_b64_tr_b16 a[18:19], v6 offset:10880
  v_mul_f32 v26, v26, v132
  v_mul_f32 v27, v27, v133
  v_mul_f32 v28, v28, v134
  v_mfma_f32_16x16x32_bf16 v[184:187], a[44:47], a[80:83], v[184:187]
  v_mul_f32 v29, v29, v135
  v_exp_f32 v22, v22
  v_mfma_f32_16x16x32_bf16 v[188:191], a[44:47], a[84:87], v[188:191]
  v_mul_f32 v144, v144, v128
  v_exp_f32 v23, v23
  s_waitcnt lgkmcnt(10)
  v_mfma_f32_16x16x32_bf16 v[160:163], a[48:51], a[88:91], v[160:163]
  ds_read_b64_tr_b16 a[20:21], v6 offset:21760
  v_mfma_f32_16x16x32_bf16 v[164:167], a[48:51], a[92:95], v[164:167]
  ds_read_b64_tr_b16 a[22:23], v6 offset:25344
  v_mfma_f32_16x16x32_bf16 v[168:171], a[48:51], a[96:99], v[168:171]
  buffer_load_dwordx4 v9, s[52:55], s34 offen offset:1024 lds
  v_mul_f32 v145, v145, v129
  v_exp_f32 v24, v24
  v_mul_f32 v146, v146, v130
  v_exp_f32 v25, v25
  v_mul_f32 v147, v147, v131
  v_exp_f32 v26, v26
  v_mfma_f32_16x16x32_bf16 v[172:175], a[48:51], a[100:103], v[172:175]
  v_mul_f32 v148, v148, v132
  v_exp_f32 v27, v27
  v_mfma_f32_16x16x32_bf16 v[176:179], a[52:55], a[88:91], v[176:179]
  ds_read_b64_tr_b16 a[24:25], v7 offset:128
  v_mul_f32 v149, v149, v133
  v_exp_f32 v28, v28
  v_mul_f32 v150, v150, v134
  v_mfma_f32_16x16x32_bf16 v[180:183], a[52:55], a[92:95], v[180:183]
  ds_read_b64_tr_b16 a[26:27], v7 offset:3712
  v_exp_f32 v29, v29
  v_mul_f32 v151, v151, v135
  v_mfma_f32_16x16x32_bf16 v[184:187], a[52:55], a[96:99], v[184:187]
  v_add_f32 v22, 1.0, v22
  v_add_f32 v23, 1.0, v23
  v_add_f32 v24, 1.0, v24
  v_mfma_f32_16x16x32_bf16 v[188:191], a[52:55], a[100:103], v[188:191]
  v_add_f32 v25, 1.0, v25
  v_add_f32 v26, 1.0, v26
  s_waitcnt lgkmcnt(10)
  v_mfma_f32_16x16x32_bf16 v[160:163], a[0:3], a[104:107], v[160:163]
  ds_read_b64_tr_b16 a[28:29], v7 offset:14592
  v_mfma_f32_16x16x32_bf16 v[164:167], a[0:3], a[108:111], v[164:167]
  ds_read_b64_tr_b16 a[30:31], v7 offset:18176
  v_mfma_f32_16x16x32_bf16 v[168:171], a[0:3], a[112:115], v[168:171]
  buffer_load_dwordx4 v10, s[52:55], s34 offen offset:2048 lds
  v_add_f32 v27, 1.0, v27
  v_add_f32 v28, 1.0, v28
  v_add_f32 v29, 1.0, v29
  v_rcp_f32 v22, v22
  v_rcp_f32 v23, v23
  v_rcp_f32 v24, v24
  v_rcp_f32 v25, v25
  v_mfma_f32_16x16x32_bf16 v[172:175], a[0:3], a[116:119], v[172:175]
  v_rcp_f32 v26, v26
  v_mfma_f32_16x16x32_bf16 v[176:179], a[4:7], a[104:107], v[176:179]
  ds_read_b64_tr_b16 a[32:33], v7 offset:7296
  v_rcp_f32 v27, v27
  v_rcp_f32 v28, v28
  v_mfma_f32_16x16x32_bf16 v[180:183], a[4:7], a[108:111], v[180:183]
  ds_read_b64_tr_b16 a[34:35], v7 offset:10880
  v_rcp_f32 v29, v29
  v_mfma_f32_16x16x32_bf16 v[184:187], a[4:7], a[112:115], v[184:187]
  v_mul_f32 v144, v144, v22
  v_mul_f32 v145, v145, v23
  v_mul_f32 v146, v146, v24
  v_mul_f32 v147, v147, v25
  v_mfma_f32_16x16x32_bf16 v[188:191], a[4:7], a[116:119], v[188:191]
  v_mul_f32 v148, v148, v26
  v_mul_f32 v149, v149, v27
  v_mul_f32 v150, v150, v28
  s_waitcnt lgkmcnt(10)
  v_mfma_f32_16x16x32_bf16 v[160:163], a[8:11], a[120:123], v[160:163]
  ds_read_b64_tr_b16 a[36:37], v7 offset:21760
  v_mfma_f32_16x16x32_bf16 v[164:167], a[8:11], a[124:127], v[164:167]
  ds_read_b64_tr_b16 a[38:39], v7 offset:25344
  v_mfma_f32_16x16x32_bf16 v[168:171], a[8:11], a[128:131], v[168:171]
  buffer_load_dwordx4 v11, s[52:55], s34 offen offset:3072 lds
  v_mul_f32 v151, v151, v29
  v_cvt_pk_bf16_f32 v128, v144, v145
  v_cvt_pk_bf16_f32 v130, v148, v149
  v_cvt_pk_bf16_f32 v129, v146, v147
  v_cvt_pk_bf16_f32 v131, v150, v151
  v_permlane16_swap_b32 v128, v130
  s_nop 0
  v_permlane16_swap_b32 v129, v131
  v_mfma_f32_16x16x32_bf16 v[172:175], a[8:11], a[132:135], v[172:175]
  v_mfma_f32_16x16x32_bf16 v[176:179], a[12:15], a[120:123], v[176:179]
  ds_read_b64_tr_b16 a[40:41], v4 offset:160
  v_mfma_f32_16x16x32_bf16 v[180:183], a[12:15], a[124:127], v[180:183]
  ds_read_b64_tr_b16 a[42:43], v4 offset:3744
  v_mfma_f32_16x16x32_bf16 v[184:187], a[12:15], a[128:131], v[184:187]
  buffer_store_dwordx4 v[128:131], v15, s[40:43], s46 offen sc1
  s_add_u32 s46, s46, 16384
  v_mul_f32 v22, v136, v136
  v_mul_f32 v23, v137, v137
  v_mul_f32 v24, v138, v138
  v_mul_f32 v25, v139, v139
  v_mul_f32 v26, v140, v140
  v_mul_f32 v27, v141, v141
  v_mul_f32 v28, v142, v142
  v_mul_f32 v29, v143, v143
  v_fma_f32 v22, v22, s44, v30
  v_mfma_f32_16x16x32_bf16 v[188:191], a[12:15], a[132:135], v[188:191]
  s_add_u32 s34, s32, 917504
  s_add_u32 m0, s33, 147456
  s_waitcnt lgkmcnt(10)
  v_mfma_f32_16x16x32_bf16 v[160:163], a[16:19], a[136:139], v[160:163]
  ds_read_b64_tr_b16 a[44:45], v4 offset:14624
  v_mfma_f32_16x16x32_bf16 v[164:167], a[16:19], a[140:143], v[164:167]
  ds_read_b64_tr_b16 a[46:47], v4 offset:18208
  v_mfma_f32_16x16x32_bf16 v[168:171], a[16:19], a[144:147], v[168:171]
  buffer_load_dwordx4 v8, s[52:55], s34 offen offset:0 lds
  v_fma_f32 v23, v23, s44, v30
  v_fma_f32 v24, v24, s44, v30
  v_fma_f32 v25, v25, s44, v30
  v_fma_f32 v26, v26, s44, v30
  v_fma_f32 v27, v27, s44, v30
  v_fma_f32 v28, v28, s44, v30
  v_fma_f32 v29, v29, s44, v30
  v_mul_f32 v22, v22, v136
  v_mul_f32 v23, v23, v137
  v_mul_f32 v24, v24, v138
  v_mul_f32 v25, v25, v139
  v_mul_f32 v26, v26, v140
  v_mul_f32 v27, v27, v141
  v_mul_f32 v28, v28, v142
  v_mul_f32 v29, v29, v143
  v_mfma_f32_16x16x32_bf16 v[172:175], a[16:19], a[148:151], v[172:175]
  v_exp_f32 v22, v22
  v_mul_f32 v152, v152, v136
  v_mfma_f32_16x16x32_bf16 v[176:179], a[20:23], a[136:139], v[176:179]
  ds_read_b64_tr_b16 a[48:49], v4 offset:7328
  v_exp_f32 v23, v23
  v_mfma_f32_16x16x32_bf16 v[180:183], a[20:23], a[140:143], v[180:183]
  ds_read_b64_tr_b16 a[50:51], v4 offset:10912
  v_mfma_f32_16x16x32_bf16 v[184:187], a[20:23], a[144:147], v[184:187]
  buffer_load_dwordx4 v9, s[52:55], s34 offen offset:1024 lds
  v_mul_f32 v153, v153, v137
  v_exp_f32 v24, v24
  v_mul_f32 v154, v154, v138
  v_exp_f32 v25, v25
  v_mul_f32 v155, v155, v139
  v_mfma_f32_16x16x32_bf16 v[188:191], a[20:23], a[148:151], v[188:191]
  v_exp_f32 v26, v26
  v_mul_f32 v156, v156, v140
  s_waitcnt lgkmcnt(10)
  v_mfma_f32_16x16x32_bf16 v[160:163], a[24:27], a[152:155], v[160:163]
  ds_read_b64_tr_b16 a[52:53], v4 offset:21792
  v_exp_f32 v27, v27
  v_mul_f32 v157, v157, v141
  v_mfma_f32_16x16x32_bf16 v[164:167], a[24:27], a[156:159], v[164:167]
  ds_read_b64_tr_b16 a[54:55], v4 offset:25376
  v_exp_f32 v28, v28
  v_mul_f32 v158, v158, v142
  v_exp_f32 v29, v29
  v_mfma_f32_16x16x32_bf16 v[168:171], a[24:27], a[160:163], v[168:171]
  v_mul_f32 v159, v159, v143
  v_add_f32 v22, 1.0, v22
  v_mfma_f32_16x16x32_bf16 v[172:175], a[24:27], a[164:167], v[172:175]
  v_add_f32 v23, 1.0, v23
  v_add_f32 v24, 1.0, v24
  v_add_f32 v25, 1.0, v25
  v_mfma_f32_16x16x32_bf16 v[176:179], a[28:31], a[152:155], v[176:179]
  ds_read_b64_tr_b16 a[0:1], v5 offset:160
  v_add_f32 v26, 1.0, v26
  v_mfma_f32_16x16x32_bf16 v[180:183], a[28:31], a[156:159], v[180:183]
  ds_read_b64_tr_b16 a[2:3], v5 offset:3744
  v_mfma_f32_16x16x32_bf16 v[184:187], a[28:31], a[160:163], v[184:187]
  buffer_load_dwordx4 v10, s[52:55], s34 offen offset:2048 lds
  v_add_f32 v27, 1.0, v27
  v_add_f32 v28, 1.0, v28
  v_add_f32 v29, 1.0, v29
  v_rcp_f32 v22, v22
  v_rcp_f32 v23, v23
  v_rcp_f32 v24, v24
  v_mfma_f32_16x16x32_bf16 v[188:191], a[28:31], a[164:167], v[188:191]
  v_rcp_f32 v25, v25
  s_waitcnt lgkmcnt(10)
  v_mfma_f32_16x16x32_bf16 v[160:163], a[32:35], a[168:171], v[160:163]
  ds_read_b64_tr_b16 a[4:5], v5 offset:14624
  v_rcp_f32 v26, v26
  v_rcp_f32 v27, v27
  v_mfma_f32_16x16x32_bf16 v[164:167], a[32:35], a[172:175], v[164:167]
  ds_read_b64_tr_b16 a[6:7], v5 offset:18208
  v_rcp_f32 v28, v28
  v_mfma_f32_16x16x32_bf16 v[168:171], a[32:35], a[176:179], v[168:171]
  v_rcp_f32 v29, v29
  v_mul_f32 v152, v152, v22
  v_mfma_f32_16x16x32_bf16 v[172:175], a[32:35], a[180:183], v[172:175]
  v_mul_f32 v153, v153, v23
  v_mul_f32 v154, v154, v24
  v_mul_f32 v155, v155, v25
  v_mul_f32 v156, v156, v26
  v_mfma_f32_16x16x32_bf16 v[176:179], a[36:39], a[168:171], v[176:179]
  ds_read_b64_tr_b16 a[8:9], v5 offset:7328
  v_mul_f32 v157, v157, v27
  v_mul_f32 v158, v158, v28
  v_mfma_f32_16x16x32_bf16 v[180:183], a[36:39], a[172:175], v[180:183]
  ds_read_b64_tr_b16 a[10:11], v5 offset:10912
  v_mfma_f32_16x16x32_bf16 v[184:187], a[36:39], a[176:179], v[184:187]
  buffer_load_dwordx4 v11, s[52:55], s34 offen offset:3072 lds
  v_mul_f32 v159, v159, v29
  v_cvt_pk_bf16_f32 v136, v152, v153
  v_cvt_pk_bf16_f32 v138, v156, v157
  v_cvt_pk_bf16_f32 v137, v154, v155
  v_cvt_pk_bf16_f32 v139, v158, v159
  v_permlane16_swap_b32 v136, v138
  v_mfma_f32_16x16x32_bf16 v[188:191], a[36:39], a[180:183], v[188:191]
  s_nop 0
  v_permlane16_swap_b32 v137, v139
  buffer_store_dwordx4 v[136:139], v15, s[40:43], s47 offen sc1
  s_add_u32 s47, s47, 16384
  s_waitcnt lgkmcnt(10)
  v_mfma_f32_16x16x32_bf16 v[192:195], a[40:43], a[56:59], v[192:195]
  ds_read_b64_tr_b16 a[12:13], v5 offset:21792
  v_mfma_f32_16x16x32_bf16 v[196:199], a[40:43], a[60:63], v[196:199]
  ds_read_b64_tr_b16 a[14:15], v5 offset:25376
  v_mfma_f32_16x16x32_bf16 v[200:203], a[40:43], a[64:67], v[200:203]
  v_mfma_f32_16x16x32_bf16 v[204:207], a[40:43], a[68:71], v[204:207]
  v_mfma_f32_16x16x32_bf16 v[208:211], a[44:47], a[56:59], v[208:211]
  ds_read_b64_tr_b16 a[16:17], v6 offset:160
  v_mfma_f32_16x16x32_bf16 v[212:215], a[44:47], a[60:63], v[212:215]
  ds_read_b64_tr_b16 a[18:19], v6 offset:3744
  v_mfma_f32_16x16x32_bf16 v[216:219], a[44:47], a[64:67], v[216:219]
  v_mul_f32 v22, v160, v160
  v_mul_f32 v23, v161, v161
  v_mul_f32 v24, v162, v162
  v_mul_f32 v25, v163, v163
  v_mfma_f32_16x16x32_bf16 v[220:223], a[44:47], a[68:71], v[220:223]
  v_mul_f32 v26, v164, v164
  v_mul_f32 v27, v165, v165
  v_mul_f32 v28, v166, v166
  s_waitcnt lgkmcnt(10)
  v_mfma_f32_16x16x32_bf16 v[192:195], a[48:51], a[72:75], v[192:195]
  ds_read_b64_tr_b16 a[20:21], v6 offset:14624
  v_mul_f32 v29, v167, v167
  v_fma_f32 v22, v22, s44, v30
  v_fma_f32 v23, v23, s44, v30
  v_mfma_f32_16x16x32_bf16 v[196:199], a[48:51], a[76:79], v[196:199]
  ds_read_b64_tr_b16 a[22:23], v6 offset:18208
  v_fma_f32 v24, v24, s44, v30
  v_fma_f32 v25, v25, s44, v30
  v_fma_f32 v26, v26, s44, v30
  v_mfma_f32_16x16x32_bf16 v[200:203], a[48:51], a[80:83], v[200:203]
  v_fma_f32 v27, v27, s44, v30
  v_fma_f32 v28, v28, s44, v30
  v_fma_f32 v29, v29, s44, v30
  v_mfma_f32_16x16x32_bf16 v[204:207], a[48:51], a[84:87], v[204:207]
  v_mul_f32 v22, v22, v160
  v_mul_f32 v23, v23, v161
  v_mul_f32 v24, v24, v162
  v_mfma_f32_16x16x32_bf16 v[208:211], a[52:55], a[72:75], v[208:211]
  ds_read_b64_tr_b16 a[24:25], v6 offset:7328
  v_mul_f32 v25, v25, v163
  v_mul_f32 v26, v26, v164
  v_mul_f32 v27, v27, v165
  v_mfma_f32_16x16x32_bf16 v[212:215], a[52:55], a[76:79], v[212:215]
  ds_read_b64_tr_b16 a[26:27], v6 offset:10912
  v_mul_f32 v28, v28, v166
  v_mul_f32 v29, v29, v167
  v_exp_f32 v22, v22
  v_mfma_f32_16x16x32_bf16 v[216:219], a[52:55], a[80:83], v[216:219]
  v_mul_f32 v176, v176, v160
  v_exp_f32 v23, v23
  v_mfma_f32_16x16x32_bf16 v[220:223], a[52:55], a[84:87], v[220:223]
  v_mul_f32 v177, v177, v161
  v_exp_f32 v24, v24
  s_waitcnt lgkmcnt(10)
  v_mfma_f32_16x16x32_bf16 v[192:195], a[0:3], a[88:91], v[192:195]
  ds_read_b64_tr_b16 a[28:29], v6 offset:21792
  v_mul_f32 v178, v178, v162
  v_exp_f32 v25, v25
  v_mfma_f32_16x16x32_bf16 v[196:199], a[0:3], a[92:95], v[196:199]
  ds_read_b64_tr_b16 a[30:31], v6 offset:25376
  v_mul_f32 v179, v179, v163
  v_exp_f32 v26, v26
  v_mfma_f32_16x16x32_bf16 v[200:203], a[0:3], a[96:99], v[200:203]
  v_mul_f32 v180, v180, v164
  v_exp_f32 v27, v27
  v_mfma_f32_16x16x32_bf16 v[204:207], a[0:3], a[100:103], v[204:207]
  v_mul_f32 v181, v181, v165
  v_exp_f32 v28, v28
  v_mfma_f32_16x16x32_bf16 v[208:211], a[4:7], a[88:91], v[208:211]
  ds_read_b64_tr_b16 a[32:33], v7 offset:160
  v_mul_f32 v182, v182, v166
  v_exp_f32 v29, v29
  v_mfma_f32_16x16x32_bf16 v[212:215], a[4:7], a[92:95], v[212:215]
  ds_read_b64_tr_b16 a[34:35], v7 offset:3744
  v_mul_f32 v183, v183, v167
  v_add_f32 v22, 1.0, v22
  v_mfma_f32_16x16x32_bf16 v[216:219], a[4:7], a[96:99], v[216:219]
  v_add_f32 v23, 1.0, v23
  v_add_f32 v24, 1.0, v24
  v_add_f32 v25, 1.0, v25
  v_mfma_f32_16x16x32_bf16 v[220:223], a[4:7], a[100:103], v[220:223]
  v_add_f32 v26, 1.0, v26
  v_add_f32 v27, 1.0, v27
  v_add_f32 v28, 1.0, v28
  s_waitcnt lgkmcnt(10)
  v_mfma_f32_16x16x32_bf16 v[192:195], a[8:11], a[104:107], v[192:195]
  ds_read_b64_tr_b16 a[36:37], v7 offset:14624
  v_add_f32 v29, 1.0, v29
  v_rcp_f32 v22, v22
  v_mfma_f32_16x16x32_bf16 v[196:199], a[8:11], a[108:111], v[196:199]
  ds_read_b64_tr_b16 a[38:39], v7 offset:18208
  v_rcp_f32 v23, v23
  v_rcp_f32 v24, v24
  v_mfma_f32_16x16x32_bf16 v[200:203], a[8:11], a[112:115], v[200:203]
  v_rcp_f32 v25, v25
  v_rcp_f32 v26, v26
  v_mfma_f32_16x16x32_bf16 v[204:207], a[8:11], a[116:119], v[204:207]
  v_rcp_f32 v27, v27
  v_mfma_f32_16x16x32_bf16 v[208:211], a[12:15], a[104:107], v[208:211]
  ds_read_b64_tr_b16 a[40:41], v7 offset:7328
  v_rcp_f32 v28, v28
  v_rcp_f32 v29, v29
  v_mfma_f32_16x16x32_bf16 v[212:215], a[12:15], a[108:111], v[212:215]
  ds_read_b64_tr_b16 a[42:43], v7 offset:10912
  v_mul_f32 v176, v176, v22
  s_mov_b32 s98, 0
  v_mfma_f32_16x16x32_bf16 v[216:219], a[12:15], a[112:115], v[216:219]
  buffer_load_dword v20, v21, s[48:51], s98 offen sc1
  v_mul_f32 v177, v177, v23
  v_mul_f32 v178, v178, v24
  v_mul_f32 v179, v179, v25
  v_mfma_f32_16x16x32_bf16 v[220:223], a[12:15], a[116:119], v[220:223]
  v_mul_f32 v180, v180, v26
  v_mul_f32 v181, v181, v27
  v_mul_f32 v182, v182, v28
  s_waitcnt lgkmcnt(10)
  v_mfma_f32_16x16x32_bf16 v[192:195], a[16:19], a[120:123], v[192:195]
  ds_read_b64_tr_b16 a[44:45], v7 offset:21792
  v_mul_f32 v183, v183, v29
  v_cvt_pk_bf16_f32 v160, v176, v177
  v_cvt_pk_bf16_f32 v162, v180, v181
  v_mfma_f32_16x16x32_bf16 v[196:199], a[16:19], a[124:127], v[196:199]
  ds_read_b64_tr_b16 a[46:47], v7 offset:25376
  v_cvt_pk_bf16_f32 v161, v178, v179
  v_cvt_pk_bf16_f32 v163, v182, v183
  v_permlane16_swap_b32 v160, v162
  v_mfma_f32_16x16x32_bf16 v[200:203], a[16:19], a[128:131], v[200:203]
  s_nop 0
  v_permlane16_swap_b32 v161, v163
  buffer_store_dwordx4 v[160:163], v15, s[40:43], s46 offen sc1
  s_add_u32 s46, s46, 16384
  v_mfma_f32_16x16x32_bf16 v[204:207], a[16:19], a[132:135], v[204:207]
  v_mul_f32 v22, v168, v168
  v_mul_f32 v23, v169, v169
  v_mul_f32 v24, v170, v170
  v_mfma_f32_16x16x32_bf16 v[208:211], a[20:23], a[120:123], v[208:211]
  ds_read_b64_tr_b16 a[48:49], v4 offset:192
  v_mul_f32 v25, v171, v171
  v_mul_f32 v26, v172, v172
  v_mul_f32 v27, v173, v173
  v_mfma_f32_16x16x32_bf16 v[212:215], a[20:23], a[124:127], v[212:215]
  ds_read_b64_tr_b16 a[50:51], v4 offset:3776
  v_mul_f32 v28, v174, v174
  v_mul_f32 v29, v175, v175
  v_fma_f32 v22, v22, s44, v30
  v_mfma_f32_16x16x32_bf16 v[216:219], a[20:23], a[128:131], v[216:219]
  v_fma_f32 v23, v23, s44, v30
  v_fma_f32 v24, v24, s44, v30
  v_fma_f32 v25, v25, s44, v30
  v_mfma_f32_16x16x32_bf16 v[220:223], a[20:23], a[132:135], v[220:223]
  v_fma_f32 v26, v26, s44, v30
  v_fma_f32 v27, v27, s44, v30
  v_fma_f32 v28, v28, s44, v30
  s_waitcnt lgkmcnt(10)
  v_mfma_f32_16x16x32_bf16 v[192:195], a[24:27], a[136:139], v[192:195]
  ds_read_b64_tr_b16 a[52:53], v4 offset:14656
  v_fma_f32 v29, v29, s44, v30
  v_mul_f32 v22, v22, v168
  v_mul_f32 v23, v23, v169
  v_mfma_f32_16x16x32_bf16 v[196:199], a[24:27], a[140:143], v[196:199]
  ds_read_b64_tr_b16 a[54:55], v4 offset:18240
  v_mul_f32 v24, v24, v170
  v_mul_f32 v25, v25, v171
  v_mul_f32 v26, v26, v172
  v_mfma_f32_16x16x32_bf16 v[200:203], a[24:27], a[144:147], v[200:203]
  v_mul_f32 v27, v27, v173
  v_mul_f32 v28, v28, v174
  v_mul_f32 v29, v29, v175
  v_mfma_f32_16x16x32_bf16 v[204:207], a[24:27], a[148:151], v[204:207]
  v_exp_f32 v22, v22
  v_mul_f32 v184, v184, v168
  v_mfma_f32_16x16x32_bf16 v[208:211], a[28:31], a[136:139], v[208:211]
  ds_read_b64_tr_b16 a[0:1], v4 offset:7360
  v_exp_f32 v23, v23
  v_mul_f32 v185, v185, v169
  v_exp_f32 v24, v24
  v_mfma_f32_16x16x32_bf16 v[212:215], a[28:31], a[140:143], v[212:215]
  ds_read_b64_tr_b16 a[2:3], v4 offset:10944
  v_mul_f32 v186, v186, v170
  v_exp_f32 v25, v25
  v_mfma_f32_16x16x32_bf16 v[216:219], a[28:31], a[144:147], v[216:219]
  v_mul_f32 v187, v187, v171
  v_exp_f32 v26, v26
  v_mfma_f32_16x16x32_bf16 v[220:223], a[28:31], a[148:151], v[220:223]
  v_mul_f32 v188, v188, v172
  v_exp_f32 v27, v27
  s_waitcnt lgkmcnt(10)
  v_mfma_f32_16x16x32_bf16 v[192:195], a[32:35], a[152:155], v[192:195]
  ds_read_b64_tr_b16 a[4:5], v4 offset:21824
  v_mul_f32 v189, v189, v173
  v_exp_f32 v28, v28
  v_mfma_f32_16x16x32_bf16 v[196:199], a[32:35], a[156:159], v[196:199]
  ds_read_b64_tr_b16 a[6:7], v4 offset:25408
  v_mul_f32 v190, v190, v174
  v_exp_f32 v29, v29
  v_mfma_f32_16x16x32_bf16 v[200:203], a[32:35], a[160:163], v[200:203]
  v_mul_f32 v191, v191, v175
  v_add_f32 v22, 1.0, v22
  v_mfma_f32_16x16x32_bf16 v[204:207], a[32:35], a[164:167], v[204:207]
  v_add_f32 v23, 1.0, v23
  v_add_f32 v24, 1.0, v24
  v_add_f32 v25, 1.0, v25
  v_mfma_f32_16x16x32_bf16 v[208:211], a[36:39], a[152:155], v[208:211]
  ds_read_b64_tr_b16 a[8:9], v5 offset:192
  v_add_f32 v26, 1.0, v26
  v_add_f32 v27, 1.0, v27
  v_add_f32 v28, 1.0, v28
  v_mfma_f32_16x16x32_bf16 v[212:215], a[36:39], a[156:159], v[212:215]
  ds_read_b64_tr_b16 a[10:11], v5 offset:3776
  v_add_f32 v29, 1.0, v29
  v_rcp_f32 v22, v22
  v_mfma_f32_16x16x32_bf16 v[216:219], a[36:39], a[160:163], v[216:219]
  v_rcp_f32 v23, v23
  v_rcp_f32 v24, v24
  v_mfma_f32_16x16x32_bf16 v[220:223], a[36:39], a[164:167], v[220:223]
  v_rcp_f32 v25, v25
  s_waitcnt lgkmcnt(10)
  v_mfma_f32_16x16x32_bf16 v[192:195], a[40:43], a[168:171], v[192:195]
  ds_read_b64_tr_b16 a[12:13], v5 offset:14656
  v_rcp_f32 v26, v26
  v_rcp_f32 v27, v27
  v_mfma_f32_16x16x32_bf16 v[196:199], a[40:43], a[172:175], v[196:199]
  ds_read_b64_tr_b16 a[14:15], v5 offset:18240
  v_rcp_f32 v28, v28
  v_mfma_f32_16x16x32_bf16 v[200:203], a[40:43], a[176:179], v[200:203]
  v_rcp_f32 v29, v29
  v_mul_f32 v184, v184, v22
  v_mfma_f32_16x16x32_bf16 v[204:207], a[40:43], a[180:183], v[204:207]
  v_mul_f32 v185, v185, v23
  v_mul_f32 v186, v186, v24
  v_mul_f32 v187, v187, v25
  v_mfma_f32_16x16x32_bf16 v[208:211], a[44:47], a[168:171], v[208:211]
  ds_read_b64_tr_b16 a[16:17], v5 offset:7360
  v_mul_f32 v188, v188, v26
  v_mul_f32 v189, v189, v27
  v_mul_f32 v190, v190, v28
  v_mfma_f32_16x16x32_bf16 v[212:215], a[44:47], a[172:175], v[212:215]
  ds_read_b64_tr_b16 a[18:19], v5 offset:10944
  v_mul_f32 v191, v191, v29
  v_cvt_pk_bf16_f32 v168, v184, v185
  v_cvt_pk_bf16_f32 v170, v188, v189
  v_mfma_f32_16x16x32_bf16 v[216:219], a[44:47], a[176:179], v[216:219]
  v_cvt_pk_bf16_f32 v169, v186, v187
  v_cvt_pk_bf16_f32 v171, v190, v191
  v_permlane16_swap_b32 v168, v170
  v_mfma_f32_16x16x32_bf16 v[220:223], a[44:47], a[180:183], v[220:223]
  s_nop 0
  v_permlane16_swap_b32 v169, v171
  buffer_store_dwordx4 v[168:171], v15, s[40:43], s47 offen sc1
  s_add_u32 s47, s47, 16384
  s_waitcnt lgkmcnt(10)
  v_mfma_f32_16x16x32_bf16 v[224:227], a[48:51], a[56:59], v[224:227]
  ds_read_b64_tr_b16 a[20:21], v5 offset:21824
  v_mfma_f32_16x16x32_bf16 v[228:231], a[48:51], a[60:63], v[228:231]
  ds_read_b64_tr_b16 a[22:23], v5 offset:25408
  v_mfma_f32_16x16x32_bf16 v[232:235], a[48:51], a[64:67], v[232:235]
  v_mfma_f32_16x16x32_bf16 v[236:239], a[48:51], a[68:71], v[236:239]
  v_mfma_f32_16x16x32_bf16 v[240:243], a[52:55], a[56:59], v[240:243]
  ds_read_b64_tr_b16 a[24:25], v6 offset:192
  v_mfma_f32_16x16x32_bf16 v[244:247], a[52:55], a[60:63], v[244:247]
  ds_read_b64_tr_b16 a[26:27], v6 offset:3776
  v_mfma_f32_16x16x32_bf16 v[248:251], a[52:55], a[64:67], v[248:251]
  s_waitcnt vmcnt(2)
  v_cmp_eq_u32 vcc, 0, v20
  s_nop 0
  s_cmp_lg_u64 vcc, 0
  s_cbranch_scc1 L_g2_slow0
L_g2_back0:
  v_mov_b32 v0, 32768
  v_mov_b32 v1, 1
  s_mov_b64 exec, 1
  buffer_store_dword v1, v0, s[48:51], s77 offen sc1
  s_mov_b64 exec, -1
  v_mul_f32 v22, v192, v192
  v_mfma_f32_16x16x32_bf16 v[252:255], a[52:55], a[68:71], v[252:255]
  v_mul_f32 v23, v193, v193
  v_mul_f32 v24, v194, v194
  v_mul_f32 v25, v195, v195
  s_mov_b32 s36, 0
  s_waitcnt lgkmcnt(10)
  v_mfma_f32_16x16x32_bf16 v[224:227], a[0:3], a[72:75], v[224:227]
  ds_read_b64_tr_b16 a[28:29], v6 offset:14656
  v_mfma_f32_16x16x32_bf16 v[228:231], a[0:3], a[76:79], v[228:231]
  ds_read_b64_tr_b16 a[30:31], v6 offset:18240
  v_mfma_f32_16x16x32_bf16 v[232:235], a[0:3], a[80:83], v[232:235]
  buffer_load_dwordx4 a[184:187], v18, s[28:31], s36 offen offset:0 sc1
  v_mul_f32 v26, v196, v196
  v_mul_f32 v27, v197, v197
  v_mul_f32 v28, v198, v198
  v_mul_f32 v29, v199, v199
  v_fma_f32 v22, v22, s44, v30
  v_fma_f32 v23, v23, s44, v30
  v_fma_f32 v24, v24, s44, v30
  v_fma_f32 v25, v25, s44, v30
  v_fma_f32 v26, v26, s44, v30
  v_mfma_f32_16x16x32_bf16 v[236:239], a[0:3], a[84:87], v[236:239]
  v_mfma_f32_16x16x32_bf16 v[240:243], a[4:7], a[72:75], v[240:243]
  ds_read_b64_tr_b16 a[32:33], v6 offset:7360
  v_mfma_f32_16x16x32_bf16 v[244:247], a[4:7], a[76:79], v[244:247]
  ds_read_b64_tr_b16 a[34:35], v6 offset:10944
  v_mfma_f32_16x16x32_bf16 v[248:251], a[4:7], a[80:83], v[248:251]
  buffer_load_dwordx4 a[188:191], v18, s[28:31], s36 offen offset:256 sc1
  v_fma_f32 v27, v27, s44, v30
  v_fma_f32 v28, v28, s44, v30
  v_fma_f32 v29, v29, s44, v30
  v_mul_f32 v22, v22, v192
  v_mul_f32 v23, v23, v193
  v_mul_f32 v24, v24, v194
  v_mul_f32 v25, v25, v195
  v_mul_f32 v26, v26, v196
  v_mul_f32 v27, v27, v197
  v_mfma_f32_16x16x32_bf16 v[252:255], a[4:7], a[84:87], v[252:255]
  s_waitcnt lgkmcnt(10)
  v_mfma_f32_16x16x32_bf16 v[224:227], a[8:11], a[88:91], v[224:227]
  ds_read_b64_tr_b16 a[36:37], v6 offset:21824
  v_mfma_f32_16x16x32_bf16 v[228:231], a[8:11], a[92:95], v[228:231]
  ds_read_b64_tr_b16 a[38:39], v6 offset:25408
  v_mfma_f32_16x16x32_bf16 v[232:235], a[8:11], a[96:99], v[232:235]
  buffer_load_dwordx4 a[192:195], v18, s[28:31], s36 offen offset:1024 sc1
  v_mul_f32 v28, v28, v198
  v_mul_f32 v29, v29, v199
  v_exp_f32 v22, v22
  v_mul_f32 v208, v208, v192
  v_exp_f32 v23, v23
  v_mul_f32 v209, v209, v193
  v_exp_f32 v24, v24
  v_mul_f32 v210, v210, v194
  v_exp_f32 v25, v25
  v_mfma_f32_16x16x32_bf16 v[236:239], a[8:11], a[100:103], v[236:239]
  v_mfma_f32_16x16x32_bf16 v[240:243], a[12:15], a[88:91], v[240:243]
  ds_read_b64_tr_b16 a[40:41], v7 offset:192
  v_mfma_f32_16x16x32_bf16 v[244:247], a[12:15], a[92:95], v[244:247]
  ds_read_b64_tr_b16 a[42:43], v7 offset:3776
  v_mfma_f32_16x16x32_bf16 v[248:251], a[12:15], a[96:99], v[248:251]
  buffer_load_dwordx4 a[196:199], v18, s[28:31], s36 offen offset:1280 sc1
  v_mul_f32 v211, v211, v195
  v_exp_f32 v26, v26
  v_mul_f32 v212, v212, v196
  v_exp_f32 v27, v27
  v_mul_f32 v213, v213, v197
  v_exp_f32 v28, v28
  v_mul_f32 v214, v214, v198
  v_exp_f32 v29, v29
  v_mul_f32 v215, v215, v199
  v_mfma_f32_16x16x32_bf16 v[252:255], a[12:15], a[100:103], v[252:255]
  s_mov_b32 s36, 4096
  s_waitcnt lgkmcnt(10)
  v_mfma_f32_16x16x32_bf16 v[224:227], a[16:19], a[104:107], v[224:227]
  ds_read_b64_tr_b16 a[44:45], v7 offset:14656
  v_mfma_f32_16x16x32_bf16 v[228:231], a[16:19], a[108:111], v[228:231]
  ds_read_b64_tr_b16 a[46:47], v7 offset:18240
  v_mfma_f32_16x16x32_bf16 v[232:235], a[16:19], a[112:115], v[232:235]
  buffer_load_dwordx4 a[200:203], v18, s[28:31], s36 offen offset:0 sc1
  v_add_f32 v22, 1.0, v22
  v_add_f32 v23, 1.0, v23
  v_add_f32 v24, 1.0, v24
  v_add_f32 v25, 1.0, v25
  v_add_f32 v26, 1.0, v26
  v_add_f32 v27, 1.0, v27
  v_add_f32 v28, 1.0, v28
  v_add_f32 v29, 1.0, v29
  v_rcp_f32 v22, v22
  v_mfma_f32_16x16x32_bf16 v[236:239], a[16:19], a[116:119], v[236:239]
  v_mfma_f32_16x16x32_bf16 v[240:243], a[20:23], a[104:107], v[240:243]
  ds_read_b64_tr_b16 a[48:49], v7 offset:7360
  v_mfma_f32_16x16x32_bf16 v[244:247], a[20:23], a[108:111], v[244:247]
  ds_read_b64_tr_b16 a[50:51], v7 offset:10944
  v_mfma_f32_16x16x32_bf16 v[248:251], a[20:23], a[112:115], v[248:251]
  buffer_load_dwordx4 a[204:207], v18, s[28:31], s36 offen offset:256 sc1
  v_rcp_f32 v23, v23
  v_rcp_f32 v24, v24
  v_rcp_f32 v25, v25
  v_rcp_f32 v26, v26
  v_rcp_f32 v27, v27
  v_rcp_f32 v28, v28
  v_rcp_f32 v29, v29
  v_mul_f32 v208, v208, v22
  v_mul_f32 v209, v209, v23
  v_mfma_f32_16x16x32_bf16 v[252:255], a[20:23], a[116:119], v[252:255]
  s_waitcnt lgkmcnt(10)
  v_mfma_f32_16x16x32_bf16 v[224:227], a[24:27], a[120:123], v[224:227]
  ds_read_b64_tr_b16 a[52:53], v7 offset:21824
  v_mfma_f32_16x16x32_bf16 v[228:231], a[24:27], a[124:127], v[228:231]
  ds_read_b64_tr_b16 a[54:55], v7 offset:25408
  v_mfma_f32_16x16x32_bf16 v[232:235], a[24:27], a[128:131], v[232:235]
  buffer_load_dwordx4 a[208:211], v18, s[28:31], s36 offen offset:1024 sc1
  v_mul_f32 v210, v210, v24
  v_mul_f32 v211, v211, v25
  v_mul_f32 v212, v212, v26
  v_mul_f32 v213, v213, v27
  v_mul_f32 v214, v214, v28
  v_mul_f32 v215, v215, v29
  v_cvt_pk_bf16_f32 v192, v208, v209
  v_cvt_pk_bf16_f32 v194, v212, v213
  v_cvt_pk_bf16_f32 v193, v210, v211
  v_mfma_f32_16x16x32_bf16 v[236:239], a[24:27], a[132:135], v[236:239]
  v_mfma_f32_16x16x32_bf16 v[240:243], a[28:31], a[120:123], v[240:243]
  v_mfma_f32_16x16x32_bf16 v[244:247], a[28:31], a[124:127], v[244:247]
  v_mfma_f32_16x16x32_bf16 v[248:251], a[28:31], a[128:131], v[248:251]
  buffer_load_dwordx4 a[212:215], v18, s[28:31], s36 offen offset:1280 sc1
  v_cvt_pk_bf16_f32 v195, v214, v215
  v_permlane16_swap_b32 v192, v194
  s_nop 0
  v_permlane16_swap_b32 v193, v195
  v_mfma_f32_16x16x32_bf16 v[252:255], a[28:31], a[132:135], v[252:255]
  s_waitcnt lgkmcnt(8)
  v_mfma_f32_16x16x32_bf16 v[224:227], a[32:35], a[136:139], v[224:227]
  v_mfma_f32_16x16x32_bf16 v[228:231], a[32:35], a[140:143], v[228:231]
  v_mfma_f32_16x16x32_bf16 v[232:235], a[32:35], a[144:147], v[232:235]
  buffer_store_dwordx4 v[192:195], v15, s[40:43], s46 offen sc1
  s_add_u32 s46, s46, 16384
  v_mul_f32 v22, v200, v200
  v_mul_f32 v23, v201, v201
  v_mul_f32 v24, v202, v202
  v_mul_f32 v25, v203, v203
  v_mfma_f32_16x16x32_bf16 v[236:239], a[32:35], a[148:151], v[236:239]
  s_mov_b32 s36, 8192
  v_mfma_f32_16x16x32_bf16 v[240:243], a[36:39], a[136:139], v[240:243]
  v_mfma_f32_16x16x32_bf16 v[244:247], a[36:39], a[140:143], v[244:247]
  v_mfma_f32_16x16x32_bf16 v[248:251], a[36:39], a[144:147], v[248:251]
  buffer_load_dwordx4 a[216:219], v18, s[28:31], s36 offen offset:0 sc1
  v_mul_f32 v26, v204, v204
  v_mul_f32 v27, v205, v205
  v_mul_f32 v28, v206, v206
  v_mul_f32 v29, v207, v207
  v_fma_f32 v22, v22, s44, v30
  v_fma_f32 v23, v23, s44, v30
  v_fma_f32 v24, v24, s44, v30
  v_fma_f32 v25, v25, s44, v30
  v_fma_f32 v26, v26, s44, v30
  v_mfma_f32_16x16x32_bf16 v[252:255], a[36:39], a[148:151], v[252:255]
  s_waitcnt lgkmcnt(4)
  v_mfma_f32_16x16x32_bf16 v[224:227], a[40:43], a[152:155], v[224:227]
  v_mfma_f32_16x16x32_bf16 v[228:231], a[40:43], a[156:159], v[228:231]
  v_mfma_f32_16x16x32_bf16 v[232:235], a[40:43], a[160:163], v[232:235]
  buffer_load_dwordx4 a[220:223], v18, s[28:31], s36 offen offset:256 sc1
  v_fma_f32 v27, v27, s44, v30
  v_fma_f32 v28, v28, s44, v30
  v_fma_f32 v29, v29, s44, v30
  v_mul_f32 v22, v22, v200
  v_mul_f32 v23, v23, v201
  v_mul_f32 v24, v24, v202
  v_mul_f32 v25, v25, v203
  v_mul_f32 v26, v26, v204
  v_mul_f32 v27, v27, v205
  v_mfma_f32_16x16x32_bf16 v[236:239], a[40:43], a[164:167], v[236:239]
  v_mfma_f32_16x16x32_bf16 v[240:243], a[44:47], a[152:155], v[240:243]
  v_mfma_f32_16x16x32_bf16 v[244:247], a[44:47], a[156:159], v[244:247]
  v_mfma_f32_16x16x32_bf16 v[248:251], a[44:47], a[160:163], v[248:251]
  buffer_load_dwordx4 a[224:227], v18, s[28:31], s36 offen offset:1024 sc1
  v_mul_f32 v28, v28, v206
  v_mul_f32 v29, v29, v207
  v_exp_f32 v22, v22
  v_mul_f32 v216, v216, v200
  v_exp_f32 v23, v23
  v_mul_f32 v217, v217, v201
  v_exp_f32 v24, v24
  v_mul_f32 v218, v218, v202
  v_exp_f32 v25, v25
  v_mfma_f32_16x16x32_bf16 v[252:255], a[44:47], a[164:167], v[252:255]
  s_waitcnt lgkmcnt(0)
  v_mfma_f32_16x16x32_bf16 v[224:227], a[48:51], a[168:171], v[224:227]
  v_mfma_f32_16x16x32_bf16 v[228:231], a[48:51], a[172:175], v[228:231]
  v_mfma_f32_16x16x32_bf16 v[232:235], a[48:51], a[176:179], v[232:235]
  buffer_load_dwordx4 a[228:231], v18, s[28:31], s36 offen offset:1280 sc1
  v_mul_f32 v219, v219, v203
  v_exp_f32 v26, v26
  v_mul_f32 v220, v220, v204
  v_exp_f32 v27, v27
  v_mul_f32 v221, v221, v205
  v_exp_f32 v28, v28
  v_mul_f32 v222, v222, v206
  v_exp_f32 v29, v29
  v_mul_f32 v223, v223, v207
  v_mfma_f32_16x16x32_bf16 v[236:239], a[48:51], a[180:183], v[236:239]
  s_mov_b32 s36, 12288
  v_mfma_f32_16x16x32_bf16 v[240:243], a[52:55], a[168:171], v[240:243]
  v_mfma_f32_16x16x32_bf16 v[244:247], a[52:55], a[172:175], v[244:247]
  v_mfma_f32_16x16x32_bf16 v[248:251], a[52:55], a[176:179], v[248:251]
  buffer_load_dwordx4 a[232:235], v18, s[28:31], s36 offen offset:0 sc1
  v_add_f32 v22, 1.0, v22
  v_add_f32 v23, 1.0, v23
  v_add_f32 v24, 1.0, v24
  v_add_f32 v25, 1.0, v25
  v_add_f32 v26, 1.0, v26
  v_add_f32 v27, 1.0, v27
  v_add_f32 v28, 1.0, v28
  v_add_f32 v29, 1.0, v29
  v_rcp_f32 v22, v22
  v_mfma_f32_16x16x32_bf16 v[252:255], a[52:55], a[180:183], v[252:255]
  buffer_load_dwordx4 a[236:239], v18, s[28:31], s36 offen offset:256 sc1
  v_rcp_f32 v23, v23
  v_rcp_f32 v24, v24
  v_rcp_f32 v25, v25
  v_rcp_f32 v26, v26
  v_rcp_f32 v27, v27
  v_rcp_f32 v28, v28
  v_rcp_f32 v29, v29
  v_mul_f32 v216, v216, v22
  v_mul_f32 v217, v217, v23
  buffer_load_dwordx4 a[240:243], v18, s[28:31], s36 offen offset:1024 sc1
  v_mul_f32 v218, v218, v24
  v_mul_f32 v219, v219, v25
  v_mul_f32 v220, v220, v26
  v_mul_f32 v221, v221, v27
  v_mul_f32 v222, v222, v28
  v_mul_f32 v223, v223, v29
  v_cvt_pk_bf16_f32 v200, v216, v217
  v_cvt_pk_bf16_f32 v202, v220, v221
  v_cvt_pk_bf16_f32 v201, v218, v219
  buffer_load_dwordx4 a[244:247], v18, s[28:31], s36 offen offset:1280 sc1
  v_cvt_pk_bf16_f32 v203, v222, v223
  v_permlane16_swap_b32 v200, v202
  s_nop 0
  v_permlane16_swap_b32 v201, v203
  buffer_store_dwordx4 v[200:203], v15, s[40:43], s47 offen sc1
  s_add_u32 s47, s47, 16384
  s_waitcnt vmcnt(28)
  s_barrier
  v_add_u32 v4, 131072, v16
  v_xor_b32 v5, 32, v4
  v_xor_b32 v6, 64, v4
  v_xor_b32 v7, 96, v4
  v_xor_b32 v12, 128, v4
  v_xor_b32 v13, 160, v4
  v_xor_b32 v14, 192, v4
  v_xor_b32 v17, 224, v4
  ds_read_b64_tr_b16 a[0:1], v4 offset:0
  ds_read_b64_tr_b16 a[2:3], v4 offset:1024
  ds_read_b64_tr_b16 a[4:5], v5 offset:0
  ds_read_b64_tr_b16 a[6:7], v5 offset:1024
  ds_read_b64_tr_b16 a[8:9], v6 offset:0
  ds_read_b64_tr_b16 a[10:11], v6 offset:1024
  ds_read_b64_tr_b16 a[12:13], v7 offset:0
  ds_read_b64_tr_b16 a[14:15], v7 offset:1024
  ds_read_b64_tr_b16 a[16:17], v12 offset:0
  ds_read_b64_tr_b16 a[18:19], v12 offset:1024
  ds_read_b64_tr_b16 a[20:21], v13 offset:0
  ds_read_b64_tr_b16 a[22:23], v13 offset:1024
  ds_read_b64_tr_b16 a[24:25], v14 offset:0
  ds_read_b64_tr_b16 a[26:27], v14 offset:1024
  s_waitcnt vmcnt(14) lgkmcnt(10)
  v_mfma_f32_16x16x32_bf16 v[32:35], a[0:3], a[184:187], 0
  ds_read_b64_tr_b16 a[28:29], v17 offset:0
  v_mul_f32 v22, v224, v224
  v_mul_f32 v23, v225, v225
  v_mfma_f32_16x16x32_bf16 v[36:39], a[0:3], a[188:191], 0
  ds_read_b64_tr_b16 a[30:31], v17 offset:1024
  s_add_u32 s34, s32, 32768
  s_add_u32 m0, s33, 65536
  v_mfma_f32_16x16x32_bf16 v[40:43], a[0:3], a[192:195], 0
  buffer_load_dwordx4 v8, s[52:55], s34 offen offset:0 lds
  v_mul_f32 v24, v226, v226
  v_mul_f32 v25, v227, v227
  v_mfma_f32_16x16x32_bf16 v[44:47], a[0:3], a[196:199], 0
  v_mul_f32 v26, v228, v228
  v_mfma_f32_16x16x32_bf16 v[48:51], a[4:7], a[184:187], 0
  ds_read_b64_tr_b16 a[32:33], v4 offset:8192
  v_mul_f32 v27, v229, v229
  v_mfma_f32_16x16x32_bf16 v[52:55], a[4:7], a[188:191], 0
  ds_read_b64_tr_b16 a[34:35], v4 offset:9216
  v_mfma_f32_16x16x32_bf16 v[56:59], a[4:7], a[192:195], 0
  buffer_load_dwordx4 v9, s[52:55], s34 offen offset:1024 lds
  v_mul_f32 v28, v230, v230
  v_mul_f32 v29, v231, v231
  v_mfma_f32_16x16x32_bf16 v[60:63], a[4:7], a[196:199], 0
  v_fma_f32 v22, v22, s44, v30
  s_waitcnt lgkmcnt(10)
  v_mfma_f32_16x16x32_bf16 v[64:67], a[8:11], a[184:187], 0
  ds_read_b64_tr_b16 a[36:37], v5 offset:8192
  v_fma_f32 v23, v23, s44, v30
  v_fma_f32 v24, v24, s44, v30
  v_mfma_f32_16x16x32_bf16 v[68:71], a[8:11], a[188:191], 0
  ds_read_b64_tr_b16 a[38:39], v5 offset:9216
  v_mfma_f32_16x16x32_bf16 v[72:75], a[8:11], a[192:195], 0
  buffer_load_dwordx4 v10, s[52:55], s34 offen offset:2048 lds
  v_fma_f32 v25, v25, s44, v30
  v_fma_f32 v26, v26, s44, v30
  v_mfma_f32_16x16x32_bf16 v[76:79], a[8:11], a[196:199], 0
  v_fma_f32 v27, v27, s44, v30
  v_mfma_f32_16x16x32_bf16 v[80:83], a[12:15], a[184:187], 0
  ds_read_b64_tr_b16 a[40:41], v6 offset:8192
  v_fma_f32 v28, v28, s44, v30
  v_mfma_f32_16x16x32_bf16 v[84:87], a[12:15], a[188:191], 0
  ds_read_b64_tr_b16 a[42:43], v6 offset:9216
  v_mfma_f32_16x16x32_bf16 v[88:91], a[12:15], a[192:195], 0
  buffer_load_dwordx4 v11, s[52:55], s34 offen offset:3072 lds
  v_fma_f32 v29, v29, s44, v30
  v_mul_f32 v22, v22, v224
  v_mfma_f32_16x16x32_bf16 v[92:95], a[12:15], a[196:199], 0
  v_mul_f32 v23, v23, v225
  s_waitcnt lgkmcnt(10)
  v_mfma_f32_16x16x32_bf16 v[96:99], a[16:19], a[184:187], 0
  ds_read_b64_tr_b16 a[44:45], v7 offset:8192
  v_mul_f32 v24, v24, v226
  v_mul_f32 v25, v25, v227
  v_mfma_f32_16x16x32_bf16 v[100:103], a[16:19], a[188:191], 0
  ds_read_b64_tr_b16 a[46:47], v7 offset:9216
  s_add_u32 s34, s32, 950272
  s_add_u32 m0, s33, 81920
  v_mfma_f32_16x16x32_bf16 v[104:107], a[16:19], a[192:195], 0
  buffer_load_dwordx4 v8, s[52:55], s34 offen offset:0 lds
  v_mul_f32 v26, v26, v228
  v_mul_f32 v27, v27, v229
  v_mul_f32 v28, v28, v230
  v_mfma_f32_16x16x32_bf16 v[108:111], a[16:19], a[196:199], 0
  v_mul_f32 v29, v29, v231
  v_mfma_f32_16x16x32_bf16 v[112:115], a[20:23], a[184:187], 0
  ds_read_b64_tr_b16 a[48:49], v12 offset:8192
  v_mfma_f32_16x16x32_bf16 v[116:119], a[20:23], a[188:191], 0
  ds_read_b64_tr_b16 a[50:51], v12 offset:9216
  v_mfma_f32_16x16x32_bf16 v[120:123], a[20:23], a[192:195], 0
  buffer_load_dwordx4 v9, s[52:55], s34 offen offset:1024 lds
  v_exp_f32 v22, v22
  v_mul_f32 v240, v240, v224
  v_exp_f32 v23, v23
  v_mfma_f32_16x16x32_bf16 v[124:127], a[20:23], a[196:199], 0
  v_mul_f32 v241, v241, v225
  s_waitcnt lgkmcnt(10)
  v_mfma_f32_16x16x32_bf16 v[128:131], a[24:27], a[184:187], 0
  ds_read_b64_tr_b16 a[52:53], v13 offset:8192
  v_exp_f32 v24, v24
  v_mfma_f32_16x16x32_bf16 v[132:135], a[24:27], a[188:191], 0
  ds_read_b64_tr_b16 a[54:55], v13 offset:9216
  v_mfma_f32_16x16x32_bf16 v[136:139], a[24:27], a[192:195], 0
  buffer_load_dwordx4 v10, s[52:55], s34 offen offset:2048 lds
  v_mul_f32 v242, v242, v226
  v_exp_f32 v25, v25
  v_mfma_f32_16x16x32_bf16 v[140:143], a[24:27], a[196:199], 0
  v_mul_f32 v243, v243, v227
  v_mfma_f32_16x16x32_bf16 v[144:147], a[28:31], a[184:187], 0
  ds_read_b64_tr_b16 a[0:1], v14 offset:8192
  v_exp_f32 v26, v26
  v_mfma_f32_16x16x32_bf16 v[148:151], a[28:31], a[188:191], 0
  ds_read_b64_tr_b16 a[2:3], v14 offset:9216
  s_mov_b32 s98, 32768
  v_mfma_f32_16x16x32_bf16 v[152:155], a[28:31], a[192:195], 0
  buffer_load_dword v20, v21, s[48:51], s98 offen sc1
  v_mul_f32 v244, v244, v228
  v_exp_f32 v27, v27
  v_mfma_f32_16x16x32_bf16 v[156:159], a[28:31], a[196:199], 0
  v_mul_f32 v245, v245, v229
  s_waitcnt vmcnt(18) lgkmcnt(10)
  v_mfma_f32_16x16x32_bf16 v[32:35], a[32:35], a[200:203], v[32:35]
  ds_read_b64_tr_b16 a[4:5], v17 offset:8192
  v_exp_f32 v28, v28
  v_mfma_f32_16x16x32_bf16 v[36:39], a[32:35], a[204:207], v[36:39]
  ds_read_b64_tr_b16 a[6:7], v17 offset:9216
  v_mul_f32 v246, v246, v230
  v_mfma_f32_16x16x32_bf16 v[40:43], a[32:35], a[208:211], v[40:43]
  buffer_load_dwordx4 v11, s[52:55], s34 offen offset:3072 lds
  v_exp_f32 v29, v29
  v_mfma_f32_16x16x32_bf16 v[44:47], a[32:35], a[212:215], v[44:47]
  v_mul_f32 v247, v247, v231
  v_add_f32 v22, 1.0, v22
  s_waitcnt vmcnt(32)
  s_barrier
  v_mfma_f32_16x16x32_bf16 v[48:51], a[36:39], a[200:203], v[48:51]
  ds_read_b64_tr_b16 a[8:9], v4 offset:16384
  v_add_f32 v23, 1.0, v23
  v_mfma_f32_16x16x32_bf16 v[52:55], a[36:39], a[204:207], v[52:55]
  ds_read_b64_tr_b16 a[10:11], v4 offset:17408
  s_mov_b32 s36, 16384
  v_mfma_f32_16x16x32_bf16 v[56:59], a[36:39], a[208:211], v[56:59]
  buffer_load_dwordx4 a[56:59], v18, s[28:31], s36 offen offset:0 sc1
  v_add_f32 v24, 1.0, v24
  v_add_f32 v25, 1.0, v25
  v_add_f32 v26, 1.0, v26
  v_add_f32 v27, 1.0, v27
  v_mfma_f32_16x16x32_bf16 v[60:63], a[36:39], a[212:215], v[60:63]
  v_add_f32 v28, 1.0, v28
  s_add_u32 s34, s32, 65536
  s_add_u32 m0, s33, 98304
  s_waitcnt lgkmcnt(10)
  v_mfma_f32_16x16x32_bf16 v[64:67], a[40:43], a[200:203], v[64:67]
  ds_read_b64_tr_b16 a[12:13], v5 offset:16384
  v_mfma_f32_16x16x32_bf16 v[68:71], a[40:43], a[204:207], v[68:71]
  ds_read_b64_tr_b16 a[14:15], v5 offset:17408
  v_mfma_f32_16x16x32_bf16 v[72:75], a[40:43], a[208:211], v[72:75]
  buffer_load_dwordx4 v8, s[52:55], s34 offen offset:0 lds
  v_add_f32 v29, 1.0, v29
  v_rcp_f32 v22, v22
  v_rcp_f32 v23, v23
  v_mfma_f32_16x16x32_bf16 v[76:79], a[40:43], a[212:215], v[76:79]
  v_rcp_f32 v24, v24
  v_mfma_f32_16x16x32_bf16 v[80:83], a[44:47], a[200:203], v[80:83]
  ds_read_b64_tr_b16 a[16:17], v6 offset:16384
  v_mfma_f32_16x16x32_bf16 v[84:87], a[44:47], a[204:207], v[84:87]
  ds_read_b64_tr_b16 a[18:19], v6 offset:17408
  v_mfma_f32_16x16x32_bf16 v[88:91], a[44:47], a[208:211], v[88:91]
  buffer_load_dwordx4 a[60:63], v18, s[28:31], s36 offen offset:256 sc1
  v_rcp_f32 v25, v25
  v_rcp_f32 v26, v26
  v_rcp_f32 v27, v27
  v_mfma_f32_16x16x32_bf16 v[92:95], a[44:47], a[212:215], v[92:95]
  s_waitcnt lgkmcnt(10)
  v_mfma_f32_16x16x32_bf16 v[96:99], a[48:51], a[200:203], v[96:99]
  ds_read_b64_tr_b16 a[20:21], v7 offset:16384
  v_rcp_f32 v28, v28
  v_mfma_f32_16x16x32_bf16 v[100:103], a[48:51], a[204:207], v[100:103]
  ds_read_b64_tr_b16 a[22:23], v7 offset:17408
  v_rcp_f32 v29, v29
  v_mfma_f32_16x16x32_bf16 v[104:107], a[48:51], a[208:211], v[104:107]
  buffer_load_dwordx4 a[64:67], v18, s[28:31], s36 offen offset:1024 sc1
  v_mfma_f32_16x16x32_bf16 v[108:111], a[48:51], a[212:215], v[108:111]
  v_mul_f32 v240, v240, v22
  v_mfma_f32_16x16x32_bf16 v[112:115], a[52:55], a[200:203], v[112:115]
  ds_read_b64_tr_b16 a[24:25], v12 offset:16384
  v_mul_f32 v241, v241, v23
  v_mul_f32 v242, v242, v24
  v_mfma_f32_16x16x32_bf16 v[116:119], a[52:55], a[204:207], v[116:119]
  ds_read_b64_tr_b16 a[26:27], v12 offset:17408
  v_mul_f32 v243, v243, v25
  v_mfma_f32_16x16x32_bf16 v[120:123], a[52:55], a[208:211], v[120:123]
  buffer_load_dwordx4 a[68:71], v18, s[28:31], s36 offen offset:1280 sc1
  v_mul_f32 v244, v244, v26
  v_mfma_f32_16x16x32_bf16 v[124:127], a[52:55], a[212:215], v[124:127]
  v_mul_f32 v245, v245, v27
  s_waitcnt lgkmcnt(10)
  v_mfma_f32_16x16x32_bf16 v[128:131], a[0:3], a[200:203], v[128:131]
  ds_read_b64_tr_b16 a[28:29], v13 offset:16384
  v_mul_f32 v246, v246, v28
  v_mul_f32 v247, v247, v29
  v_mfma_f32_16x16x32_bf16 v[132:135], a[0:3], a[204:207], v[132:135]
  ds_read_b64_tr_b16 a[30:31], v13 offset:17408
  v_cvt_pk_bf16_f32 v224, v240, v241
  v_mfma_f32_16x16x32_bf16 v[136:139], a[0:3], a[208:211], v[136:139]
  buffer_load_dwordx4 v9, s[52:55], s34 offen offset:1024 lds
  v_cvt_pk_bf16_f32 v226, v244, v245
  v_mfma_f32_16x16x32_bf16 v[140:143], a[0:3], a[212:215], v[140:143]
  v_cvt_pk_bf16_f32 v225, v242, v243
  v_mfma_f32_16x16x32_bf16 v[144:147], a[4:7], a[200:203], v[144:147]
  ds_read_b64_tr_b16 a[32:33], v14 offset:16384
  v_cvt_pk_bf16_f32 v227, v246, v247
  v_permlane16_swap_b32 v224, v226
  v_mfma_f32_16x16x32_bf16 v[148:151], a[4:7], a[204:207], v[148:151]
  ds_read_b64_tr_b16 a[34:35], v14 offset:17408
  s_mov_b32 s36, 20480
  v_mfma_f32_16x16x32_bf16 v[152:155], a[4:7], a[208:211], v[152:155]
  buffer_load_dwordx4 a[72:75], v18, s[28:31], s36 offen offset:0 sc1
  s_nop 0
  v_permlane16_swap_b32 v225, v227
  v_mfma_f32_16x16x32_bf16 v[156:159], a[4:7], a[212:215], v[156:159]
  v_mul_f32 v22, v232, v232
  s_waitcnt vmcnt(21) lgkmcnt(10)
  v_mfma_f32_16x16x32_bf16 v[32:35], a[8:11], a[216:219], v[32:35]
  ds_read_b64_tr_b16 a[36:37], v17 offset:16384
  s_waitcnt vmcnt(16)
  v_mul_f32 v23, v233, v233
  v_mfma_f32_16x16x32_bf16 v[36:39], a[8:11], a[220:223], v[36:39]
  ds_read_b64_tr_b16 a[38:39], v17 offset:17408
  v_mul_f32 v24, v234, v234
  v_mfma_f32_16x16x32_bf16 v[40:43], a[8:11], a[224:227], v[40:43]
  buffer_load_dwordx4 v10, s[52:55], s34 offen offset:2048 lds
  v_mul_f32 v25, v235, v235
  v_mfma_f32_16x16x32_bf16 v[44:47], a[8:11], a[228:231], v[44:47]
  v_mul_f32 v26, v236, v236
  v_mfma_f32_16x16x32_bf16 v[48:51], a[12:15], a[216:219], v[48:51]
  ds_read_b64_tr_b16 a[40:41], v4 offset:24576
  v_mul_f32 v27, v237, v237
  v_mul_f32 v28, v238, v238
  v_mfma_f32_16x16x32_bf16 v[52:55], a[12:15], a[220:223], v[52:55]
  ds_read_b64_tr_b16 a[42:43], v4 offset:25600
  v_mfma_f32_16x16x32_bf16 v[56:59], a[12:15], a[224:227], v[56:59]
  buffer_load_dwordx4 a[76:79], v18, s[28:31], s36 offen offset:256 sc1
  v_mul_f32 v29, v239, v239
  v_fma_f32 v22, v22, s44, v30
  v_mfma_f32_16x16x32_bf16 v[60:63], a[12:15], a[228:231], v[60:63]
  v_fma_f32 v23, v23, s44, v30
  s_waitcnt lgkmcnt(10)
  v_mfma_f32_16x16x32_bf16 v[64:67], a[16:19], a[216:219], v[64:67]
  ds_read_b64_tr_b16 a[44:45], v5 offset:24576
  v_fma_f32 v24, v24, s44, v30
  v_mfma_f32_16x16x32_bf16 v[68:71], a[16:19], a[220:223], v[68:71]
  ds_read_b64_tr_b16 a[46:47], v5 offset:25600
  v_fma_f32 v25, v25, s44, v30
  v_mfma_f32_16x16x32_bf16 v[72:75], a[16:19], a[224:227], v[72:75]
  buffer_load_dwordx4 a[80:83], v18, s[28:31], s36 offen offset:1024 sc1
  v_fma_f32 v26, v26, s44, v30
  v_mfma_f32_16x16x32_bf16 v[76:79], a[16:19], a[228:231], v[76:79]
  v_fma_f32 v27, v27, s44, v30
  v_fma_f32 v28, v28, s44, v30
  v_mfma_f32_16x16x32_bf16 v[80:83], a[20:23], a[216:219], v[80:83]
  ds_read_b64_tr_b16 a[48:49], v6 offset:24576
  v_fma_f32 v29, v29, s44, v30
  v_mfma_f32_16x16x32_bf16 v[84:87], a[20:23], a[220:223], v[84:87]
  ds_read_b64_tr_b16 a[50:51], v6 offset:25600
  v_mfma_f32_16x16x32_bf16 v[88:91], a[20:23], a[224:227], v[88:91]
  v_mov_b32 v0, 65536
  v_mov_b32 v1, 1
  s_mov_b64 exec, 1
  buffer_store_dword v1, v0, s[48:51], s77 offen sc1
  s_mov_b64 exec, -1
  v_mul_f32 v22, v22, v232
  v_mul_f32 v23, v23, v233
  v_mfma_f32_16x16x32_bf16 v[92:95], a[20:23], a[228:231], v[92:95]
  v_mul_f32 v24, v24, v234
  s_waitcnt lgkmcnt(10)
  v_mfma_f32_16x16x32_bf16 v[96:99], a[24:27], a[216:219], v[96:99]
  ds_read_b64_tr_b16 a[52:53], v7 offset:24576
  s_waitcnt vmcnt(12)
  v_cmp_eq_u32 vcc, 0, v20
  s_nop 0
  s_cmp_lg_u64 vcc, 0
  s_cbranch_scc1 L_g2_slow1
L_g2_back1:
  v_mfma_f32_16x16x32_bf16 v[100:103], a[24:27], a[220:223], v[100:103]
  ds_read_b64_tr_b16 a[54:55], v7 offset:25600
  v_mul_f32 v25, v25, v235
  v_mul_f32 v26, v26, v236
  v_mfma_f32_16x16x32_bf16 v[104:107], a[24:27], a[224:227], v[104:107]
  buffer_load_dwordx4 a[84:87], v18, s[28:31], s36 offen offset:1280 sc1
  v_mul_f32 v27, v27, v237
  v_mfma_f32_16x16x32_bf16 v[108:111], a[24:27], a[228:231], v[108:111]
  v_mul_f32 v28, v28, v238
  v_mul_f32 v29, v29, v239
  v_mfma_f32_16x16x32_bf16 v[112:115], a[28:31], a[216:219], v[112:115]
  ds_read_b64_tr_b16 a[0:1], v12 offset:24576
  v_exp_f32 v22, v22
  v_mfma_f32_16x16x32_bf16 v[116:119], a[28:31], a[220:223], v[116:119]
  ds_read_b64_tr_b16 a[2:3], v12 offset:25600
  v_mfma_f32_16x16x32_bf16 v[120:123], a[28:31], a[224:227], v[120:123]
  buffer_load_dwordx4 v11, s[52:55], s34 offen offset:3072 lds
  v_mul_f32 v248, v248, v232
  v_exp_f32 v23, v23
  v_mfma_f32_16x16x32_bf16 v[124:127], a[28:31], a[228:231], v[124:127]
  v_mul_f32 v249, v249, v233
  v_exp_f32 v24, v24
  s_waitcnt lgkmcnt(10)
  v_mfma_f32_16x16x32_bf16 v[128:131], a[32:35], a[216:219], v[128:131]
  ds_read_b64_tr_b16 a[4:5], v13 offset:24576
  v_mul_f32 v250, v250, v234
  v_mfma_f32_16x16x32_bf16 v[132:135], a[32:35], a[220:223], v[132:135]
  ds_read_b64_tr_b16 a[6:7], v13 offset:25600
  s_mov_b32 s36, 24576
  v_mfma_f32_16x16x32_bf16 v[136:139], a[32:35], a[224:227], v[136:139]
  buffer_load_dwordx4 a[88:91], v18, s[28:31], s36 offen offset:0 sc1
  v_exp_f32 v25, v25
  v_mul_f32 v251, v251, v235
  v_mfma_f32_16x16x32_bf16 v[140:143], a[32:35], a[228:231], v[140:143]
  v_exp_f32 v26, v26
  v_mfma_f32_16x16x32_bf16 v[144:147], a[36:39], a[216:219], v[144:147]
  ds_read_b64_tr_b16 a[8:9], v14 offset:24576
  v_mul_f32 v252, v252, v236
  v_mfma_f32_16x16x32_bf16 v[148:151], a[36:39], a[220:223], v[148:151]
  ds_read_b64_tr_b16 a[10:11], v14 offset:25600
  s_add_u32 s34, s32, 983040
  s_add_u32 m0, s33, 114688
  v_mfma_f32_16x16x32_bf16 v[152:155], a[36:39], a[224:227], v[152:155]
  buffer_load_dwordx4 v8, s[52:55], s34 offen offset:0 lds
  v_exp_f32 v27, v27
  v_mul_f32 v253, v253, v237
  v_exp_f32 v28, v28
  v_mfma_f32_16x16x32_bf16 v[156:159], a[36:39], a[228:231], v[156:159]
  s_waitcnt vmcnt(25) lgkmcnt(10)
  v_mfma_f32_16x16x32_bf16 v[32:35], a[40:43], a[232:235], v[32:35]
  ds_read_b64_tr_b16 a[12:13], v17 offset:24576
  v_mul_f32 v254, v254, v238
  v_exp_f32 v29, v29
  v_mfma_f32_16x16x32_bf16 v[36:39], a[40:43], a[236:239], v[36:39]
  ds_read_b64_tr_b16 a[14:15], v17 offset:25600
  v_mfma_f32_16x16x32_bf16 v[40:43], a[40:43], a[240:243], v[40:43]
  buffer_load_dwordx4 a[92:95], v18, s[28:31], s36 offen offset:256 sc1
  v_mul_f32 v255, v255, v239
  v_add_f32 v22, 1.0, v22
  v_mfma_f32_16x16x32_bf16 v[44:47], a[40:43], a[244:247], v[44:47]
  v_add_f32 v23, 1.0, v23
  s_waitcnt vmcnt(21)
  s_barrier
  v_add_u32 v4, 65536, v16
  v_xor_b32 v5, 32, v4
  v_xor_b32 v6, 64, v4
  v_xor_b32 v7, 96, v4
  v_xor_b32 v12, 128, v4
  v_xor_b32 v13, 160, v4
  v_xor_b32 v14, 192, v4
  v_xor_b32 v17, 224, v4
  v_mfma_f32_16x16x32_bf16 v[48:51], a[44:47], a[232:235], v[48:51]
  ds_read_b64_tr_b16 a[16:17], v4 offset:0
  v_add_f32 v24, 1.0, v24
  v_mfma_f32_16x16x32_bf16 v[52:55], a[44:47], a[236:239], v[52:55]
  ds_read_b64_tr_b16 a[18:19], v4 offset:1024
  v_mfma_f32_16x16x32_bf16 v[56:59], a[44:47], a[240:243], v[56:59]
  buffer_load_dwordx4 a[96:99], v18, s[28:31], s36 offen offset:1024 sc1
  v_add_f32 v25, 1.0, v25
  v_add_f32 v26, 1.0, v26
  v_add_f32 v27, 1.0, v27
  v_add_f32 v28, 1.0, v28
  v_mfma_f32_16x16x32_bf16 v[60:63], a[44:47], a[244:247], v[60:63]
  s_waitcnt lgkmcnt(10)
  v_mfma_f32_16x16x32_bf16 v[64:67], a[48:51], a[232:235], v[64:67]
  ds_read_b64_tr_b16 a[20:21], v5 offset:0
  v_mfma_f32_16x16x32_bf16 v[68:71], a[48:51], a[236:239], v[68:71]
  ds_read_b64_tr_b16 a[22:23], v5 offset:1024
  v_mfma_f32_16x16x32_bf16 v[72:75], a[48:51], a[240:243], v[72:75]
  buffer_load_dwordx4 a[100:103], v18, s[28:31], s36 offen offset:1280 sc1
  v_add_f32 v29, 1.0, v29
  v_rcp_f32 v22, v22
  v_rcp_f32 v23, v23
  v_rcp_f32 v24, v24
  v_mfma_f32_16x16x32_bf16 v[76:79], a[48:51], a[244:247], v[76:79]
  v_mfma_f32_16x16x32_bf16 v[80:83], a[52:55], a[232:235], v[80:83]
  ds_read_b64_tr_b16 a[24:25], v6 offset:0
  v_mfma_f32_16x16x32_bf16 v[84:87], a[52:55], a[236:239], v[84:87]
  ds_read_b64_tr_b16 a[26:27], v6 offset:1024
  v_mfma_f32_16x16x32_bf16 v[88:91], a[52:55], a[240:243], v[88:91]
  buffer_load_dwordx4 v9, s[52:55], s34 offen offset:1024 lds
  v_rcp_f32 v25, v25
  v_rcp_f32 v26, v26
  v_rcp_f32 v27, v27
  v_mfma_f32_16x16x32_bf16 v[92:95], a[52:55], a[244:247], v[92:95]
  s_waitcnt lgkmcnt(10)
  v_mfma_f32_16x16x32_bf16 v[96:99], a[0:3], a[232:235], v[96:99]
  ds_read_b64_tr_b16 a[28:29], v7 offset:0
  v_rcp_f32 v28, v28
  v_mfma_f32_16x16x32_bf16 v[100:103], a[0:3], a[236:239], v[100:103]
  ds_read_b64_tr_b16 a[30:31], v7 offset:1024
  v_rcp_f32 v29, v29
  s_mov_b32 s36, 28672
  v_mfma_f32_16x16x32_bf16 v[104:107], a[0:3], a[240:243], v[104:107]
  buffer_load_dwordx4 a[104:107], v18, s[28:31], s36 offen offset:0 sc1
  v_mfma_f32_16x16x32_bf16 v[108:111], a[0:3], a[244:247], v[108:111]
  v_mul_f32 v248, v248, v22
  v_mfma_f32_16x16x32_bf16 v[112:115], a[4:7], a[232:235], v[112:115]
  ds_read_b64_tr_b16 a[32:33], v12 offset:0
  v_mul_f32 v249, v249, v23
  v_mul_f32 v250, v250, v24
  v_mfma_f32_16x16x32_bf16 v[116:119], a[4:7], a[236:239], v[116:119]
  ds_read_b64_tr_b16 a[34:35], v12 offset:1024
  v_mul_f32 v251, v251, v25
  v_mfma_f32_16x16x32_bf16 v[120:123], a[4:7], a[240:243], v[120:123]
  buffer_load_dwordx4 v10, s[52:55], s34 offen offset:2048 lds
  v_mul_f32 v252, v252, v26
  v_mfma_f32_16x16x32_bf16 v[124:127], a[4:7], a[244:247], v[124:127]
  v_mul_f32 v253, v253, v27
  s_waitcnt lgkmcnt(10)
  v_mfma_f32_16x16x32_bf16 v[128:131], a[8:11], a[232:235], v[128:131]
  ds_read_b64_tr_b16 a[36:37], v13 offset:0
  v_mul_f32 v254, v254, v28
  v_mfma_f32_16x16x32_bf16 v[132:135], a[8:11], a[236:239], v[132:135]
  ds_read_b64_tr_b16 a[38:39], v13 offset:1024
  v_mul_f32 v255, v255, v29
  v_mfma_f32_16x16x32_bf16 v[136:139], a[8:11], a[240:243], v[136:139]
  buffer_load_dwordx4 a[108:111], v18, s[28:31], s36 offen offset:256 sc1
  v_cvt_pk_bf16_f32 v232, v248, v249
  v_mfma_f32_16x16x32_bf16 v[140:143], a[8:11], a[244:247], v[140:143]
  v_cvt_pk_bf16_f32 v234, v252, v253
  v_cvt_pk_bf16_f32 v233, v250, v251
  v_mfma_f32_16x16x32_bf16 v[144:147], a[12:15], a[232:235], v[144:147]
  ds_read_b64_tr_b16 a[40:41], v14 offset:0
  v_cvt_pk_bf16_f32 v235, v254, v255
  v_mfma_f32_16x16x32_bf16 v[148:151], a[12:15], a[236:239], v[148:151]
  ds_read_b64_tr_b16 a[42:43], v14 offset:1024
  v_mfma_f32_16x16x32_bf16 v[152:155], a[12:15], a[240:243], v[152:155]
  buffer_load_dwordx4 a[112:115], v18, s[28:31], s36 offen offset:1024 sc1
  v_permlane16_swap_b32 v232, v234
  s_nop 0
  v_mfma_f32_16x16x32_bf16 v[156:159], a[12:15], a[244:247], v[156:159]
  v_permlane16_swap_b32 v233, v235
  s_waitcnt vmcnt(18) lgkmcnt(10)
  v_mfma_f32_16x16x32_bf16 v[32:35], a[16:19], a[56:59], v[32:35]
  ds_read_b64_tr_b16 a[44:45], v17 offset:0
  v_mfma_f32_16x16x32_bf16 v[36:39], a[16:19], a[60:63], v[36:39]
  ds_read_b64_tr_b16 a[46:47], v17 offset:1024
  v_mfma_f32_16x16x32_bf16 v[40:43], a[16:19], a[64:67], v[40:43]
  buffer_load_dwordx4 a[116:119], v18, s[28:31], s36 offen offset:1280 sc1
  v_mfma_f32_16x16x32_bf16 v[44:47], a[16:19], a[68:71], v[44:47]
  v_mfma_f32_16x16x32_bf16 v[48:51], a[20:23], a[56:59], v[48:51]
  ds_read_b64_tr_b16 a[48:49], v4 offset:8192
  v_mfma_f32_16x16x32_bf16 v[52:55], a[20:23], a[60:63], v[52:55]
  ds_read_b64_tr_b16 a[50:51], v4 offset:9216
  v_mfma_f32_16x16x32_bf16 v[56:59], a[20:23], a[64:67], v[56:59]
  buffer_load_dwordx4 v11, s[52:55], s34 offen offset:3072 lds
  v_mfma_f32_16x16x32_bf16 v[60:63], a[20:23], a[68:71], v[60:63]
  s_waitcnt lgkmcnt(10)
  v_mfma_f32_16x16x32_bf16 v[64:67], a[24:27], a[56:59], v[64:67]
  ds_read_b64_tr_b16 a[52:53], v5 offset:8192
  v_mfma_f32_16x16x32_bf16 v[68:71], a[24:27], a[60:63], v[68:71]
  ds_read_b64_tr_b16 a[54:55], v5 offset:9216
  v_mfma_f32_16x16x32_bf16 v[72:75], a[24:27], a[64:67], v[72:75]
  buffer_store_dwordx4 v[224:227], v15, s[40:43], s46 offen sc1
  s_add_u32 s46, s46, 16384
  v_mfma_f32_16x16x32_bf16 v[76:79], a[24:27], a[68:71], v[76:79]
  v_mfma_f32_16x16x32_bf16 v[80:83], a[28:31], a[56:59], v[80:83]
  ds_read_b64_tr_b16 a[0:1], v6 offset:8192
  v_mfma_f32_16x16x32_bf16 v[84:87], a[28:31], a[60:63], v[84:87]
  ds_read_b64_tr_b16 a[2:3], v6 offset:9216
  v_mfma_f32_16x16x32_bf16 v[88:91], a[28:31], a[64:67], v[88:91]
  buffer_store_dwordx4 v[232:235], v15, s[40:43], s47 offen sc1
  s_add_u32 s47, s47, 16384
  v_mfma_f32_16x16x32_bf16 v[92:95], a[28:31], a[68:71], v[92:95]
  s_waitcnt lgkmcnt(10)
  v_mfma_f32_16x16x32_bf16 v[96:99], a[32:35], a[56:59], v[96:99]
  ds_read_b64_tr_b16 a[4:5], v7 offset:8192
  v_mfma_f32_16x16x32_bf16 v[100:103], a[32:35], a[60:63], v[100:103]
  ds_read_b64_tr_b16 a[6:7], v7 offset:9216
  s_mov_b32 s36, 32768
  v_mfma_f32_16x16x32_bf16 v[104:107], a[32:35], a[64:67], v[104:107]
  buffer_load_dwordx4 a[120:123], v18, s[28:31], s36 offen offset:0 sc1
  v_mfma_f32_16x16x32_bf16 v[108:111], a[32:35], a[68:71], v[108:111]
  s_add_u32 s34, s32, 98304
  s_add_u32 m0, s33, 131072
  v_mfma_f32_16x16x32_bf16 v[112:115], a[36:39], a[56:59], v[112:115]
  ds_read_b64_tr_b16 a[8:9], v12 offset:8192
  v_mfma_f32_16x16x32_bf16 v[116:119], a[36:39], a[60:63], v[116:119]
  ds_read_b64_tr_b16 a[10:11], v12 offset:9216
  v_mfma_f32_16x16x32_bf16 v[120:123], a[36:39], a[64:67], v[120:123]
  buffer_load_dwordx4 v8, s[52:55], s34 offen offset:0 lds
  v_mfma_f32_16x16x32_bf16 v[124:127], a[36:39], a[68:71], v[124:127]
  s_add_u32 s78, s79, 65536
  s_waitcnt lgkmcnt(10)
  v_mfma_f32_16x16x32_bf16 v[128:131], a[40:43], a[56:59], v[128:131]
  ds_read_b64_tr_b16 a[12:13], v13 offset:8192
  v_mfma_f32_16x16x32_bf16 v[132:135], a[40:43], a[60:63], v[132:135]
  ds_read_b64_tr_b16 a[14:15], v13 offset:9216
  v_mfma_f32_16x16x32_bf16 v[136:139], a[40:43], a[64:67], v[136:139]
  buffer_load_dwordx4 v[160:163], v15, s[20:23], s79 offen offset:0 sc1
  v_mfma_f32_16x16x32_bf16 v[140:143], a[40:43], a[68:71], v[140:143]
  v_mfma_f32_16x16x32_bf16 v[144:147], a[44:47], a[56:59], v[144:147]
  ds_read_b64_tr_b16 a[16:17], v14 offset:8192
  v_mfma_f32_16x16x32_bf16 v[148:151], a[44:47], a[60:63], v[148:151]
  ds_read_b64_tr_b16 a[18:19], v14 offset:9216
  v_mfma_f32_16x16x32_bf16 v[152:155], a[44:47], a[64:67], v[152:155]
  buffer_load_dwordx4 v[164:167], v15, s[20:23], s78 offen offset:0 sc1
  v_mfma_f32_16x16x32_bf16 v[156:159], a[44:47], a[68:71], v[156:159]
  s_waitcnt vmcnt(19) lgkmcnt(10)
  v_mfma_f32_16x16x32_bf16 v[32:35], a[48:51], a[72:75], v[32:35]
  ds_read_b64_tr_b16 a[20:21], v17 offset:8192
  v_mfma_f32_16x16x32_bf16 v[36:39], a[48:51], a[76:79], v[36:39]
  ds_read_b64_tr_b16 a[22:23], v17 offset:9216
  v_mfma_f32_16x16x32_bf16 v[40:43], a[48:51], a[80:83], v[40:43]
  buffer_load_dwordx4 a[124:127], v18, s[28:31], s36 offen offset:256 sc1
  v_mfma_f32_16x16x32_bf16 v[44:47], a[48:51], a[84:87], v[44:47]
  s_waitcnt vmcnt(32)
  s_barrier
  v_mfma_f32_16x16x32_bf16 v[48:51], a[52:55], a[72:75], v[48:51]
  ds_read_b64_tr_b16 a[24:25], v4 offset:16384
  v_mfma_f32_16x16x32_bf16 v[52:55], a[52:55], a[76:79], v[52:55]
  ds_read_b64_tr_b16 a[26:27], v4 offset:17408
  v_mfma_f32_16x16x32_bf16 v[56:59], a[52:55], a[80:83], v[56:59]
  buffer_load_dwordx4 a[128:131], v18, s[28:31], s36 offen offset:1024 sc1
  v_mfma_f32_16x16x32_bf16 v[60:63], a[52:55], a[84:87], v[60:63]
  s_waitcnt lgkmcnt(10)
  v_mfma_f32_16x16x32_bf16 v[64:67], a[0:3], a[72:75], v[64:67]
  ds_read_b64_tr_b16 a[28:29], v5 offset:16384
  v_mfma_f32_16x16x32_bf16 v[68:71], a[0:3], a[76:79], v[68:71]
  ds_read_b64_tr_b16 a[30:31], v5 offset:17408
  v_mfma_f32_16x16x32_bf16 v[72:75], a[0:3], a[80:83], v[72:75]
  buffer_load_dwordx4 v[168:171], v15, s[20:23], s79 offen offset:1024 sc1
  v_mfma_f32_16x16x32_bf16 v[76:79], a[0:3], a[84:87], v[76:79]
  v_mfma_f32_16x16x32_bf16 v[80:83], a[4:7], a[72:75], v[80:83]
  ds_read_b64_tr_b16 a[32:33], v6 offset:16384
  v_mfma_f32_16x16x32_bf16 v[84:87], a[4:7], a[76:79], v[84:87]
  ds_read_b64_tr_b16 a[34:35], v6 offset:17408
  v_mfma_f32_16x16x32_bf16 v[88:91], a[4:7], a[80:83], v[88:91]
  buffer_load_dwordx4 v[172:175], v15, s[20:23], s78 offen offset:1024 sc1
  v_mfma_f32_16x16x32_bf16 v[92:95], a[4:7], a[84:87], v[92:95]
  s_waitcnt lgkmcnt(10)
  v_mfma_f32_16x16x32_bf16 v[96:99], a[8:11], a[72:75], v[96:99]
  ds_read_b64_tr_b16 a[36:37], v7 offset:16384
  v_mfma_f32_16x16x32_bf16 v[100:103], a[8:11], a[76:79], v[100:103]
  ds_read_b64_tr_b16 a[38:39], v7 offset:17408
  v_mfma_f32_16x16x32_bf16 v[104:107], a[8:11], a[80:83], v[104:107]
  buffer_load_dwordx4 a[132:135], v18, s[28:31], s36 offen offset:1280 sc1
  v_mfma_f32_16x16x32_bf16 v[108:111], a[8:11], a[84:87], v[108:111]
  v_mfma_f32_16x16x32_bf16 v[112:115], a[12:15], a[72:75], v[112:115]
  ds_read_b64_tr_b16 a[40:41], v12 offset:16384
  v_mfma_f32_16x16x32_bf16 v[116:119], a[12:15], a[76:79], v[116:119]
  ds_read_b64_tr_b16 a[42:43], v12 offset:17408
  v_mfma_f32_16x16x32_bf16 v[120:123], a[12:15], a[80:83], v[120:123]
  buffer_load_dwordx4 v9, s[52:55], s34 offen offset:1024 lds
  v_mfma_f32_16x16x32_bf16 v[124:127], a[12:15], a[84:87], v[124:127]
  s_mov_b32 s36, 36864
  s_waitcnt lgkmcnt(10)
  v_mfma_f32_16x16x32_bf16 v[128:131], a[16:19], a[72:75], v[128:131]
  ds_read_b64_tr_b16 a[44:45], v13 offset:16384
  v_mfma_f32_16x16x32_bf16 v[132:135], a[16:19], a[76:79], v[132:135]
  ds_read_b64_tr_b16 a[46:47], v13 offset:17408
  v_mfma_f32_16x16x32_bf16 v[136:139], a[16:19], a[80:83], v[136:139]
  buffer_load_dwordx4 a[136:139], v18, s[28:31], s36 offen offset:0 sc1
  v_mfma_f32_16x16x32_bf16 v[140:143], a[16:19], a[84:87], v[140:143]
  s_mov_b32 s98, 65536
  v_mfma_f32_16x16x32_bf16 v[144:147], a[20:23], a[72:75], v[144:147]
  ds_read_b64_tr_b16 a[48:49], v14 offset:16384
  v_mfma_f32_16x16x32_bf16 v[148:151], a[20:23], a[76:79], v[148:151]
  ds_read_b64_tr_b16 a[50:51], v14 offset:17408
  v_mfma_f32_16x16x32_bf16 v[152:155], a[20:23], a[80:83], v[152:155]
  buffer_load_dword v20, v21, s[48:51], s98 offen sc1
  v_mfma_f32_16x16x32_bf16 v[156:159], a[20:23], a[84:87], v[156:159]
  s_waitcnt vmcnt(21) lgkmcnt(10)
  v_mfma_f32_16x16x32_bf16 v[32:35], a[24:27], a[88:91], v[32:35]
  ds_read_b64_tr_b16 a[52:53], v17 offset:16384
  s_waitcnt vmcnt(12)
  v_mfma_f32_16x16x32_bf16 v[36:39], a[24:27], a[92:95], v[36:39]
  ds_read_b64_tr_b16 a[54:55], v17 offset:17408
  v_mfma_f32_16x16x32_bf16 v[40:43], a[24:27], a[96:99], v[40:43]
  buffer_load_dwordx4 v10, s[52:55], s34 offen offset:2048 lds
  v_mfma_f32_16x16x32_bf16 v[44:47], a[24:27], a[100:103], v[44:47]
  v_mfma_f32_16x16x32_bf16 v[48:51], a[28:31], a[88:91], v[48:51]
  ds_read_b64_tr_b16 a[0:1], v4 offset:24576
  v_mfma_f32_16x16x32_bf16 v[52:55], a[28:31], a[92:95], v[52:55]
  ds_read_b64_tr_b16 a[2:3], v4 offset:25600
  v_mfma_f32_16x16x32_bf16 v[56:59], a[28:31], a[96:99], v[56:59]
  buffer_load_dwordx4 a[140:143], v18, s[28:31], s36 offen offset:256 sc1
  v_mfma_f32_16x16x32_bf16 v[60:63], a[28:31], a[100:103], v[60:63]
  s_waitcnt lgkmcnt(10)
  v_mfma_f32_16x16x32_bf16 v[64:67], a[32:35], a[88:91], v[64:67]
  ds_read_b64_tr_b16 a[4:5], v5 offset:24576
  v_mfma_f32_16x16x32_bf16 v[68:71], a[32:35], a[92:95], v[68:71]
  ds_read_b64_tr_b16 a[6:7], v5 offset:25600
  v_mfma_f32_16x16x32_bf16 v[72:75], a[32:35], a[96:99], v[72:75]
  buffer_load_dwordx4 a[144:147], v18, s[28:31], s36 offen offset:1024 sc1
  v_mfma_f32_16x16x32_bf16 v[76:79], a[32:35], a[100:103], v[76:79]
  v_mfma_f32_16x16x32_bf16 v[80:83], a[36:39], a[88:91], v[80:83]
  ds_read_b64_tr_b16 a[8:9], v6 offset:24576
  v_mfma_f32_16x16x32_bf16 v[84:87], a[36:39], a[92:95], v[84:87]
  ds_read_b64_tr_b16 a[10:11], v6 offset:25600
  v_mfma_f32_16x16x32_bf16 v[88:91], a[36:39], a[96:99], v[88:91]
  v_mov_b32 v0, 98304
  v_mov_b32 v1, 1
  s_mov_b64 exec, 1
  buffer_store_dword v1, v0, s[48:51], s77 offen sc1
  s_mov_b64 exec, -1
  v_mfma_f32_16x16x32_bf16 v[92:95], a[36:39], a[100:103], v[92:95]
  s_waitcnt lgkmcnt(10)
  v_mfma_f32_16x16x32_bf16 v[96:99], a[40:43], a[88:91], v[96:99]
  ds_read_b64_tr_b16 a[12:13], v7 offset:24576
  v_mfma_f32_16x16x32_bf16 v[100:103], a[40:43], a[92:95], v[100:103]
  ds_read_b64_tr_b16 a[14:15], v7 offset:25600
  v_mfma_f32_16x16x32_bf16 v[104:107], a[40:43], a[96:99], v[104:107]
  buffer_load_dwordx4 a[148:151], v18, s[28:31], s36 offen offset:1280 sc1
  v_mfma_f32_16x16x32_bf16 v[108:111], a[40:43], a[100:103], v[108:111]
  v_mfma_f32_16x16x32_bf16 v[112:115], a[44:47], a[88:91], v[112:115]
  ds_read_b64_tr_b16 a[16:17], v12 offset:24576
  v_mfma_f32_16x16x32_bf16 v[116:119], a[44:47], a[92:95], v[116:119]
  ds_read_b64_tr_b16 a[18:19], v12 offset:25600
  v_mfma_f32_16x16x32_bf16 v[120:123], a[44:47], a[96:99], v[120:123]
  buffer_load_dwordx4 v11, s[52:55], s34 offen offset:3072 lds
  v_mfma_f32_16x16x32_bf16 v[124:127], a[44:47], a[100:103], v[124:127]
  s_mov_b32 s36, 40960
  s_waitcnt lgkmcnt(10)
  v_mfma_f32_16x16x32_bf16 v[128:131], a[48:51], a[88:91], v[128:131]
  ds_read_b64_tr_b16 a[20:21], v13 offset:24576
  v_mfma_f32_16x16x32_bf16 v[132:135], a[48:51], a[92:95], v[132:135]
  ds_read_b64_tr_b16 a[22:23], v13 offset:25600
  v_mfma_f32_16x16x32_bf16 v[136:139], a[48:51], a[96:99], v[136:139]
  buffer_load_dwordx4 a[152:155], v18, s[28:31], s36 offen offset:0 sc1
  v_mfma_f32_16x16x32_bf16 v[140:143], a[48:51], a[100:103], v[140:143]
  s_add_u32 s34, s32, 1015808
  s_add_u32 m0, s33, 147456
  v_mfma_f32_16x16x32_bf16 v[144:147], a[52:55], a[88:91], v[144:147]
  ds_read_b64_tr_b16 a[24:25], v14 offset:24576
  v_mfma_f32_16x16x32_bf16 v[148:151], a[52:55], a[92:95], v[148:151]
  ds_read_b64_tr_b16 a[26:27], v14 offset:25600
  v_mfma_f32_16x16x32_bf16 v[152:155], a[52:55], a[96:99], v[152:155]
  buffer_load_dwordx4 v8, s[52:55], s34 offen offset:0 lds
  v_mfma_f32_16x16x32_bf16 v[156:159], a[52:55], a[100:103], v[156:159]
  s_waitcnt vmcnt(23) lgkmcnt(10)
  v_mfma_f32_16x16x32_bf16 v[32:35], a[0:3], a[104:107], v[32:35]
  ds_read_b64_tr_b16 a[28:29], v17 offset:24576
  v_mfma_f32_16x16x32_bf16 v[36:39], a[0:3], a[108:111], v[36:39]
  ds_read_b64_tr_b16 a[30:31], v17 offset:25600
  v_mfma_f32_16x16x32_bf16 v[40:43], a[0:3], a[112:115], v[40:43]
  buffer_load_dwordx4 a[156:159], v18, s[28:31], s36 offen offset:256 sc1
  v_mfma_f32_16x16x32_bf16 v[44:47], a[0:3], a[116:119], v[44:47]
  s_waitcnt vmcnt(35)
  s_barrier
  v_mfma_f32_16x16x32_bf16 v[48:51], a[4:7], a[104:107], v[48:51]
  ds_read_b64_tr_b16 a[32:33], v4 offset:32768
  v_mfma_f32_16x16x32_bf16 v[52:55], a[4:7], a[108:111], v[52:55]
  ds_read_b64_tr_b16 a[34:35], v4 offset:33792
  v_mfma_f32_16x16x32_bf16 v[56:59], a[4:7], a[112:115], v[56:59]
  buffer_load_dwordx4 a[160:163], v18, s[28:31], s36 offen offset:1024 sc1
  v_mfma_f32_16x16x32_bf16 v[60:63], a[4:7], a[116:119], v[60:63]
  s_waitcnt lgkmcnt(10)
  v_mfma_f32_16x16x32_bf16 v[64:67], a[8:11], a[104:107], v[64:67]
  ds_read_b64_tr_b16 a[36:37], v5 offset:32768
  v_mfma_f32_16x16x32_bf16 v[68:71], a[8:11], a[108:111], v[68:71]
  ds_read_b64_tr_b16 a[38:39], v5 offset:33792
  v_mfma_f32_16x16x32_bf16 v[72:75], a[8:11], a[112:115], v[72:75]
  buffer_load_dwordx4 a[164:167], v18, s[28:31], s36 offen offset:1280 sc1
  v_mfma_f32_16x16x32_bf16 v[76:79], a[8:11], a[116:119], v[76:79]
  v_mfma_f32_16x16x32_bf16 v[80:83], a[12:15], a[104:107], v[80:83]
  ds_read_b64_tr_b16 a[40:41], v6 offset:32768
  v_mfma_f32_16x16x32_bf16 v[84:87], a[12:15], a[108:111], v[84:87]
  ds_read_b64_tr_b16 a[42:43], v6 offset:33792
  v_mfma_f32_16x16x32_bf16 v[88:91], a[12:15], a[112:115], v[88:91]
  buffer_load_dwordx4 v9, s[52:55], s34 offen offset:1024 lds
  v_mfma_f32_16x16x32_bf16 v[92:95], a[12:15], a[116:119], v[92:95]
  s_waitcnt lgkmcnt(10)
  v_mfma_f32_16x16x32_bf16 v[96:99], a[16:19], a[104:107], v[96:99]
  ds_read_b64_tr_b16 a[44:45], v7 offset:32768
  s_waitcnt vmcnt(12)
  v_mfma_f32_16x16x32_bf16 v[100:103], a[16:19], a[108:111], v[100:103]
  ds_read_b64_tr_b16 a[46:47], v7 offset:33792
  v_mfma_f32_16x16x32_bf16 v[104:107], a[16:19], a[112:115], v[104:107]
  v_cmp_eq_u32 vcc, 0, v20
  s_nop 0
  s_cmp_lg_u64 vcc, 0
  s_cbranch_scc1 L_g2_slow2
L_g2_back2:
  v_mfma_f32_16x16x32_bf16 v[108:111], a[16:19], a[116:119], v[108:111]
  s_mov_b32 s36, 45056
  v_mfma_f32_16x16x32_bf16 v[112:115], a[20:23], a[104:107], v[112:115]
  ds_read_b64_tr_b16 a[48:49], v12 offset:32768
  v_mfma_f32_16x16x32_bf16 v[116:119], a[20:23], a[108:111], v[116:119]
  ds_read_b64_tr_b16 a[50:51], v12 offset:33792
  v_mfma_f32_16x16x32_bf16 v[120:123], a[20:23], a[112:115], v[120:123]
  buffer_load_dwordx4 a[168:171], v18, s[28:31], s36 offen offset:0 sc1
  v_mfma_f32_16x16x32_bf16 v[124:127], a[20:23], a[116:119], v[124:127]
  s_waitcnt lgkmcnt(10)
  v_mfma_f32_16x16x32_bf16 v[128:131], a[24:27], a[104:107], v[128:131]
  ds_read_b64_tr_b16 a[52:53], v13 offset:32768
  v_mfma_f32_16x16x32_bf16 v[132:135], a[24:27], a[108:111], v[132:135]
  ds_read_b64_tr_b16 a[54:55], v13 offset:33792
  v_mfma_f32_16x16x32_bf16 v[136:139], a[24:27], a[112:115], v[136:139]
  buffer_load_dwordx4 v10, s[52:55], s34 offen offset:2048 lds
  v_mfma_f32_16x16x32_bf16 v[140:143], a[24:27], a[116:119], v[140:143]
  v_mfma_f32_16x16x32_bf16 v[144:147], a[28:31], a[104:107], v[144:147]
  ds_read_b64_tr_b16 a[0:1], v14 offset:32768
  v_mfma_f32_16x16x32_bf16 v[148:151], a[28:31], a[108:111], v[148:151]
  ds_read_b64_tr_b16 a[2:3], v14 offset:33792
  v_mfma_f32_16x16x32_bf16 v[152:155], a[28:31], a[112:115], v[152:155]
  buffer_load_dwordx4 a[172:175], v18, s[28:31], s36 offen offset:256 sc1
  v_mfma_f32_16x16x32_bf16 v[156:159], a[28:31], a[116:119], v[156:159]
  buffer_load_dwordx4 a[176:179], v18, s[28:31], s36 offen offset:1024 sc1
  s_waitcnt vmcnt(19) lgkmcnt(10)
  v_mfma_f32_16x16x32_bf16 v[32:35], a[32:35], a[120:123], v[32:35]
  ds_read_b64_tr_b16 a[4:5], v17 offset:32768
  v_mfma_f32_16x16x32_bf16 v[36:39], a[32:35], a[124:127], v[36:39]
  ds_read_b64_tr_b16 a[6:7], v17 offset:33792
  v_mfma_f32_16x16x32_bf16 v[40:43], a[32:35], a[128:131], v[40:43]
  buffer_load_dwordx4 a[180:183], v18, s[28:31], s36 offen offset:1280 sc1
  v_mfma_f32_16x16x32_bf16 v[44:47], a[32:35], a[132:135], v[44:47]
  v_mfma_f32_16x16x32_bf16 v[48:51], a[36:39], a[120:123], v[48:51]
  ds_read_b64_tr_b16 a[8:9], v4 offset:40960
  v_mfma_f32_16x16x32_bf16 v[52:55], a[36:39], a[124:127], v[52:55]
  ds_read_b64_tr_b16 a[10:11], v4 offset:41984
  v_mfma_f32_16x16x32_bf16 v[56:59], a[36:39], a[128:131], v[56:59]
  buffer_load_dwordx4 v11, s[52:55], s34 offen offset:3072 lds
  v_mfma_f32_16x16x32_bf16 v[60:63], a[36:39], a[132:135], v[60:63]
  s_mov_b32 s36, 49152
  s_waitcnt lgkmcnt(10)
  v_mfma_f32_16x16x32_bf16 v[64:67], a[40:43], a[120:123], v[64:67]
  ds_read_b64_tr_b16 a[12:13], v5 offset:40960
  v_mfma_f32_16x16x32_bf16 v[68:71], a[40:43], a[124:127], v[68:71]
  ds_read_b64_tr_b16 a[14:15], v5 offset:41984
  v_mfma_f32_16x16x32_bf16 v[72:75], a[40:43], a[128:131], v[72:75]
  buffer_load_dwordx4 a[184:187], v18, s[28:31], s36 offen offset:0 sc1
  v_mfma_f32_16x16x32_bf16 v[76:79], a[40:43], a[132:135], v[76:79]
  s_add_u32 s34, s32, 131072
  s_add_u32 m0, s33, 65536
  v_mfma_f32_16x16x32_bf16 v[80:83], a[44:47], a[120:123], v[80:83]
  ds_read_b64_tr_b16 a[16:17], v6 offset:40960
  v_mfma_f32_16x16x32_bf16 v[84:87], a[44:47], a[124:127], v[84:87]
  ds_read_b64_tr_b16 a[18:19], v6 offset:41984
  v_mfma_f32_16x16x32_bf16 v[88:91], a[44:47], a[128:131], v[88:91]
  buffer_load_dwordx4 v8, s[52:55], s34 offen offset:0 lds
  v_mfma_f32_16x16x32_bf16 v[92:95], a[44:47], a[132:135], v[92:95]
  s_waitcnt lgkmcnt(10)
  v_mfma_f32_16x16x32_bf16 v[96:99], a[48:51], a[120:123], v[96:99]
  ds_read_b64_tr_b16 a[20:21], v7 offset:40960
  v_mfma_f32_16x16x32_bf16 v[100:103], a[48:51], a[124:127], v[100:103]
  ds_read_b64_tr_b16 a[22:23], v7 offset:41984
  v_mfma_f32_16x16x32_bf16 v[104:107], a[48:51], a[128:131], v[104:107]
  buffer_load_dwordx4 a[188:191], v18, s[28:31], s36 offen offset:256 sc1
  v_mfma_f32_16x16x32_bf16 v[108:111], a[48:51], a[132:135], v[108:111]
  v_mfma_f32_16x16x32_bf16 v[112:115], a[52:55], a[120:123], v[112:115]
  ds_read_b64_tr_b16 a[24:25], v12 offset:40960
  v_mfma_f32_16x16x32_bf16 v[116:119], a[52:55], a[124:127], v[116:119]
  ds_read_b64_tr_b16 a[26:27], v12 offset:41984
  v_mfma_f32_16x16x32_bf16 v[120:123], a[52:55], a[128:131], v[120:123]
  buffer_load_dwordx4 a[192:195], v18, s[28:31], s36 offen offset:1024 sc1
  v_mfma_f32_16x16x32_bf16 v[124:127], a[52:55], a[132:135], v[124:127]
  s_waitcnt lgkmcnt(10)
  v_mfma_f32_16x16x32_bf16 v[128:131], a[0:3], a[120:123], v[128:131]
  ds_read_b64_tr_b16 a[28:29], v13 offset:40960
  v_mfma_f32_16x16x32_bf16 v[132:135], a[0:3], a[124:127], v[132:135]
  ds_read_b64_tr_b16 a[30:31], v13 offset:41984
  v_mfma_f32_16x16x32_bf16 v[136:139], a[0:3], a[128:131], v[136:139]
  buffer_load_dwordx4 a[196:199], v18, s[28:31], s36 offen offset:1280 sc1
  v_mfma_f32_16x16x32_bf16 v[140:143], a[0:3], a[132:135], v[140:143]
  v_mfma_f32_16x16x32_bf16 v[144:147], a[4:7], a[120:123], v[144:147]
  ds_read_b64_tr_b16 a[32:33], v14 offset:40960
  v_mfma_f32_16x16x32_bf16 v[148:151], a[4:7], a[124:127], v[148:151]
  ds_read_b64_tr_b16 a[34:35], v14 offset:41984
  v_mfma_f32_16x16x32_bf16 v[152:155], a[4:7], a[128:131], v[152:155]
  buffer_load_dwordx4 v9, s[52:55], s34 offen offset:1024 lds
  v_mfma_f32_16x16x32_bf16 v[156:159], a[4:7], a[132:135], v[156:159]
  s_waitcnt vmcnt(19) lgkmcnt(10)
  v_mfma_f32_16x16x32_bf16 v[32:35], a[8:11], a[136:139], v[32:35]
  ds_read_b64_tr_b16 a[36:37], v17 offset:40960
  v_mfma_f32_16x16x32_bf16 v[36:39], a[8:11], a[140:143], v[36:39]
  ds_read_b64_tr_b16 a[38:39], v17 offset:41984
  s_mov_b32 s36, 53248
  v_mfma_f32_16x16x32_bf16 v[40:43], a[8:11], a[144:147], v[40:43]
  buffer_load_dwordx4 a[200:203], v18, s[28:31], s36 offen offset:0 sc1
  v_mfma_f32_16x16x32_bf16 v[44:47], a[8:11], a[148:151], v[44:47]
  s_waitcnt vmcnt(39)
  s_barrier
  v_mfma_f32_16x16x32_bf16 v[48:51], a[12:15], a[136:139], v[48:51]
  ds_read_b64_tr_b16 a[40:41], v4 offset:49152
  v_mfma_f32_16x16x32_bf16 v[52:55], a[12:15], a[140:143], v[52:55]
  ds_read_b64_tr_b16 a[42:43], v4 offset:50176
  v_mfma_f32_16x16x32_bf16 v[56:59], a[12:15], a[144:147], v[56:59]
  buffer_load_dwordx4 v10, s[52:55], s34 offen offset:2048 lds
  v_mfma_f32_16x16x32_bf16 v[60:63], a[12:15], a[148:151], v[60:63]
  s_waitcnt lgkmcnt(10)
  v_mfma_f32_16x16x32_bf16 v[64:67], a[16:19], a[136:139], v[64:67]
  ds_read_b64_tr_b16 a[44:45], v5 offset:49152
  v_mfma_f32_16x16x32_bf16 v[68:71], a[16:19], a[140:143], v[68:71]
  ds_read_b64_tr_b16 a[46:47], v5 offset:50176
  v_mfma_f32_16x16x32_bf16 v[72:75], a[16:19], a[144:147], v[72:75]
  buffer_load_dwordx4 a[204:207], v18, s[28:31], s36 offen offset:256 sc1
  v_mfma_f32_16x16x32_bf16 v[76:79], a[16:19], a[148:151], v[76:79]
  v_mfma_f32_16x16x32_bf16 v[80:83], a[20:23], a[136:139], v[80:83]
  ds_read_b64_tr_b16 a[48:49], v6 offset:49152
  v_mfma_f32_16x16x32_bf16 v[84:87], a[20:23], a[140:143], v[84:87]
  ds_read_b64_tr_b16 a[50:51], v6 offset:50176
  v_mfma_f32_16x16x32_bf16 v[88:91], a[20:23], a[144:147], v[88:91]
  buffer_load_dwordx4 a[208:211], v18, s[28:31], s36 offen offset:1024 sc1
  v_mfma_f32_16x16x32_bf16 v[92:95], a[20:23], a[148:151], v[92:95]
  s_waitcnt lgkmcnt(10)
  v_mfma_f32_16x16x32_bf16 v[96:99], a[24:27], a[136:139], v[96:99]
  ds_read_b64_tr_b16 a[52:53], v7 offset:49152
  v_mfma_f32_16x16x32_bf16 v[100:103], a[24:27], a[140:143], v[100:103]
  ds_read_b64_tr_b16 a[54:55], v7 offset:50176
  v_mfma_f32_16x16x32_bf16 v[104:107], a[24:27], a[144:147], v[104:107]
  buffer_load_dwordx4 a[212:215], v18, s[28:31], s36 offen offset:1280 sc1
  v_mfma_f32_16x16x32_bf16 v[108:111], a[24:27], a[148:151], v[108:111]
  v_mfma_f32_16x16x32_bf16 v[112:115], a[28:31], a[136:139], v[112:115]
  ds_read_b64_tr_b16 a[0:1], v12 offset:49152
  v_mfma_f32_16x16x32_bf16 v[116:119], a[28:31], a[140:143], v[116:119]
  ds_read_b64_tr_b16 a[2:3], v12 offset:50176
  v_mfma_f32_16x16x32_bf16 v[120:123], a[28:31], a[144:147], v[120:123]
  buffer_load_dwordx4 v11, s[52:55], s34 offen offset:3072 lds
  v_mfma_f32_16x16x32_bf16 v[124:127], a[28:31], a[148:151], v[124:127]
  s_mov_b32 s36, 57344
  s_waitcnt lgkmcnt(10)
  v_mfma_f32_16x16x32_bf16 v[128:131], a[32:35], a[136:139], v[128:131]
  ds_read_b64_tr_b16 a[4:5], v13 offset:49152
  v_mfma_f32_16x16x32_bf16 v[132:135], a[32:35], a[140:143], v[132:135]
  ds_read_b64_tr_b16 a[6:7], v13 offset:50176
  v_mfma_f32_16x16x32_bf16 v[136:139], a[32:35], a[144:147], v[136:139]
  buffer_load_dwordx4 a[216:219], v18, s[28:31], s36 offen offset:0 sc1
  v_mfma_f32_16x16x32_bf16 v[140:143], a[32:35], a[148:151], v[140:143]
  s_mov_b32 s98, 98304
  v_mfma_f32_16x16x32_bf16 v[144:147], a[36:39], a[136:139], v[144:147]
  ds_read_b64_tr_b16 a[8:9], v14 offset:49152
  v_mfma_f32_16x16x32_bf16 v[148:151], a[36:39], a[140:143], v[148:151]
  ds_read_b64_tr_b16 a[10:11], v14 offset:50176
  v_mfma_f32_16x16x32_bf16 v[152:155], a[36:39], a[144:147], v[152:155]
  buffer_load_dword v20, v21, s[48:51], s98 offen sc1
  v_mfma_f32_16x16x32_bf16 v[156:159], a[36:39], a[148:151], v[156:159]
  s_waitcnt vmcnt(21) lgkmcnt(10)
  v_mfma_f32_16x16x32_bf16 v[32:35], a[40:43], a[152:155], v[32:35]
  ds_read_b64_tr_b16 a[12:13], v17 offset:49152
  v_mfma_f32_16x16x32_bf16 v[36:39], a[40:43], a[156:159], v[36:39]
  ds_read_b64_tr_b16 a[14:15], v17 offset:50176
  s_add_u32 s34, s32, 1048576
  s_add_u32 m0, s33, 81920
  v_mfma_f32_16x16x32_bf16 v[40:43], a[40:43], a[160:163], v[40:43]
  buffer_load_dwordx4 v8, s[52:55], s34 offen offset:0 lds
  v_mfma_f32_16x16x32_bf16 v[44:47], a[40:43], a[164:167], v[44:47]
  v_mfma_f32_16x16x32_bf16 v[48:51], a[44:47], a[152:155], v[48:51]
  ds_read_b64_tr_b16 a[16:17], v4 offset:57344
  v_mfma_f32_16x16x32_bf16 v[52:55], a[44:47], a[156:159], v[52:55]
  ds_read_b64_tr_b16 a[18:19], v4 offset:58368
  v_mfma_f32_16x16x32_bf16 v[56:59], a[44:47], a[160:163], v[56:59]
  buffer_load_dwordx4 a[220:223], v18, s[28:31], s36 offen offset:256 sc1
  v_mfma_f32_16x16x32_bf16 v[60:63], a[44:47], a[164:167], v[60:63]
  s_waitcnt lgkmcnt(10)
  v_mfma_f32_16x16x32_bf16 v[64:67], a[48:51], a[152:155], v[64:67]
  ds_read_b64_tr_b16 a[20:21], v5 offset:57344
  v_mfma_f32_16x16x32_bf16 v[68:71], a[48:51], a[156:159], v[68:71]
  ds_read_b64_tr_b16 a[22:23], v5 offset:58368
  v_mfma_f32_16x16x32_bf16 v[72:75], a[48:51], a[160:163], v[72:75]
  buffer_load_dwordx4 a[224:227], v18, s[28:31], s36 offen offset:1024 sc1
  v_mfma_f32_16x16x32_bf16 v[76:79], a[48:51], a[164:167], v[76:79]
  v_mfma_f32_16x16x32_bf16 v[80:83], a[52:55], a[152:155], v[80:83]
  ds_read_b64_tr_b16 a[24:25], v6 offset:57344
  v_mfma_f32_16x16x32_bf16 v[84:87], a[52:55], a[156:159], v[84:87]
  ds_read_b64_tr_b16 a[26:27], v6 offset:58368
  v_mfma_f32_16x16x32_bf16 v[88:91], a[52:55], a[160:163], v[88:91]
  buffer_load_dwordx4 a[228:231], v18, s[28:31], s36 offen offset:1280 sc1
  v_mfma_f32_16x16x32_bf16 v[92:95], a[52:55], a[164:167], v[92:95]
  s_waitcnt lgkmcnt(10)
  v_mfma_f32_16x16x32_bf16 v[96:99], a[0:3], a[152:155], v[96:99]
  ds_read_b64_tr_b16 a[28:29], v7 offset:57344
  v_mfma_f32_16x16x32_bf16 v[100:103], a[0:3], a[156:159], v[100:103]
  ds_read_b64_tr_b16 a[30:31], v7 offset:58368
  v_mfma_f32_16x16x32_bf16 v[104:107], a[0:3], a[160:163], v[104:107]
  buffer_load_dwordx4 v9, s[52:55], s34 offen offset:1024 lds
  v_mfma_f32_16x16x32_bf16 v[108:111], a[0:3], a[164:167], v[108:111]
  s_mov_b32 s36, 61440
  v_mfma_f32_16x16x32_bf16 v[112:115], a[4:7], a[152:155], v[112:115]
  ds_read_b64_tr_b16 a[32:33], v12 offset:57344
  v_mfma_f32_16x16x32_bf16 v[116:119], a[4:7], a[156:159], v[116:119]
  ds_read_b64_tr_b16 a[34:35], v12 offset:58368
  v_mfma_f32_16x16x32_bf16 v[120:123], a[4:7], a[160:163], v[120:123]
  buffer_load_dwordx4 a[232:235], v18, s[28:31], s36 offen offset:0 sc1
  v_mfma_f32_16x16x32_bf16 v[124:127], a[4:7], a[164:167], v[124:127]
  s_waitcnt lgkmcnt(10)
  v_mfma_f32_16x16x32_bf16 v[128:131], a[8:11], a[152:155], v[128:131]
  ds_read_b64_tr_b16 a[36:37], v13 offset:57344
  v_mfma_f32_16x16x32_bf16 v[132:135], a[8:11], a[156:159], v[132:135]
  ds_read_b64_tr_b16 a[38:39], v13 offset:58368
  v_mfma_f32_16x16x32_bf16 v[136:139], a[8:11], a[160:163], v[136:139]
  buffer_load_dwordx4 v10, s[52:55], s34 offen offset:2048 lds
  v_mfma_f32_16x16x32_bf16 v[140:143], a[8:11], a[164:167], v[140:143]
  v_mfma_f32_16x16x32_bf16 v[144:147], a[12:15], a[152:155], v[144:147]
  ds_read_b64_tr_b16 a[40:41], v14 offset:57344
  v_mfma_f32_16x16x32_bf16 v[148:151], a[12:15], a[156:159], v[148:151]
  ds_read_b64_tr_b16 a[42:43], v14 offset:58368
  v_mfma_f32_16x16x32_bf16 v[152:155], a[12:15], a[160:163], v[152:155]
  buffer_load_dwordx4 a[236:239], v18, s[28:31], s36 offen offset:256 sc1
  v_mfma_f32_16x16x32_bf16 v[156:159], a[12:15], a[164:167], v[156:159]
  s_waitcnt vmcnt(23) lgkmcnt(10)
  v_mfma_f32_16x16x32_bf16 v[32:35], a[16:19], a[168:171], v[32:35]
  ds_read_b64_tr_b16 a[44:45], v17 offset:57344
  v_mfma_f32_16x16x32_bf16 v[36:39], a[16:19], a[172:175], v[36:39]
  ds_read_b64_tr_b16 a[46:47], v17 offset:58368
  v_mfma_f32_16x16x32_bf16 v[40:43], a[16:19], a[176:179], v[40:43]
  buffer_load_dwordx4 a[240:243], v18, s[28:31], s36 offen offset:1024 sc1
  v_mfma_f32_16x16x32_bf16 v[44:47], a[16:19], a[180:183], v[44:47]
  s_waitcnt vmcnt(35)
  s_barrier
  v_add_u32 v4, 131072, v16
  v_xor_b32 v5, 32, v4
  v_xor_b32 v6, 64, v4
  v_xor_b32 v7, 96, v4
  v_xor_b32 v12, 128, v4
  v_xor_b32 v13, 160, v4
  v_xor_b32 v14, 192, v4
  v_xor_b32 v17, 224, v4
  v_mfma_f32_16x16x32_bf16 v[48:51], a[20:23], a[168:171], v[48:51]
  ds_read_b64_tr_b16 a[48:49], v4 offset:0
  v_mfma_f32_16x16x32_bf16 v[52:55], a[20:23], a[172:175], v[52:55]
  ds_read_b64_tr_b16 a[50:51], v4 offset:1024
  v_mfma_f32_16x16x32_bf16 v[56:59], a[20:23], a[176:179], v[56:59]
  buffer_load_dwordx4 a[244:247], v18, s[28:31], s36 offen offset:1280 sc1
  v_mfma_f32_16x16x32_bf16 v[60:63], a[20:23], a[180:183], v[60:63]
  s_waitcnt lgkmcnt(10)
  v_mfma_f32_16x16x32_bf16 v[64:67], a[24:27], a[168:171], v[64:67]
  ds_read_b64_tr_b16 a[52:53], v5 offset:0
  v_mfma_f32_16x16x32_bf16 v[68:71], a[24:27], a[172:175], v[68:71]
  ds_read_b64_tr_b16 a[54:55], v5 offset:1024
  v_mfma_f32_16x16x32_bf16 v[72:75], a[24:27], a[176:179], v[72:75]
  buffer_load_dwordx4 v11, s[52:55], s34 offen offset:3072 lds
  v_mfma_f32_16x16x32_bf16 v[76:79], a[24:27], a[180:183], v[76:79]
  s_mov_b32 s36, 65536
  v_mfma_f32_16x16x32_bf16 v[80:83], a[28:31], a[168:171], v[80:83]
  ds_read_b64_tr_b16 a[0:1], v6 offset:0
  v_mfma_f32_16x16x32_bf16 v[84:87], a[28:31], a[172:175], v[84:87]
  ds_read_b64_tr_b16 a[2:3], v6 offset:1024
  v_mfma_f32_16x16x32_bf16 v[88:91], a[28:31], a[176:179], v[88:91]
  buffer_load_dwordx4 a[56:59], v18, s[28:31], s36 offen offset:0 sc1
  v_mfma_f32_16x16x32_bf16 v[92:95], a[28:31], a[180:183], v[92:95]
  s_waitcnt lgkmcnt(10)
  v_mfma_f32_16x16x32_bf16 v[96:99], a[32:35], a[168:171], v[96:99]
  ds_read_b64_tr_b16 a[4:5], v7 offset:0
  s_waitcnt vmcnt(12)
  v_mfma_f32_16x16x32_bf16 v[100:103], a[32:35], a[172:175], v[100:103]
  ds_read_b64_tr_b16 a[6:7], v7 offset:1024
  v_mfma_f32_16x16x32_bf16 v[104:107], a[32:35], a[176:179], v[104:107]
  v_cmp_eq_u32 vcc, 0, v20
  s_nop 0
  s_cmp_lg_u64 vcc, 0
  s_cbranch_scc1 L_g2_slow3
L_g2_back3:
  v_mfma_f32_16x16x32_bf16 v[108:111], a[32:35], a[180:183], v[108:111]
  s_add_u32 s34, s32, 163840
  s_add_u32 m0, s33, 0
  v_mfma_f32_16x16x32_bf16 v[112:115], a[36:39], a[168:171], v[112:115]
  ds_read_b64_tr_b16 a[8:9], v12 offset:0
  v_mfma_f32_16x16x32_bf16 v[116:119], a[36:39], a[172:175], v[116:119]
  ds_read_b64_tr_b16 a[10:11], v12 offset:1024
  v_mfma_f32_16x16x32_bf16 v[120:123], a[36:39], a[176:179], v[120:123]
  buffer_load_dwordx4 v8, s[52:55], s34 offen offset:0 lds
  v_mfma_f32_16x16x32_bf16 v[124:127], a[36:39], a[180:183], v[124:127]
  s_waitcnt lgkmcnt(10)
  v_mfma_f32_16x16x32_bf16 v[128:131], a[40:43], a[168:171], v[128:131]
  ds_read_b64_tr_b16 a[12:13], v13 offset:0
  v_mfma_f32_16x16x32_bf16 v[132:135], a[40:43], a[172:175], v[132:135]
  ds_read_b64_tr_b16 a[14:15], v13 offset:1024
  v_mfma_f32_16x16x32_bf16 v[136:139], a[40:43], a[176:179], v[136:139]
  buffer_load_dwordx4 a[60:63], v18, s[28:31], s36 offen offset:256 sc1
  v_mfma_f32_16x16x32_bf16 v[140:143], a[40:43], a[180:183], v[140:143]
  v_mfma_f32_16x16x32_bf16 v[144:147], a[44:47], a[168:171], v[144:147]
  ds_read_b64_tr_b16 a[16:17], v14 offset:0
  v_mfma_f32_16x16x32_bf16 v[148:151], a[44:47], a[172:175], v[148:151]
  ds_read_b64_tr_b16 a[18:19], v14 offset:1024
  v_mfma_f32_16x16x32_bf16 v[152:155], a[44:47], a[176:179], v[152:155]
  buffer_load_dwordx4 a[64:67], v18, s[28:31], s36 offen offset:1024 sc1
  v_mfma_f32_16x16x32_bf16 v[156:159], a[44:47], a[180:183], v[156:159]
  buffer_load_dwordx4 a[68:71], v18, s[28:31], s36 offen offset:1280 sc1
  s_waitcnt vmcnt(25) lgkmcnt(10)
  v_mfma_f32_16x16x32_bf16 v[32:35], a[48:51], a[184:187], v[32:35]
  ds_read_b64_tr_b16 a[20:21], v17 offset:0
  v_mfma_f32_16x16x32_bf16 v[36:39], a[48:51], a[188:191], v[36:39]
  ds_read_b64_tr_b16 a[22:23], v17 offset:1024
  v_mfma_f32_16x16x32_bf16 v[40:43], a[48:51], a[192:195], v[40:43]
  buffer_load_dwordx4 v9, s[52:55], s34 offen offset:1024 lds
  v_mfma_f32_16x16x32_bf16 v[44:47], a[48:51], a[196:199], v[44:47]
  s_mov_b32 s36, 69632
  v_mfma_f32_16x16x32_bf16 v[48:51], a[52:55], a[184:187], v[48:51]
  ds_read_b64_tr_b16 a[24:25], v4 offset:8192
  v_mfma_f32_16x16x32_bf16 v[52:55], a[52:55], a[188:191], v[52:55]
  ds_read_b64_tr_b16 a[26:27], v4 offset:9216
  v_mfma_f32_16x16x32_bf16 v[56:59], a[52:55], a[192:195], v[56:59]
  buffer_load_dwordx4 a[72:75], v18, s[28:31], s36 offen offset:0 sc1
  v_mfma_f32_16x16x32_bf16 v[60:63], a[52:55], a[196:199], v[60:63]
  s_waitcnt lgkmcnt(10)
  v_mfma_f32_16x16x32_bf16 v[64:67], a[0:3], a[184:187], v[64:67]
  ds_read_b64_tr_b16 a[28:29], v5 offset:8192
  v_mfma_f32_16x16x32_bf16 v[68:71], a[0:3], a[188:191], v[68:71]
  ds_read_b64_tr_b16 a[30:31], v5 offset:9216
  v_mfma_f32_16x16x32_bf16 v[72:75], a[0:3], a[192:195], v[72:75]
  buffer_load_dwordx4 v10, s[52:55], s34 offen offset:2048 lds
  v_mfma_f32_16x16x32_bf16 v[76:79], a[0:3], a[196:199], v[76:79]
  v_mfma_f32_16x16x32_bf16 v[80:83], a[4:7], a[184:187], v[80:83]
  ds_read_b64_tr_b16 a[32:33], v6 offset:8192
  v_mfma_f32_16x16x32_bf16 v[84:87], a[4:7], a[188:191], v[84:87]
  ds_read_b64_tr_b16 a[34:35], v6 offset:9216
  v_mfma_f32_16x16x32_bf16 v[88:91], a[4:7], a[192:195], v[88:91]
  buffer_load_dwordx4 a[76:79], v18, s[28:31], s36 offen offset:256 sc1
  v_mfma_f32_16x16x32_bf16 v[92:95], a[4:7], a[196:199], v[92:95]
  s_waitcnt lgkmcnt(10)
  v_mfma_f32_16x16x32_bf16 v[96:99], a[8:11], a[184:187], v[96:99]
  ds_read_b64_tr_b16 a[36:37], v7 offset:8192
  v_mfma_f32_16x16x32_bf16 v[100:103], a[8:11], a[188:191], v[100:103]
  ds_read_b64_tr_b16 a[38:39], v7 offset:9216
  v_mfma_f32_16x16x32_bf16 v[104:107], a[8:11], a[192:195], v[104:107]
  buffer_load_dwordx4 a[80:83], v18, s[28:31], s36 offen offset:1024 sc1
  v_mfma_f32_16x16x32_bf16 v[108:111], a[8:11], a[196:199], v[108:111]
  v_mfma_f32_16x16x32_bf16 v[112:115], a[12:15], a[184:187], v[112:115]
  ds_read_b64_tr_b16 a[40:41], v12 offset:8192
  v_mfma_f32_16x16x32_bf16 v[116:119], a[12:15], a[188:191], v[116:119]
  ds_read_b64_tr_b16 a[42:43], v12 offset:9216
  v_mfma_f32_16x16x32_bf16 v[120:123], a[12:15], a[192:195], v[120:123]
  buffer_load_dwordx4 a[84:87], v18, s[28:31], s36 offen offset:1280 sc1
  v_mfma_f32_16x16x32_bf16 v[124:127], a[12:15], a[196:199], v[124:127]
  s_waitcnt lgkmcnt(10)
  v_mfma_f32_16x16x32_bf16 v[128:131], a[16:19], a[184:187], v[128:131]
  ds_read_b64_tr_b16 a[44:45], v13 offset:8192
  v_mfma_f32_16x16x32_bf16 v[132:135], a[16:19], a[188:191], v[132:135]
  ds_read_b64_tr_b16 a[46:47], v13 offset:9216
  v_mfma_f32_16x16x32_bf16 v[136:139], a[16:19], a[192:195], v[136:139]
  buffer_load_dwordx4 v11, s[52:55], s34 offen offset:3072 lds
  v_mfma_f32_16x16x32_bf16 v[140:143], a[16:19], a[196:199], v[140:143]
  s_mov_b32 s36, 73728
  v_mfma_f32_16x16x32_bf16 v[144:147], a[20:23], a[184:187], v[144:147]
  ds_read_b64_tr_b16 a[48:49], v14 offset:8192
  v_mfma_f32_16x16x32_bf16 v[148:151], a[20:23], a[188:191], v[148:151]
  ds_read_b64_tr_b16 a[50:51], v14 offset:9216
  v_mfma_f32_16x16x32_bf16 v[152:155], a[20:23], a[192:195], v[152:155]
  buffer_load_dwordx4 a[88:91], v18, s[28:31], s36 offen offset:0 sc1
  v_mfma_f32_16x16x32_bf16 v[156:159], a[20:23], a[196:199], v[156:159]
  s_waitcnt vmcnt(27) lgkmcnt(10)
  v_mfma_f32_16x16x32_bf16 v[32:35], a[24:27], a[200:203], v[32:35]
  ds_read_b64_tr_b16 a[52:53], v17 offset:8192
  v_mfma_f32_16x16x32_bf16 v[36:39], a[24:27], a[204:207], v[36:39]
  ds_read_b64_tr_b16 a[54:55], v17 offset:9216
  s_add_u32 s34, s32, 1081344
  s_add_u32 m0, s33, 16384
  v_mfma_f32_16x16x32_bf16 v[40:43], a[24:27], a[208:211], v[40:43]
  buffer_load_dwordx4 v8, s[52:55], s34 offen offset:0 lds
  v_mfma_f32_16x16x32_bf16 v[44:47], a[24:27], a[212:215], v[44:47]
  s_waitcnt vmcnt(39)
  s_barrier
  v_mfma_f32_16x16x32_bf16 v[48:51], a[28:31], a[200:203], v[48:51]
  ds_read_b64_tr_b16 a[0:1], v4 offset:16384
  v_mfma_f32_16x16x32_bf16 v[52:55], a[28:31], a[204:207], v[52:55]
  ds_read_b64_tr_b16 a[2:3], v4 offset:17408
  v_mfma_f32_16x16x32_bf16 v[56:59], a[28:31], a[208:211], v[56:59]
  buffer_load_dwordx4 a[92:95], v18, s[28:31], s36 offen offset:256 sc1
  v_mfma_f32_16x16x32_bf16 v[60:63], a[28:31], a[212:215], v[60:63]
  s_waitcnt lgkmcnt(10)
  v_mfma_f32_16x16x32_bf16 v[64:67], a[32:35], a[200:203], v[64:67]
  ds_read_b64_tr_b16 a[4:5], v5 offset:16384
  v_mfma_f32_16x16x32_bf16 v[68:71], a[32:35], a[204:207], v[68:71]
  ds_read_b64_tr_b16 a[6:7], v5 offset:17408
  v_mfma_f32_16x16x32_bf16 v[72:75], a[32:35], a[208:211], v[72:75]
  buffer_load_dwordx4 a[96:99], v18, s[28:31], s36 offen offset:1024 sc1
  v_mfma_f32_16x16x32_bf16 v[76:79], a[32:35], a[212:215], v[76:79]
  v_mfma_f32_16x16x32_bf16 v[80:83], a[36:39], a[200:203], v[80:83]
  ds_read_b64_tr_b16 a[8:9], v6 offset:16384
  v_mfma_f32_16x16x32_bf16 v[84:87], a[36:39], a[204:207], v[84:87]
  ds_read_b64_tr_b16 a[10:11], v6 offset:17408
  v_mfma_f32_16x16x32_bf16 v[88:91], a[36:39], a[208:211], v[88:91]
  buffer_load_dwordx4 a[100:103], v18, s[28:31], s36 offen offset:1280 sc1
  v_mfma_f32_16x16x32_bf16 v[92:95], a[36:39], a[212:215], v[92:95]
  s_waitcnt lgkmcnt(10)
  v_mfma_f32_16x16x32_bf16 v[96:99], a[40:43], a[200:203], v[96:99]
  ds_read_b64_tr_b16 a[12:13], v7 offset:16384
  v_mfma_f32_16x16x32_bf16 v[100:103], a[40:43], a[204:207], v[100:103]
  ds_read_b64_tr_b16 a[14:15], v7 offset:17408
  v_mfma_f32_16x16x32_bf16 v[104:107], a[40:43], a[208:211], v[104:107]
  buffer_load_dwordx4 v9, s[52:55], s34 offen offset:1024 lds
  v_mfma_f32_16x16x32_bf16 v[108:111], a[40:43], a[212:215], v[108:111]
  s_mov_b32 s36, 77824
  v_mfma_f32_16x16x32_bf16 v[112:115], a[44:47], a[200:203], v[112:115]
  ds_read_b64_tr_b16 a[16:17], v12 offset:16384
  v_mfma_f32_16x16x32_bf16 v[116:119], a[44:47], a[204:207], v[116:119]
  ds_read_b64_tr_b16 a[18:19], v12 offset:17408
  v_mfma_f32_16x16x32_bf16 v[120:123], a[44:47], a[208:211], v[120:123]
  buffer_load_dwordx4 a[104:107], v18, s[28:31], s36 offen offset:0 sc1
  v_mfma_f32_16x16x32_bf16 v[124:127], a[44:47], a[212:215], v[124:127]
  s_waitcnt lgkmcnt(10)
  v_mfma_f32_16x16x32_bf16 v[128:131], a[48:51], a[200:203], v[128:131]
  ds_read_b64_tr_b16 a[20:21], v13 offset:16384
  v_mfma_f32_16x16x32_bf16 v[132:135], a[48:51], a[204:207], v[132:135]
  ds_read_b64_tr_b16 a[22:23], v13 offset:17408
  v_mfma_f32_16x16x32_bf16 v[136:139], a[48:51], a[208:211], v[136:139]
  buffer_load_dwordx4 v10, s[52:55], s34 offen offset:2048 lds
  v_mfma_f32_16x16x32_bf16 v[140:143], a[48:51], a[212:215], v[140:143]
  v_mfma_f32_16x16x32_bf16 v[144:147], a[52:55], a[200:203], v[144:147]
  ds_read_b64_tr_b16 a[24:25], v14 offset:16384
  v_mfma_f32_16x16x32_bf16 v[148:151], a[52:55], a[204:207], v[148:151]
  ds_read_b64_tr_b16 a[26:27], v14 offset:17408
  v_mfma_f32_16x16x32_bf16 v[152:155], a[52:55], a[208:211], v[152:155]
  v_mfma_f32_16x16x32_bf16 v[156:159], a[52:55], a[212:215], v[156:159]
  s_waitcnt vmcnt(27) lgkmcnt(10)
  v_mfma_f32_16x16x32_bf16 v[32:35], a[0:3], a[216:219], v[32:35]
  ds_read_b64_tr_b16 a[28:29], v17 offset:16384
  v_mfma_f32_16x16x32_bf16 v[36:39], a[0:3], a[220:223], v[36:39]
  ds_read_b64_tr_b16 a[30:31], v17 offset:17408
  v_mfma_f32_16x16x32_bf16 v[40:43], a[0:3], a[224:227], v[40:43]
  buffer_load_dwordx4 a[108:111], v18, s[28:31], s36 offen offset:256 sc1
  v_mfma_f32_16x16x32_bf16 v[44:47], a[0:3], a[228:231], v[44:47]
  v_mfma_f32_16x16x32_bf16 v[48:51], a[4:7], a[216:219], v[48:51]
  ds_read_b64_tr_b16 a[32:33], v4 offset:24576
  v_mfma_f32_16x16x32_bf16 v[52:55], a[4:7], a[220:223], v[52:55]
  ds_read_b64_tr_b16 a[34:35], v4 offset:25600
  v_mfma_f32_16x16x32_bf16 v[56:59], a[4:7], a[224:227], v[56:59]
  buffer_load_dwordx4 a[112:115], v18, s[28:31], s36 offen offset:1024 sc1
  v_mfma_f32_16x16x32_bf16 v[60:63], a[4:7], a[228:231], v[60:63]
  s_waitcnt lgkmcnt(10)
  v_mfma_f32_16x16x32_bf16 v[64:67], a[8:11], a[216:219], v[64:67]
  ds_read_b64_tr_b16 a[36:37], v5 offset:24576
  v_mfma_f32_16x16x32_bf16 v[68:71], a[8:11], a[220:223], v[68:71]
  ds_read_b64_tr_b16 a[38:39], v5 offset:25600
  v_mfma_f32_16x16x32_bf16 v[72:75], a[8:11], a[224:227], v[72:75]
  buffer_load_dwordx4 a[116:119], v18, s[28:31], s36 offen offset:1280 sc1
  v_mfma_f32_16x16x32_bf16 v[76:79], a[8:11], a[228:231], v[76:79]
  v_mfma_f32_16x16x32_bf16 v[80:83], a[12:15], a[216:219], v[80:83]
  ds_read_b64_tr_b16 a[40:41], v6 offset:24576
  v_mfma_f32_16x16x32_bf16 v[84:87], a[12:15], a[220:223], v[84:87]
  ds_read_b64_tr_b16 a[42:43], v6 offset:25600
  v_mfma_f32_16x16x32_bf16 v[88:91], a[12:15], a[224:227], v[88:91]
  v_mfma_f32_16x16x32_bf16 v[92:95], a[12:15], a[228:231], v[92:95]
  s_waitcnt lgkmcnt(10)
  v_mfma_f32_16x16x32_bf16 v[96:99], a[16:19], a[216:219], v[96:99]
  ds_read_b64_tr_b16 a[44:45], v7 offset:24576
  v_mfma_f32_16x16x32_bf16 v[100:103], a[16:19], a[220:223], v[100:103]
  ds_read_b64_tr_b16 a[46:47], v7 offset:25600
  v_mfma_f32_16x16x32_bf16 v[104:107], a[16:19], a[224:227], v[104:107]
  buffer_load_dwordx4 v11, s[52:55], s34 offen offset:3072 lds
  v_mfma_f32_16x16x32_bf16 v[108:111], a[16:19], a[228:231], v[108:111]
  s_mov_b32 s36, 81920
  v_mfma_f32_16x16x32_bf16 v[112:115], a[20:23], a[216:219], v[112:115]
  ds_read_b64_tr_b16 a[48:49], v12 offset:24576
  v_mfma_f32_16x16x32_bf16 v[116:119], a[20:23], a[220:223], v[116:119]
  ds_read_b64_tr_b16 a[50:51], v12 offset:25600
  v_mfma_f32_16x16x32_bf16 v[120:123], a[20:23], a[224:227], v[120:123]
  buffer_load_dwordx4 a[120:123], v18, s[28:31], s36 offen offset:0 sc1
  v_mfma_f32_16x16x32_bf16 v[124:127], a[20:23], a[228:231], v[124:127]
  s_add_u32 s34, s32, 196608
  s_add_u32 m0, s33, 32768
  s_waitcnt lgkmcnt(10)
  v_mfma_f32_16x16x32_bf16 v[128:131], a[24:27], a[216:219], v[128:131]
  ds_read_b64_tr_b16 a[52:53], v13 offset:24576
  v_mfma_f32_16x16x32_bf16 v[132:135], a[24:27], a[220:223], v[132:135]
  ds_read_b64_tr_b16 a[54:55], v13 offset:25600
  v_mfma_f32_16x16x32_bf16 v[136:139], a[24:27], a[224:227], v[136:139]
  buffer_load_dwordx4 v8, s[52:55], s34 offen offset:0 lds
  v_mfma_f32_16x16x32_bf16 v[140:143], a[24:27], a[228:231], v[140:143]
  v_mfma_f32_16x16x32_bf16 v[144:147], a[28:31], a[216:219], v[144:147]
  ds_read_b64_tr_b16 a[0:1], v14 offset:24576
  v_mfma_f32_16x16x32_bf16 v[148:151], a[28:31], a[220:223], v[148:151]
  ds_read_b64_tr_b16 a[2:3], v14 offset:25600
  v_mfma_f32_16x16x32_bf16 v[152:155], a[28:31], a[224:227], v[152:155]
  v_mfma_f32_16x16x32_bf16 v[156:159], a[28:31], a[228:231], v[156:159]
  s_waitcnt vmcnt(27) lgkmcnt(10)
  v_mfma_f32_16x16x32_bf16 v[32:35], a[32:35], a[232:235], v[32:35]
  ds_read_b64_tr_b16 a[4:5], v17 offset:24576
  v_mfma_f32_16x16x32_bf16 v[36:39], a[32:35], a[236:239], v[36:39]
  ds_read_b64_tr_b16 a[6:7], v17 offset:25600
  v_mfma_f32_16x16x32_bf16 v[40:43], a[32:35], a[240:243], v[40:43]
  buffer_load_dwordx4 a[124:127], v18, s[28:31], s36 offen offset:256 sc1
  v_mfma_f32_16x16x32_bf16 v[44:47], a[32:35], a[244:247], v[44:47]
  s_waitcnt vmcnt(40)
  s_barrier
  v_add_u32 v4, 65536, v16
  v_xor_b32 v5, 32, v4
  v_xor_b32 v6, 64, v4
  v_xor_b32 v7, 96, v4
  v_xor_b32 v12, 128, v4
  v_xor_b32 v13, 160, v4
  v_xor_b32 v14, 192, v4
  v_xor_b32 v17, 224, v4
  v_mfma_f32_16x16x32_bf16 v[48:51], a[36:39], a[232:235], v[48:51]
  ds_read_b64_tr_b16 a[8:9], v4 offset:0
  v_mfma_f32_16x16x32_bf16 v[52:55], a[36:39], a[236:239], v[52:55]
  ds_read_b64_tr_b16 a[10:11], v4 offset:1024
  v_mfma_f32_16x16x32_bf16 v[56:59], a[36:39], a[240:243], v[56:59]
  buffer_load_dwordx4 a[128:131], v18, s[28:31], s36 offen offset:1024 sc1
  v_mfma_f32_16x16x32_bf16 v[60:63], a[36:39], a[244:247], v[60:63]
  s_waitcnt lgkmcnt(10)
  v_mfma_f32_16x16x32_bf16 v[64:67], a[40:43], a[232:235], v[64:67]
  ds_read_b64_tr_b16 a[12:13], v5 offset:0
  v_mfma_f32_16x16x32_bf16 v[68:71], a[40:43], a[236:239], v[68:71]
  ds_read_b64_tr_b16 a[14:15], v5 offset:1024
  v_mfma_f32_16x16x32_bf16 v[72:75], a[40:43], a[240:243], v[72:75]
  buffer_load_dwordx4 a[132:135], v18, s[28:31], s36 offen offset:1280 sc1
  v_mfma_f32_16x16x32_bf16 v[76:79], a[40:43], a[244:247], v[76:79]
  v_mfma_f32_16x16x32_bf16 v[80:83], a[44:47], a[232:235], v[80:83]
  ds_read_b64_tr_b16 a[16:17], v6 offset:0
  v_mfma_f32_16x16x32_bf16 v[84:87], a[44:47], a[236:239], v[84:87]
  ds_read_b64_tr_b16 a[18:19], v6 offset:1024
  v_mfma_f32_16x16x32_bf16 v[88:91], a[44:47], a[240:243], v[88:91]
  v_mfma_f32_16x16x32_bf16 v[92:95], a[44:47], a[244:247], v[92:95]
  s_waitcnt lgkmcnt(10)
  v_mfma_f32_16x16x32_bf16 v[96:99], a[48:51], a[232:235], v[96:99]
  ds_read_b64_tr_b16 a[20:21], v7 offset:0
  v_mfma_f32_16x16x32_bf16 v[100:103], a[48:51], a[236:239], v[100:103]
  ds_read_b64_tr_b16 a[22:23], v7 offset:1024
  v_mfma_f32_16x16x32_bf16 v[104:107], a[48:51], a[240:243], v[104:107]
  buffer_load_dwordx4 v9, s[52:55], s34 offen offset:1024 lds
  v_mfma_f32_16x16x32_bf16 v[108:111], a[48:51], a[244:247], v[108:111]
  s_mov_b32 s36, 86016
  v_mfma_f32_16x16x32_bf16 v[112:115], a[52:55], a[232:235], v[112:115]
  ds_read_b64_tr_b16 a[24:25], v12 offset:0
  v_mfma_f32_16x16x32_bf16 v[116:119], a[52:55], a[236:239], v[116:119]
  ds_read_b64_tr_b16 a[26:27], v12 offset:1024
  v_mfma_f32_16x16x32_bf16 v[120:123], a[52:55], a[240:243], v[120:123]
  buffer_load_dwordx4 a[136:139], v18, s[28:31], s36 offen offset:0 sc1
  v_mfma_f32_16x16x32_bf16 v[124:127], a[52:55], a[244:247], v[124:127]
  s_waitcnt lgkmcnt(10)
  v_mfma_f32_16x16x32_bf16 v[128:131], a[0:3], a[232:235], v[128:131]
  ds_read_b64_tr_b16 a[28:29], v13 offset:0
  v_mfma_f32_16x16x32_bf16 v[132:135], a[0:3], a[236:239], v[132:135]
  ds_read_b64_tr_b16 a[30:31], v13 offset:1024
  v_mfma_f32_16x16x32_bf16 v[136:139], a[0:3], a[240:243], v[136:139]
  buffer_load_dwordx4 v10, s[52:55], s34 offen offset:2048 lds
  v_mfma_f32_16x16x32_bf16 v[140:143], a[0:3], a[244:247], v[140:143]
  v_mfma_f32_16x16x32_bf16 v[144:147], a[4:7], a[232:235], v[144:147]
  ds_read_b64_tr_b16 a[32:33], v14 offset:0
  v_mfma_f32_16x16x32_bf16 v[148:151], a[4:7], a[236:239], v[148:151]
  ds_read_b64_tr_b16 a[34:35], v14 offset:1024
  v_mfma_f32_16x16x32_bf16 v[152:155], a[4:7], a[240:243], v[152:155]
  v_mfma_f32_16x16x32_bf16 v[156:159], a[4:7], a[244:247], v[156:159]
  s_waitcnt vmcnt(27) lgkmcnt(10)
  v_mfma_f32_16x16x32_bf16 v[32:35], a[8:11], a[56:59], v[32:35]
  ds_read_b64_tr_b16 a[36:37], v17 offset:0
  v_mfma_f32_16x16x32_bf16 v[36:39], a[8:11], a[60:63], v[36:39]
  ds_read_b64_tr_b16 a[38:39], v17 offset:1024
  v_mfma_f32_16x16x32_bf16 v[40:43], a[8:11], a[64:67], v[40:43]
  buffer_load_dwordx4 a[140:143], v18, s[28:31], s36 offen offset:256 sc1
  v_mfma_f32_16x16x32_bf16 v[44:47], a[8:11], a[68:71], v[44:47]
  v_mfma_f32_16x16x32_bf16 v[48:51], a[12:15], a[56:59], v[48:51]
  ds_read_b64_tr_b16 a[40:41], v4 offset:8192
  v_mfma_f32_16x16x32_bf16 v[52:55], a[12:15], a[60:63], v[52:55]
  ds_read_b64_tr_b16 a[42:43], v4 offset:9216
  v_mfma_f32_16x16x32_bf16 v[56:59], a[12:15], a[64:67], v[56:59]
  buffer_load_dwordx4 a[144:147], v18, s[28:31], s36 offen offset:1024 sc1
  v_mfma_f32_16x16x32_bf16 v[60:63], a[12:15], a[68:71], v[60:63]
  s_waitcnt lgkmcnt(10)
  v_mfma_f32_16x16x32_bf16 v[64:67], a[16:19], a[56:59], v[64:67]
  ds_read_b64_tr_b16 a[44:45], v5 offset:8192
  v_mfma_f32_16x16x32_bf16 v[68:71], a[16:19], a[60:63], v[68:71]
  ds_read_b64_tr_b16 a[46:47], v5 offset:9216
  v_mfma_f32_16x16x32_bf16 v[72:75], a[16:19], a[64:67], v[72:75]
  buffer_load_dwordx4 a[148:151], v18, s[28:31], s36 offen offset:1280 sc1
  v_mfma_f32_16x16x32_bf16 v[76:79], a[16:19], a[68:71], v[76:79]
  v_mfma_f32_16x16x32_bf16 v[80:83], a[20:23], a[56:59], v[80:83]
  ds_read_b64_tr_b16 a[48:49], v6 offset:8192
  v_mfma_f32_16x16x32_bf16 v[84:87], a[20:23], a[60:63], v[84:87]
  ds_read_b64_tr_b16 a[50:51], v6 offset:9216
  v_mfma_f32_16x16x32_bf16 v[88:91], a[20:23], a[64:67], v[88:91]
  v_mfma_f32_16x16x32_bf16 v[92:95], a[20:23], a[68:71], v[92:95]
  s_waitcnt lgkmcnt(10)
  v_mfma_f32_16x16x32_bf16 v[96:99], a[24:27], a[56:59], v[96:99]
  ds_read_b64_tr_b16 a[52:53], v7 offset:8192
  v_mfma_f32_16x16x32_bf16 v[100:103], a[24:27], a[60:63], v[100:103]
  ds_read_b64_tr_b16 a[54:55], v7 offset:9216
  v_mfma_f32_16x16x32_bf16 v[104:107], a[24:27], a[64:67], v[104:107]
  buffer_load_dwordx4 v11, s[52:55], s34 offen offset:3072 lds
  v_mfma_f32_16x16x32_bf16 v[108:111], a[24:27], a[68:71], v[108:111]
  s_mov_b32 s36, 90112
  v_mfma_f32_16x16x32_bf16 v[112:115], a[28:31], a[56:59], v[112:115]
  ds_read_b64_tr_b16 a[0:1], v12 offset:8192
  v_mfma_f32_16x16x32_bf16 v[116:119], a[28:31], a[60:63], v[116:119]
  ds_read_b64_tr_b16 a[2:3], v12 offset:9216
  v_mfma_f32_16x16x32_bf16 v[120:123], a[28:31], a[64:67], v[120:123]
  buffer_load_dwordx4 a[152:155], v18, s[28:31], s36 offen offset:0 sc1
  v_mfma_f32_16x16x32_bf16 v[124:127], a[28:31], a[68:71], v[124:127]
  s_add_u32 s34, s32, 1114112
  s_add_u32 m0, s33, 49152
  s_waitcnt lgkmcnt(10)
  v_mfma_f32_16x16x32_bf16 v[128:131], a[32:35], a[56:59], v[128:131]
  ds_read_b64_tr_b16 a[4:5], v13 offset:8192
  v_mfma_f32_16x16x32_bf16 v[132:135], a[32:35], a[60:63], v[132:135]
  ds_read_b64_tr_b16 a[6:7], v13 offset:9216
  v_mfma_f32_16x16x32_bf16 v[136:139], a[32:35], a[64:67], v[136:139]
  buffer_load_dwordx4 v8, s[52:55], s34 offen offset:0 lds
  v_mfma_f32_16x16x32_bf16 v[140:143], a[32:35], a[68:71], v[140:143]
  v_mfma_f32_16x16x32_bf16 v[144:147], a[36:39], a[56:59], v[144:147]
  ds_read_b64_tr_b16 a[8:9], v14 offset:8192
  v_mfma_f32_16x16x32_bf16 v[148:151], a[36:39], a[60:63], v[148:151]
  ds_read_b64_tr_b16 a[10:11], v14 offset:9216
  v_mfma_f32_16x16x32_bf16 v[152:155], a[36:39], a[64:67], v[152:155]
  v_mfma_f32_16x16x32_bf16 v[156:159], a[36:39], a[68:71], v[156:159]
  s_waitcnt vmcnt(27) lgkmcnt(10)
  v_mfma_f32_16x16x32_bf16 v[32:35], a[40:43], a[72:75], v[32:35]
  ds_read_b64_tr_b16 a[12:13], v17 offset:8192
  v_mfma_f32_16x16x32_bf16 v[36:39], a[40:43], a[76:79], v[36:39]
  ds_read_b64_tr_b16 a[14:15], v17 offset:9216
  v_mfma_f32_16x16x32_bf16 v[40:43], a[40:43], a[80:83], v[40:43]
  buffer_load_dwordx4 a[156:159], v18, s[28:31], s36 offen offset:256 sc1
  v_mfma_f32_16x16x32_bf16 v[44:47], a[40:43], a[84:87], v[44:47]
  s_waitcnt vmcnt(39)
  s_barrier
  v_mfma_f32_16x16x32_bf16 v[48:51], a[44:47], a[72:75], v[48:51]
  ds_read_b64_tr_b16 a[16:17], v4 offset:16384
  v_mfma_f32_16x16x32_bf16 v[52:55], a[44:47], a[76:79], v[52:55]
  ds_read_b64_tr_b16 a[18:19], v4 offset:17408
  v_mfma_f32_16x16x32_bf16 v[56:59], a[44:47], a[80:83], v[56:59]
  buffer_load_dwordx4 a[160:163], v18, s[28:31], s36 offen offset:1024 sc1
  v_mfma_f32_16x16x32_bf16 v[60:63], a[44:47], a[84:87], v[60:63]
  s_waitcnt lgkmcnt(10)
  v_mfma_f32_16x16x32_bf16 v[64:67], a[48:51], a[72:75], v[64:67]
  ds_read_b64_tr_b16 a[20:21], v5 offset:16384
  v_mfma_f32_16x16x32_bf16 v[68:71], a[48:51], a[76:79], v[68:71]
  ds_read_b64_tr_b16 a[22:23], v5 offset:17408
  v_mfma_f32_16x16x32_bf16 v[72:75], a[48:51], a[80:83], v[72:75]
  buffer_load_dwordx4 a[164:167], v18, s[28:31], s36 offen offset:1280 sc1
  v_mfma_f32_16x16x32_bf16 v[76:79], a[48:51], a[84:87], v[76:79]
  v_mfma_f32_16x16x32_bf16 v[80:83], a[52:55], a[72:75], v[80:83]
  ds_read_b64_tr_b16 a[24:25], v6 offset:16384
  v_mfma_f32_16x16x32_bf16 v[84:87], a[52:55], a[76:79], v[84:87]
  ds_read_b64_tr_b16 a[26:27], v6 offset:17408
  v_mfma_f32_16x16x32_bf16 v[88:91], a[52:55], a[80:83], v[88:91]
  v_mfma_f32_16x16x32_bf16 v[92:95], a[52:55], a[84:87], v[92:95]
  s_waitcnt lgkmcnt(10)
  v_mfma_f32_16x16x32_bf16 v[96:99], a[0:3], a[72:75], v[96:99]
  ds_read_b64_tr_b16 a[28:29], v7 offset:16384
  v_mfma_f32_16x16x32_bf16 v[100:103], a[0:3], a[76:79], v[100:103]
  ds_read_b64_tr_b16 a[30:31], v7 offset:17408
  v_mfma_f32_16x16x32_bf16 v[104:107], a[0:3], a[80:83], v[104:107]
  buffer_load_dwordx4 v9, s[52:55], s34 offen offset:1024 lds
  v_mfma_f32_16x16x32_bf16 v[108:111], a[0:3], a[84:87], v[108:111]
  s_mov_b32 s36, 94208
  v_mfma_f32_16x16x32_bf16 v[112:115], a[4:7], a[72:75], v[112:115]
  ds_read_b64_tr_b16 a[32:33], v12 offset:16384
  v_mfma_f32_16x16x32_bf16 v[116:119], a[4:7], a[76:79], v[116:119]
  ds_read_b64_tr_b16 a[34:35], v12 offset:17408
  v_mfma_f32_16x16x32_bf16 v[120:123], a[4:7], a[80:83], v[120:123]
  buffer_load_dwordx4 a[168:171], v18, s[28:31], s36 offen offset:0 sc1
  v_mfma_f32_16x16x32_bf16 v[124:127], a[4:7], a[84:87], v[124:127]
  s_waitcnt lgkmcnt(10)
  v_mfma_f32_16x16x32_bf16 v[128:131], a[8:11], a[72:75], v[128:131]
  ds_read_b64_tr_b16 a[36:37], v13 offset:16384
  v_mfma_f32_16x16x32_bf16 v[132:135], a[8:11], a[76:79], v[132:135]
  ds_read_b64_tr_b16 a[38:39], v13 offset:17408
  v_mfma_f32_16x16x32_bf16 v[136:139], a[8:11], a[80:83], v[136:139]
  buffer_load_dwordx4 v10, s[52:55], s34 offen offset:2048 lds
  v_mfma_f32_16x16x32_bf16 v[140:143], a[8:11], a[84:87], v[140:143]
  v_mfma_f32_16x16x32_bf16 v[144:147], a[12:15], a[72:75], v[144:147]
  ds_read_b64_tr_b16 a[40:41], v14 offset:16384
  v_mfma_f32_16x16x32_bf16 v[148:151], a[12:15], a[76:79], v[148:151]
  ds_read_b64_tr_b16 a[42:43], v14 offset:17408
  v_mfma_f32_16x16x32_bf16 v[152:155], a[12:15], a[80:83], v[152:155]
  v_mfma_f32_16x16x32_bf16 v[156:159], a[12:15], a[84:87], v[156:159]
  s_waitcnt vmcnt(27) lgkmcnt(10)
  v_mfma_f32_16x16x32_bf16 v[32:35], a[16:19], a[88:91], v[32:35]
  ds_read_b64_tr_b16 a[44:45], v17 offset:16384
  v_mfma_f32_16x16x32_bf16 v[36:39], a[16:19], a[92:95], v[36:39]
  ds_read_b64_tr_b16 a[46:47], v17 offset:17408
  v_mfma_f32_16x16x32_bf16 v[40:43], a[16:19], a[96:99], v[40:43]
  buffer_load_dwordx4 a[172:175], v18, s[28:31], s36 offen offset:256 sc1
  v_mfma_f32_16x16x32_bf16 v[44:47], a[16:19], a[100:103], v[44:47]
  v_mfma_f32_16x16x32_bf16 v[48:51], a[20:23], a[88:91], v[48:51]
  ds_read_b64_tr_b16 a[48:49], v4 offset:24576
  v_mfma_f32_16x16x32_bf16 v[52:55], a[20:23], a[92:95], v[52:55]
  ds_read_b64_tr_b16 a[50:51], v4 offset:25600
  v_mfma_f32_16x16x32_bf16 v[56:59], a[20:23], a[96:99], v[56:59]
  buffer_load_dwordx4 a[176:179], v18, s[28:31], s36 offen offset:1024 sc1
  v_mfma_f32_16x16x32_bf16 v[60:63], a[20:23], a[100:103], v[60:63]
  s_waitcnt lgkmcnt(10)
  v_mfma_f32_16x16x32_bf16 v[64:67], a[24:27], a[88:91], v[64:67]
  ds_read_b64_tr_b16 a[52:53], v5 offset:24576
  v_mfma_f32_16x16x32_bf16 v[68:71], a[24:27], a[92:95], v[68:71]
  ds_read_b64_tr_b16 a[54:55], v5 offset:25600
  v_mfma_f32_16x16x32_bf16 v[72:75], a[24:27], a[96:99], v[72:75]
  buffer_load_dwordx4 a[180:183], v18, s[28:31], s36 offen offset:1280 sc1
  v_mfma_f32_16x16x32_bf16 v[76:79], a[24:27], a[100:103], v[76:79]
  v_mfma_f32_16x16x32_bf16 v[80:83], a[28:31], a[88:91], v[80:83]
  ds_read_b64_tr_b16 a[0:1], v6 offset:24576
  v_mfma_f32_16x16x32_bf16 v[84:87], a[28:31], a[92:95], v[84:87]
  ds_read_b64_tr_b16 a[2:3], v6 offset:25600
  v_mfma_f32_16x16x32_bf16 v[88:91], a[28:31], a[96:99], v[88:91]
  v_mfma_f32_16x16x32_bf16 v[92:95], a[28:31], a[100:103], v[92:95]
  s_waitcnt lgkmcnt(10)
  v_mfma_f32_16x16x32_bf16 v[96:99], a[32:35], a[88:91], v[96:99]
  ds_read_b64_tr_b16 a[4:5], v7 offset:24576
  v_mfma_f32_16x16x32_bf16 v[100:103], a[32:35], a[92:95], v[100:103]
  ds_read_b64_tr_b16 a[6:7], v7 offset:25600
  v_mfma_f32_16x16x32_bf16 v[104:107], a[32:35], a[96:99], v[104:107]
  buffer_load_dwordx4 v11, s[52:55], s34 offen offset:3072 lds
  v_mfma_f32_16x16x32_bf16 v[108:111], a[32:35], a[100:103], v[108:111]
  s_mov_b32 s36, 98304
  v_mfma_f32_16x16x32_bf16 v[112:115], a[36:39], a[88:91], v[112:115]
  ds_read_b64_tr_b16 a[8:9], v12 offset:24576
  v_mfma_f32_16x16x32_bf16 v[116:119], a[36:39], a[92:95], v[116:119]
  ds_read_b64_tr_b16 a[10:11], v12 offset:25600
  v_mfma_f32_16x16x32_bf16 v[120:123], a[36:39], a[96:99], v[120:123]
  buffer_load_dwordx4 a[184:187], v18, s[28:31], s36 offen offset:0 sc1
  v_mfma_f32_16x16x32_bf16 v[124:127], a[36:39], a[100:103], v[124:127]
  s_waitcnt lgkmcnt(10)
  v_mfma_f32_16x16x32_bf16 v[128:131], a[40:43], a[88:91], v[128:131]
  ds_read_b64_tr_b16 a[12:13], v13 offset:24576
  v_mfma_f32_16x16x32_bf16 v[132:135], a[40:43], a[92:95], v[132:135]
  ds_read_b64_tr_b16 a[14:15], v13 offset:25600
  v_mfma_f32_16x16x32_bf16 v[136:139], a[40:43], a[96:99], v[136:139]
  buffer_load_dwordx4 a[188:191], v18, s[28:31], s36 offen offset:256 sc1
  v_mfma_f32_16x16x32_bf16 v[140:143], a[40:43], a[100:103], v[140:143]
  v_mfma_f32_16x16x32_bf16 v[144:147], a[44:47], a[88:91], v[144:147]
  ds_read_b64_tr_b16 a[16:17], v14 offset:24576
  v_mfma_f32_16x16x32_bf16 v[148:151], a[44:47], a[92:95], v[148:151]
  ds_read_b64_tr_b16 a[18:19], v14 offset:25600
  v_mfma_f32_16x16x32_bf16 v[152:155], a[44:47], a[96:99], v[152:155]
  v_mfma_f32_16x16x32_bf16 v[156:159], a[44:47], a[100:103], v[156:159]
  s_waitcnt vmcnt(27) lgkmcnt(10)
  v_mfma_f32_16x16x32_bf16 v[32:35], a[48:51], a[104:107], v[32:35]
  ds_read_b64_tr_b16 a[20:21], v17 offset:24576
  v_mfma_f32_16x16x32_bf16 v[36:39], a[48:51], a[108:111], v[36:39]
  ds_read_b64_tr_b16 a[22:23], v17 offset:25600
  v_mfma_f32_16x16x32_bf16 v[40:43], a[48:51], a[112:115], v[40:43]
  buffer_load_dwordx4 a[192:195], v18, s[28:31], s36 offen offset:1024 sc1
  v_mfma_f32_16x16x32_bf16 v[44:47], a[48:51], a[116:119], v[44:47]
  s_waitcnt vmcnt(39)
  s_barrier
  v_add_u32 v4, 0, v16
  v_xor_b32 v5, 32, v4
  v_xor_b32 v6, 64, v4
  v_xor_b32 v7, 96, v4
  v_xor_b32 v12, 128, v4
  v_xor_b32 v13, 160, v4
  v_xor_b32 v14, 192, v4
  v_xor_b32 v17, 224, v4
  v_mfma_f32_16x16x32_bf16 v[48:51], a[52:55], a[104:107], v[48:51]
  ds_read_b64_tr_b16 a[24:25], v6 offset:0
  v_mfma_f32_16x16x32_bf16 v[52:55], a[52:55], a[108:111], v[52:55]
  ds_read_b64_tr_b16 a[26:27], v6 offset:1024
  v_mfma_f32_16x16x32_bf16 v[56:59], a[52:55], a[112:115], v[56:59]
  buffer_load_dwordx4 a[196:199], v18, s[28:31], s36 offen offset:1280 sc1
  v_mfma_f32_16x16x32_bf16 v[60:63], a[52:55], a[116:119], v[60:63]
  s_mov_b32 s36, 102400
  s_waitcnt lgkmcnt(10)
  v_mfma_f32_16x16x32_bf16 v[64:67], a[0:3], a[104:107], v[64:67]
  ds_read_b64_tr_b16 a[28:29], v7 offset:0
  v_mfma_f32_16x16x32_bf16 v[68:71], a[0:3], a[108:111], v[68:71]
  ds_read_b64_tr_b16 a[30:31], v7 offset:1024
  v_mfma_f32_16x16x32_bf16 v[72:75], a[0:3], a[112:115], v[72:75]
  buffer_load_dwordx4 a[200:203], v18, s[28:31], s36 offen offset:0 sc1
  v_mfma_f32_16x16x32_bf16 v[76:79], a[0:3], a[116:119], v[76:79]
  v_mfma_f32_16x16x32_bf16 v[80:83], a[4:7], a[104:107], v[80:83]
  ds_read_b64_tr_b16 a[32:33], v6 offset:8192
  v_mfma_f32_16x16x32_bf16 v[84:87], a[4:7], a[108:111], v[84:87]
  ds_read_b64_tr_b16 a[34:35], v6 offset:9216
  v_mfma_f32_16x16x32_bf16 v[88:91], a[4:7], a[112:115], v[88:91]
  v_mfma_f32_16x16x32_bf16 v[92:95], a[4:7], a[116:119], v[92:95]
  s_waitcnt lgkmcnt(10)
  v_mfma_f32_16x16x32_bf16 v[96:99], a[8:11], a[104:107], v[96:99]
  ds_read_b64_tr_b16 a[36:37], v7 offset:8192
  v_mfma_f32_16x16x32_bf16 v[100:103], a[8:11], a[108:111], v[100:103]
  ds_read_b64_tr_b16 a[38:39], v7 offset:9216
  v_mfma_f32_16x16x32_bf16 v[104:107], a[8:11], a[112:115], v[104:107]
  buffer_load_dwordx4 a[204:207], v18, s[28:31], s36 offen offset:256 sc1
  v_mfma_f32_16x16x32_bf16 v[108:111], a[8:11], a[116:119], v[108:111]
  s_waitcnt vmcnt(30)
  s_barrier
  v_mfma_f32_16x16x32_bf16 v[112:115], a[12:15], a[104:107], v[112:115]
  ds_read_b64_tr_b16 a[40:41], v6 offset:16384
  v_mfma_f32_16x16x32_bf16 v[116:119], a[12:15], a[108:111], v[116:119]
  ds_read_b64_tr_b16 a[42:43], v6 offset:17408
  v_mfma_f32_16x16x32_bf16 v[120:123], a[12:15], a[112:115], v[120:123]
  buffer_load_dwordx4 a[208:211], v18, s[28:31], s36 offen offset:1024 sc1
  v_mfma_f32_16x16x32_bf16 v[124:127], a[12:15], a[116:119], v[124:127]
  s_waitcnt lgkmcnt(10)
  v_mfma_f32_16x16x32_bf16 v[128:131], a[16:19], a[104:107], v[128:131]
  ds_read_b64_tr_b16 a[44:45], v7 offset:16384
  v_mfma_f32_16x16x32_bf16 v[132:135], a[16:19], a[108:111], v[132:135]
  ds_read_b64_tr_b16 a[46:47], v7 offset:17408
  v_mfma_f32_16x16x32_bf16 v[136:139], a[16:19], a[112:115], v[136:139]
  buffer_load_dwordx4 a[212:215], v18, s[28:31], s36 offen offset:1280 sc1
  v_mfma_f32_16x16x32_bf16 v[140:143], a[16:19], a[116:119], v[140:143]
  v_mfma_f32_16x16x32_bf16 v[144:147], a[20:23], a[104:107], v[144:147]
  ds_read_b64_tr_b16 a[48:49], v6 offset:24576
  v_mfma_f32_16x16x32_bf16 v[148:151], a[20:23], a[108:111], v[148:151]
  ds_read_b64_tr_b16 a[50:51], v6 offset:25600
  v_mfma_f32_16x16x32_bf16 v[152:155], a[20:23], a[112:115], v[152:155]
  v_mfma_f32_16x16x32_bf16 v[156:159], a[20:23], a[116:119], v[156:159]
  s_waitcnt vmcnt(27) lgkmcnt(10)
  v_mfma_f32_16x16x32_bf16 v[64:67], a[24:27], a[120:123], v[64:67]
  ds_read_b64_tr_b16 a[52:53], v7 offset:24576
  v_mfma_f32_16x16x32_bf16 v[68:71], a[24:27], a[124:127], v[68:71]
  ds_read_b64_tr_b16 a[54:55], v7 offset:25600
  s_mov_b32 s36, 106496
  v_mfma_f32_16x16x32_bf16 v[72:75], a[24:27], a[128:131], v[72:75]
  buffer_load_dwordx4 a[216:219], v18, s[28:31], s36 offen offset:0 sc1
  v_mfma_f32_16x16x32_bf16 v[76:79], a[24:27], a[132:135], v[76:79]
  s_waitcnt vmcnt(21)
  s_barrier
  v_mfma_f32_16x16x32_bf16 v[80:83], a[28:31], a[120:123], v[80:83]
  ds_read_b64_tr_b16 a[0:1], v6 offset:32768
  v_mfma_f32_16x16x32_bf16 v[84:87], a[28:31], a[124:127], v[84:87]
  ds_read_b64_tr_b16 a[2:3], v6 offset:33792
  v_mfma_f32_16x16x32_bf16 v[88:91], a[28:31], a[128:131], v[88:91]
  buffer_load_dwordx4 a[220:223], v18, s[28:31], s36 offen offset:256 sc1
  v_mfma_f32_16x16x32_bf16 v[92:95], a[28:31], a[132:135], v[92:95]
  s_waitcnt vmcnt(23) lgkmcnt(10)
  v_mfma_f32_16x16x32_bf16 v[64:67], a[32:35], a[136:139], v[64:67]
  ds_read_b64_tr_b16 a[4:5], v7 offset:32768
  v_mfma_f32_16x16x32_bf16 v[68:71], a[32:35], a[140:143], v[68:71]
  ds_read_b64_tr_b16 a[6:7], v7 offset:33792
  v_mfma_f32_16x16x32_bf16 v[72:75], a[32:35], a[144:147], v[72:75]
  buffer_load_dwordx4 a[224:227], v18, s[28:31], s36 offen offset:1024 sc1
  v_mfma_f32_16x16x32_bf16 v[76:79], a[32:35], a[148:151], v[76:79]
  v_mfma_f32_16x16x32_bf16 v[80:83], a[36:39], a[136:139], v[80:83]
  ds_read_b64_tr_b16 a[8:9], v6 offset:40960
  v_mfma_f32_16x16x32_bf16 v[84:87], a[36:39], a[140:143], v[84:87]
  ds_read_b64_tr_b16 a[10:11], v6 offset:41984
  v_mfma_f32_16x16x32_bf16 v[88:91], a[36:39], a[144:147], v[88:91]
  buffer_load_dwordx4 a[228:231], v18, s[28:31], s36 offen offset:1280 sc1
  v_mfma_f32_16x16x32_bf16 v[92:95], a[36:39], a[148:151], v[92:95]
  s_mov_b32 s36, 110592
  s_waitcnt vmcnt(19) lgkmcnt(10)
  v_mfma_f32_16x16x32_bf16 v[64:67], a[40:43], a[152:155], v[64:67]
  ds_read_b64_tr_b16 a[12:13], v7 offset:40960
  v_mfma_f32_16x16x32_bf16 v[68:71], a[40:43], a[156:159], v[68:71]
  ds_read_b64_tr_b16 a[14:15], v7 offset:41984
  v_mfma_f32_16x16x32_bf16 v[72:75], a[40:43], a[160:163], v[72:75]
  buffer_load_dwordx4 a[232:235], v18, s[28:31], s36 offen offset:0 sc1
  v_mfma_f32_16x16x32_bf16 v[76:79], a[40:43], a[164:167], v[76:79]
  s_waitcnt vmcnt(13)
  s_barrier
  v_mfma_f32_16x16x32_bf16 v[80:83], a[44:47], a[152:155], v[80:83]
  ds_read_b64_tr_b16 a[16:17], v6 offset:49152
  v_mfma_f32_16x16x32_bf16 v[84:87], a[44:47], a[156:159], v[84:87]
  ds_read_b64_tr_b16 a[18:19], v6 offset:50176
  v_mfma_f32_16x16x32_bf16 v[88:91], a[44:47], a[160:163], v[88:91]
  buffer_load_dwordx4 a[236:239], v18, s[28:31], s36 offen offset:256 sc1
  v_mfma_f32_16x16x32_bf16 v[92:95], a[44:47], a[164:167], v[92:95]
  s_waitcnt vmcnt(15) lgkmcnt(10)
  v_mfma_f32_16x16x32_bf16 v[64:67], a[48:51], a[168:171], v[64:67]
  ds_read_b64_tr_b16 a[20:21], v7 offset:49152
  v_mfma_f32_16x16x32_bf16 v[68:71], a[48:51], a[172:175], v[68:71]
  ds_read_b64_tr_b16 a[22:23], v7 offset:50176
  v_mfma_f32_16x16x32_bf16 v[72:75], a[48:51], a[176:179], v[72:75]
  buffer_load_dwordx4 a[240:243], v18, s[28:31], s36 offen offset:1024 sc1
  v_mfma_f32_16x16x32_bf16 v[76:79], a[48:51], a[180:183], v[76:79]
  v_mfma_f32_16x16x32_bf16 v[80:83], a[52:55], a[168:171], v[80:83]
  ds_read_b64_tr_b16 a[24:25], v6 offset:57344
  v_mfma_f32_16x16x32_bf16 v[84:87], a[52:55], a[172:175], v[84:87]
  ds_read_b64_tr_b16 a[26:27], v6 offset:58368
  v_mfma_f32_16x16x32_bf16 v[88:91], a[52:55], a[176:179], v[88:91]
  buffer_load_dwordx4 a[244:247], v18, s[28:31], s36 offen offset:1280 sc1
  s_mov_b32 s40, s66
  s_mov_b32 s41, s67
  s_mov_b32 s42, 4194304
  s_mov_b32 s43, 0x20000
  s_mov_b32 s46, s99
  s_lshl_b32 s77, s17, 15
  s_add_u32 s77, s77, s101
  s_add_u32 s77, s77, 131072
  v_and_b32 v21, 3, v2
  v_max_u32 v21, 1, v21
  v_lshrrev_b32 v19, 1, v21
  v_mul_u32_u24 v19, 0, v19
  v_cmp_eq_u32 vcc, 3, v21
  v_mov_b32 v3, 0
  v_lshlrev_b32 v21, 8, v21
  v_cndmask_b32 v3, 0, v3, vcc
  v_xor_b32 v21, s77, v21
  v_add3_u32 v21, v21, v19, v3
  v_and_b32 v3, 31, v2
  v_lshlrev_b32 v3, 11, v3
  v_lshrrev_b32 v19, 5, v2
  v_lshl_add_u32 v3, v19, 4, v3
  s_lshl_b32 s78, s16, 17
  s_lshl_b32 s79, s72, 8
  s_add_u32 s78, s78, s79
  s_lshl_b32 s79, s70, 6
  s_add_u32 s78, s78, s79
  s_add_u32 s79, s78, 65536
  v_permlane16_swap_b32 v160, v162
  v_permlane16_swap_b32 v161, v163
  v_permlane16_swap_b32 v164, v166
  v_permlane16_swap_b32 v165, v167
  v_permlane16_swap_b32 v168, v170
  v_permlane16_swap_b32 v169, v171
  v_permlane16_swap_b32 v172, v174
  v_mfma_f32_16x16x32_bf16 v[92:95], a[52:55], a[180:183], v[92:95]
  v_permlane16_swap_b32 v173, v175
  s_waitcnt vmcnt(12) lgkmcnt(10)
  v_mfma_f32_16x16x32_bf16 v[64:67], a[0:3], a[184:187], v[64:67]
  ds_read_b64_tr_b16 a[28:29], v7 offset:57344
  v_mfma_f32_16x16x32_bf16 v[68:71], a[0:3], a[188:191], v[68:71]
  ds_read_b64_tr_b16 a[30:31], v7 offset:58368
  v_mfma_f32_16x16x32_bf16 v[72:75], a[0:3], a[192:195], v[72:75]
  v_mfma_f32_16x16x32_bf16 v[76:79], a[0:3], a[196:199], v[76:79]
  v_mfma_f32_16x16x32_bf16 v[80:83], a[4:7], a[184:187], v[80:83]
  ds_read_b64_tr_b16 a[32:33], v12 offset:0
  v_mfma_f32_16x16x32_bf16 v[84:87], a[4:7], a[188:191], v[84:87]
  ds_read_b64_tr_b16 a[34:35], v12 offset:1024
  v_mfma_f32_16x16x32_bf16 v[88:91], a[4:7], a[192:195], v[88:91]
  v_mfma_f32_16x16x32_bf16 v[92:95], a[4:7], a[196:199], v[92:95]
  s_waitcnt vmcnt(8) lgkmcnt(10)
  v_mfma_f32_16x16x32_bf16 v[64:67], a[8:11], a[200:203], v[64:67]
  ds_read_b64_tr_b16 a[36:37], v13 offset:0
  v_mfma_f32_16x16x32_bf16 v[68:71], a[8:11], a[204:207], v[68:71]
  ds_read_b64_tr_b16 a[38:39], v13 offset:1024
  v_mfma_f32_16x16x32_bf16 v[72:75], a[8:11], a[208:211], v[72:75]
  v_mfma_f32_16x16x32_bf16 v[76:79], a[8:11], a[212:215], v[76:79]
  v_mfma_f32_16x16x32_bf16 v[80:83], a[12:15], a[200:203], v[80:83]
  ds_read_b64_tr_b16 a[40:41], v12 offset:8192
  v_mfma_f32_16x16x32_bf16 v[84:87], a[12:15], a[204:207], v[84:87]
  ds_read_b64_tr_b16 a[42:43], v12 offset:9216
  v_mfma_f32_16x16x32_bf16 v[88:91], a[12:15], a[208:211], v[88:91]
  v_mfma_f32_16x16x32_bf16 v[92:95], a[12:15], a[212:215], v[92:95]
  s_waitcnt vmcnt(4) lgkmcnt(10)
  v_mfma_f32_16x16x32_bf16 v[64:67], a[16:19], a[216:219], v[64:67]
  ds_read_b64_tr_b16 a[44:45], v13 offset:8192
  v_mfma_f32_16x16x32_bf16 v[68:71], a[16:19], a[220:223], v[68:71]
  ds_read_b64_tr_b16 a[46:47], v13 offset:9216
  v_mfma_f32_16x16x32_bf16 v[72:75], a[16:19], a[224:227], v[72:75]
  v_mfma_f32_16x16x32_bf16 v[76:79], a[16:19], a[228:231], v[76:79]
  v_mfma_f32_16x16x32_bf16 v[80:83], a[20:23], a[216:219], v[80:83]
  ds_read_b64_tr_b16 a[48:49], v12 offset:16384
  v_mfma_f32_16x16x32_bf16 v[84:87], a[20:23], a[220:223], v[84:87]
  ds_read_b64_tr_b16 a[50:51], v12 offset:17408
  v_mfma_f32_16x16x32_bf16 v[88:91], a[20:23], a[224:227], v[88:91]
  v_mfma_f32_16x16x32_bf16 v[92:95], a[20:23], a[228:231], v[92:95]
  s_waitcnt vmcnt(0) lgkmcnt(10)
  v_mfma_f32_16x16x32_bf16 v[64:67], a[24:27], a[232:235], v[64:67]
  ds_read_b64_tr_b16 a[52:53], v13 offset:16384
  v_mfma_f32_16x16x32_bf16 v[68:71], a[24:27], a[236:239], v[68:71]
  ds_read_b64_tr_b16 a[54:55], v13 offset:17408
  v_mfma_f32_16x16x32_bf16 v[72:75], a[24:27], a[240:243], v[72:75]
  v_mfma_f32_16x16x32_bf16 v[76:79], a[24:27], a[244:247], v[76:79]
  v_mfma_f32_16x16x32_bf16 v[80:83], a[28:31], a[232:235], v[80:83]
  ds_read_b64_tr_b16 a[0:1], v12 offset:24576
  v_mfma_f32_16x16x32_bf16 v[84:87], a[28:31], a[236:239], v[84:87]
  ds_read_b64_tr_b16 a[2:3], v12 offset:25600
  v_mfma_f32_16x16x32_bf16 v[88:91], a[28:31], a[240:243], v[88:91]
  v_mfma_f32_16x16x32_bf16 v[92:95], a[28:31], a[244:247], v[92:95]
  s_waitcnt lgkmcnt(10)
  v_mfma_f32_16x16x32_bf16 v[96:99], a[32:35], a[120:123], v[96:99]
  ds_read_b64_tr_b16 a[4:5], v13 offset:24576
  v_mfma_f32_16x16x32_bf16 v[100:103], a[32:35], a[124:127], v[100:103]
  ds_read_b64_tr_b16 a[6:7], v13 offset:25600
  v_mfma_f32_16x16x32_bf16 v[104:107], a[32:35], a[128:131], v[104:107]
  v_mfma_f32_16x16x32_bf16 v[108:111], a[32:35], a[132:135], v[108:111]
  v_mfma_f32_16x16x32_bf16 v[112:115], a[36:39], a[120:123], v[112:115]
  ds_read_b64_tr_b16 a[8:9], v12 offset:32768
  v_mfma_f32_16x16x32_bf16 v[116:119], a[36:39], a[124:127], v[116:119]
  ds_read_b64_tr_b16 a[10:11], v12 offset:33792
  v_mfma_f32_16x16x32_bf16 v[120:123], a[36:39], a[128:131], v[120:123]
  v_cvt_pk_bf16_f32 v64, v64, v65
  v_mfma_f32_16x16x32_bf16 v[124:127], a[36:39], a[132:135], v[124:127]
  v_cvt_pk_bf16_f32 v65, v66, v67
  s_waitcnt lgkmcnt(10)
  v_mfma_f32_16x16x32_bf16 v[96:99], a[40:43], a[136:139], v[96:99]
  ds_read_b64_tr_b16 a[12:13], v13 offset:32768
  v_cvt_pk_bf16_f32 v66, v68, v69
  v_mfma_f32_16x16x32_bf16 v[100:103], a[40:43], a[140:143], v[100:103]
  ds_read_b64_tr_b16 a[14:15], v13 offset:33792
  v_cvt_pk_bf16_f32 v67, v70, v71
  v_mfma_f32_16x16x32_bf16 v[104:107], a[40:43], a[144:147], v[104:107]
  buffer_store_dwordx4 v[64:67], v15, s[56:59], s46 offen offset:0 sc1
  v_mfma_f32_16x16x32_bf16 v[108:111], a[40:43], a[148:151], v[108:111]
  v_mfma_f32_16x16x32_bf16 v[112:115], a[44:47], a[136:139], v[112:115]
  ds_read_b64_tr_b16 a[16:17], v12 offset:40960
  v_cvt_pk_bf16_f32 v68, v72, v73
  v_mfma_f32_16x16x32_bf16 v[116:119], a[44:47], a[140:143], v[116:119]
  ds_read_b64_tr_b16 a[18:19], v12 offset:41984
  v_cvt_pk_bf16_f32 v69, v74, v75
  v_mfma_f32_16x16x32_bf16 v[120:123], a[44:47], a[144:147], v[120:123]
  v_cvt_pk_bf16_f32 v70, v76, v77
  v_mfma_f32_16x16x32_bf16 v[124:127], a[44:47], a[148:151], v[124:127]
  v_cvt_pk_bf16_f32 v71, v78, v79
  s_waitcnt lgkmcnt(10)
  v_mfma_f32_16x16x32_bf16 v[96:99], a[48:51], a[152:155], v[96:99]
  ds_read_b64_tr_b16 a[20:21], v13 offset:40960
  v_mfma_f32_16x16x32_bf16 v[100:103], a[48:51], a[156:159], v[100:103]
  ds_read_b64_tr_b16 a[22:23], v13 offset:41984
  v_mfma_f32_16x16x32_bf16 v[104:107], a[48:51], a[160:163], v[104:107]
  buffer_store_dwordx4 v[68:71], v15, s[56:59], s46 offen offset:1024 sc1
  v_cvt_pk_bf16_f32 v72, v80, v81
  v_mfma_f32_16x16x32_bf16 v[108:111], a[48:51], a[164:167], v[108:111]
  v_cvt_pk_bf16_f32 v73, v82, v83
  v_mfma_f32_16x16x32_bf16 v[112:115], a[52:55], a[152:155], v[112:115]
  ds_read_b64_tr_b16 a[24:25], v12 offset:49152
  v_cvt_pk_bf16_f32 v74, v84, v85
  v_mfma_f32_16x16x32_bf16 v[116:119], a[52:55], a[156:159], v[116:119]
  ds_read_b64_tr_b16 a[26:27], v12 offset:50176
  v_mfma_f32_16x16x32_bf16 v[120:123], a[52:55], a[160:163], v[120:123]
  v_cvt_pk_bf16_f32 v75, v86, v87
  buffer_store_dwordx4 v[72:75], v15, s[56:59], s46 offen offset:2048 sc1
  v_mfma_f32_16x16x32_bf16 v[124:127], a[52:55], a[164:167], v[124:127]
  s_waitcnt lgkmcnt(10)
  v_mfma_f32_16x16x32_bf16 v[96:99], a[0:3], a[168:171], v[96:99]
  ds_read_b64_tr_b16 a[28:29], v13 offset:49152
  v_cvt_pk_bf16_f32 v76, v88, v89
  v_mfma_f32_16x16x32_bf16 v[100:103], a[0:3], a[172:175], v[100:103]
  ds_read_b64_tr_b16 a[30:31], v13 offset:50176
  v_cvt_pk_bf16_f32 v77, v90, v91
  v_mfma_f32_16x16x32_bf16 v[104:107], a[0:3], a[176:179], v[104:107]
  v_mfma_f32_16x16x32_bf16 v[108:111], a[0:3], a[180:183], v[108:111]
  v_cvt_pk_bf16_f32 v78, v92, v93
  v_mfma_f32_16x16x32_bf16 v[112:115], a[4:7], a[168:171], v[112:115]
  ds_read_b64_tr_b16 a[32:33], v12 offset:57344
  v_cvt_pk_bf16_f32 v79, v94, v95
  v_mfma_f32_16x16x32_bf16 v[116:119], a[4:7], a[172:175], v[116:119]
  ds_read_b64_tr_b16 a[34:35], v12 offset:58368
  v_mfma_f32_16x16x32_bf16 v[120:123], a[4:7], a[176:179], v[120:123]
  buffer_store_dwordx4 v[76:79], v15, s[56:59], s46 offen offset:3072 sc1
  s_add_u32 s46, s46, 4096
  v_mfma_f32_16x16x32_bf16 v[124:127], a[4:7], a[180:183], v[124:127]
  s_waitcnt lgkmcnt(10)
  v_mfma_f32_16x16x32_bf16 v[96:99], a[8:11], a[184:187], v[96:99]
  ds_read_b64_tr_b16 a[36:37], v13 offset:57344
  v_mfma_f32_16x16x32_bf16 v[100:103], a[8:11], a[188:191], v[100:103]
  ds_read_b64_tr_b16 a[38:39], v13 offset:58368
  v_mfma_f32_16x16x32_bf16 v[104:107], a[8:11], a[192:195], v[104:107]
  v_mfma_f32_16x16x32_bf16 v[108:111], a[8:11], a[196:199], v[108:111]
  v_mfma_f32_16x16x32_bf16 v[112:115], a[12:15], a[184:187], v[112:115]
  ds_read_b64_tr_b16 a[40:41], v14 offset:0
  v_mfma_f32_16x16x32_bf16 v[116:119], a[12:15], a[188:191], v[116:119]
  ds_read_b64_tr_b16 a[42:43], v14 offset:1024
  v_mfma_f32_16x16x32_bf16 v[120:123], a[12:15], a[192:195], v[120:123]
  v_mfma_f32_16x16x32_bf16 v[124:127], a[12:15], a[196:199], v[124:127]
  s_waitcnt lgkmcnt(10)
  v_mfma_f32_16x16x32_bf16 v[96:99], a[16:19], a[200:203], v[96:99]
  ds_read_b64_tr_b16 a[44:45], v17 offset:0
  v_mfma_f32_16x16x32_bf16 v[100:103], a[16:19], a[204:207], v[100:103]
  ds_read_b64_tr_b16 a[46:47], v17 offset:1024
  v_mfma_f32_16x16x32_bf16 v[104:107], a[16:19], a[208:211], v[104:107]
  v_mfma_f32_16x16x32_bf16 v[108:111], a[16:19], a[212:215], v[108:111]
  v_mfma_f32_16x16x32_bf16 v[112:115], a[20:23], a[200:203], v[112:115]
  ds_read_b64_tr_b16 a[48:49], v14 offset:8192
  v_mfma_f32_16x16x32_bf16 v[116:119], a[20:23], a[204:207], v[116:119]
  ds_read_b64_tr_b16 a[50:51], v14 offset:9216
  v_mfma_f32_16x16x32_bf16 v[120:123], a[20:23], a[208:211], v[120:123]
  v_mfma_f32_16x16x32_bf16 v[124:127], a[20:23], a[212:215], v[124:127]
  s_waitcnt lgkmcnt(10)
  v_mfma_f32_16x16x32_bf16 v[96:99], a[24:27], a[216:219], v[96:99]
  ds_read_b64_tr_b16 a[52:53], v17 offset:8192
  v_mfma_f32_16x16x32_bf16 v[100:103], a[24:27], a[220:223], v[100:103]
  ds_read_b64_tr_b16 a[54:55], v17 offset:9216
  v_mfma_f32_16x16x32_bf16 v[104:107], a[24:27], a[224:227], v[104:107]
  v_mfma_f32_16x16x32_bf16 v[108:111], a[24:27], a[228:231], v[108:111]
  v_mfma_f32_16x16x32_bf16 v[112:115], a[28:31], a[216:219], v[112:115]
  ds_read_b64_tr_b16 a[0:1], v14 offset:16384
  v_mfma_f32_16x16x32_bf16 v[116:119], a[28:31], a[220:223], v[116:119]
  ds_read_b64_tr_b16 a[2:3], v14 offset:17408
  v_mfma_f32_16x16x32_bf16 v[120:123], a[28:31], a[224:227], v[120:123]
  v_mfma_f32_16x16x32_bf16 v[124:127], a[28:31], a[228:231], v[124:127]
  s_waitcnt lgkmcnt(10)
  v_mfma_f32_16x16x32_bf16 v[96:99], a[32:35], a[232:235], v[96:99]
  ds_read_b64_tr_b16 a[4:5], v17 offset:16384
  v_mfma_f32_16x16x32_bf16 v[100:103], a[32:35], a[236:239], v[100:103]
  ds_read_b64_tr_b16 a[6:7], v17 offset:17408
  v_mfma_f32_16x16x32_bf16 v[104:107], a[32:35], a[240:243], v[104:107]
  v_mfma_f32_16x16x32_bf16 v[108:111], a[32:35], a[244:247], v[108:111]
  v_mfma_f32_16x16x32_bf16 v[112:115], a[36:39], a[232:235], v[112:115]
  ds_read_b64_tr_b16 a[8:9], v14 offset:24576
  v_mfma_f32_16x16x32_bf16 v[116:119], a[36:39], a[236:239], v[116:119]
  ds_read_b64_tr_b16 a[10:11], v14 offset:25600
  v_mfma_f32_16x16x32_bf16 v[120:123], a[36:39], a[240:243], v[120:123]
  v_mfma_f32_16x16x32_bf16 v[124:127], a[36:39], a[244:247], v[124:127]
  s_waitcnt lgkmcnt(10)
  v_mfma_f32_16x16x32_bf16 v[128:131], a[40:43], a[120:123], v[128:131]
  ds_read_b64_tr_b16 a[12:13], v17 offset:24576
  v_mfma_f32_16x16x32_bf16 v[132:135], a[40:43], a[124:127], v[132:135]
  ds_read_b64_tr_b16 a[14:15], v17 offset:25600
  v_mfma_f32_16x16x32_bf16 v[136:139], a[40:43], a[128:131], v[136:139]
  v_mfma_f32_16x16x32_bf16 v[140:143], a[40:43], a[132:135], v[140:143]
  v_mfma_f32_16x16x32_bf16 v[144:147], a[44:47], a[120:123], v[144:147]
  ds_read_b64_tr_b16 a[16:17], v14 offset:32768
  v_mfma_f32_16x16x32_bf16 v[148:151], a[44:47], a[124:127], v[148:151]
  ds_read_b64_tr_b16 a[18:19], v14 offset:33792
  v_mfma_f32_16x16x32_bf16 v[152:155], a[44:47], a[128:131], v[152:155]
  v_cvt_pk_bf16_f32 v96, v96, v97
  v_mfma_f32_16x16x32_bf16 v[156:159], a[44:47], a[132:135], v[156:159]
  v_cvt_pk_bf16_f32 v97, v98, v99
  s_waitcnt lgkmcnt(10)
  v_mfma_f32_16x16x32_bf16 v[128:131], a[48:51], a[136:139], v[128:131]
  ds_read_b64_tr_b16 a[20:21], v17 offset:32768
  v_cvt_pk_bf16_f32 v98, v100, v101
  v_mfma_f32_16x16x32_bf16 v[132:135], a[48:51], a[140:143], v[132:135]
  ds_read_b64_tr_b16 a[22:23], v17 offset:33792
  v_cvt_pk_bf16_f32 v99, v102, v103
  v_mfma_f32_16x16x32_bf16 v[136:139], a[48:51], a[144:147], v[136:139]
  buffer_store_dwordx4 v[96:99], v15, s[56:59], s46 offen offset:0 sc1
  v_mfma_f32_16x16x32_bf16 v[140:143], a[48:51], a[148:151], v[140:143]
  v_mfma_f32_16x16x32_bf16 v[144:147], a[52:55], a[136:139], v[144:147]
  ds_read_b64_tr_b16 a[24:25], v14 offset:40960
  v_cvt_pk_bf16_f32 v100, v104, v105
  v_mfma_f32_16x16x32_bf16 v[148:151], a[52:55], a[140:143], v[148:151]
  ds_read_b64_tr_b16 a[26:27], v14 offset:41984
  v_cvt_pk_bf16_f32 v101, v106, v107
  v_mfma_f32_16x16x32_bf16 v[152:155], a[52:55], a[144:147], v[152:155]
  v_cvt_pk_bf16_f32 v102, v108, v109
  v_mfma_f32_16x16x32_bf16 v[156:159], a[52:55], a[148:151], v[156:159]
  v_cvt_pk_bf16_f32 v103, v110, v111
  s_waitcnt lgkmcnt(10)
  v_mfma_f32_16x16x32_bf16 v[128:131], a[0:3], a[152:155], v[128:131]
  ds_read_b64_tr_b16 a[28:29], v17 offset:40960
  v_mfma_f32_16x16x32_bf16 v[132:135], a[0:3], a[156:159], v[132:135]
  ds_read_b64_tr_b16 a[30:31], v17 offset:41984
  v_mfma_f32_16x16x32_bf16 v[136:139], a[0:3], a[160:163], v[136:139]
  buffer_store_dwordx4 v[100:103], v15, s[56:59], s46 offen offset:1024 sc1
  v_cvt_pk_bf16_f32 v104, v112, v113
  v_mfma_f32_16x16x32_bf16 v[140:143], a[0:3], a[164:167], v[140:143]
  v_cvt_pk_bf16_f32 v105, v114, v115
  v_mfma_f32_16x16x32_bf16 v[144:147], a[4:7], a[152:155], v[144:147]
  ds_read_b64_tr_b16 a[32:33], v14 offset:49152
  v_cvt_pk_bf16_f32 v106, v116, v117
  v_mfma_f32_16x16x32_bf16 v[148:151], a[4:7], a[156:159], v[148:151]
  ds_read_b64_tr_b16 a[34:35], v14 offset:50176
  v_mfma_f32_16x16x32_bf16 v[152:155], a[4:7], a[160:163], v[152:155]
  v_cvt_pk_bf16_f32 v107, v118, v119
  buffer_store_dwordx4 v[104:107], v15, s[56:59], s46 offen offset:2048 sc1
  v_mfma_f32_16x16x32_bf16 v[156:159], a[4:7], a[164:167], v[156:159]
  s_waitcnt lgkmcnt(10)
  v_mfma_f32_16x16x32_bf16 v[128:131], a[8:11], a[168:171], v[128:131]
  ds_read_b64_tr_b16 a[36:37], v17 offset:49152
  v_cvt_pk_bf16_f32 v108, v120, v121
  v_mfma_f32_16x16x32_bf16 v[132:135], a[8:11], a[172:175], v[132:135]
  ds_read_b64_tr_b16 a[38:39], v17 offset:50176
  v_cvt_pk_bf16_f32 v109, v122, v123
  v_mfma_f32_16x16x32_bf16 v[136:139], a[8:11], a[176:179], v[136:139]
  v_mfma_f32_16x16x32_bf16 v[140:143], a[8:11], a[180:183], v[140:143]
  v_cvt_pk_bf16_f32 v110, v124, v125
  v_mfma_f32_16x16x32_bf16 v[144:147], a[12:15], a[168:171], v[144:147]
  ds_read_b64_tr_b16 a[40:41], v14 offset:57344
  v_cvt_pk_bf16_f32 v111, v126, v127
  v_mfma_f32_16x16x32_bf16 v[148:151], a[12:15], a[172:175], v[148:151]
  ds_read_b64_tr_b16 a[42:43], v14 offset:58368
  v_mfma_f32_16x16x32_bf16 v[152:155], a[12:15], a[176:179], v[152:155]
  buffer_store_dwordx4 v[108:111], v15, s[56:59], s46 offen offset:3072 sc1
  s_add_u32 s46, s46, 4096
  v_mfma_f32_16x16x32_bf16 v[156:159], a[12:15], a[180:183], v[156:159]
  s_waitcnt lgkmcnt(10)
  v_mfma_f32_16x16x32_bf16 v[128:131], a[16:19], a[184:187], v[128:131]
  ds_read_b64_tr_b16 a[44:45], v17 offset:57344
  v_mfma_f32_16x16x32_bf16 v[132:135], a[16:19], a[188:191], v[132:135]
  ds_read_b64_tr_b16 a[46:47], v17 offset:58368
  v_mfma_f32_16x16x32_bf16 v[136:139], a[16:19], a[192:195], v[136:139]
  v_mfma_f32_16x16x32_bf16 v[140:143], a[16:19], a[196:199], v[140:143]
  v_mfma_f32_16x16x32_bf16 v[144:147], a[20:23], a[184:187], v[144:147]
  ds_read_b64_tr_b16 a[48:49], v4 offset:0
  v_mfma_f32_16x16x32_bf16 v[148:151], a[20:23], a[188:191], v[148:151]
  ds_read_b64_tr_b16 a[50:51], v4 offset:1024
  v_mfma_f32_16x16x32_bf16 v[152:155], a[20:23], a[192:195], v[152:155]
  v_mfma_f32_16x16x32_bf16 v[156:159], a[20:23], a[196:199], v[156:159]
  s_waitcnt lgkmcnt(10)
  v_mfma_f32_16x16x32_bf16 v[128:131], a[24:27], a[200:203], v[128:131]
  ds_read_b64_tr_b16 a[52:53], v5 offset:0
  v_mfma_f32_16x16x32_bf16 v[132:135], a[24:27], a[204:207], v[132:135]
  ds_read_b64_tr_b16 a[54:55], v5 offset:1024
  v_mfma_f32_16x16x32_bf16 v[136:139], a[24:27], a[208:211], v[136:139]
  v_mfma_f32_16x16x32_bf16 v[140:143], a[24:27], a[212:215], v[140:143]
  v_mfma_f32_16x16x32_bf16 v[144:147], a[28:31], a[200:203], v[144:147]
  ds_read_b64_tr_b16 a[0:1], v4 offset:8192
  v_mfma_f32_16x16x32_bf16 v[148:151], a[28:31], a[204:207], v[148:151]
  ds_read_b64_tr_b16 a[2:3], v4 offset:9216
  v_mfma_f32_16x16x32_bf16 v[152:155], a[28:31], a[208:211], v[152:155]
  v_mfma_f32_16x16x32_bf16 v[156:159], a[28:31], a[212:215], v[156:159]
  s_waitcnt lgkmcnt(10)
  v_mfma_f32_16x16x32_bf16 v[128:131], a[32:35], a[216:219], v[128:131]
  ds_read_b64_tr_b16 a[4:5], v5 offset:8192
  v_mfma_f32_16x16x32_bf16 v[132:135], a[32:35], a[220:223], v[132:135]
  ds_read_b64_tr_b16 a[6:7], v5 offset:9216
  v_mfma_f32_16x16x32_bf16 v[136:139], a[32:35], a[224:227], v[136:139]
  v_mfma_f32_16x16x32_bf16 v[140:143], a[32:35], a[228:231], v[140:143]
  v_mfma_f32_16x16x32_bf16 v[144:147], a[36:39], a[216:219], v[144:147]
  ds_read_b64_tr_b16 a[8:9], v4 offset:16384
  v_mfma_f32_16x16x32_bf16 v[148:151], a[36:39], a[220:223], v[148:151]
  ds_read_b64_tr_b16 a[10:11], v4 offset:17408
  v_mfma_f32_16x16x32_bf16 v[152:155], a[36:39], a[224:227], v[152:155]
  v_mfma_f32_16x16x32_bf16 v[156:159], a[36:39], a[228:231], v[156:159]
  s_waitcnt lgkmcnt(10)
  v_mfma_f32_16x16x32_bf16 v[128:131], a[40:43], a[232:235], v[128:131]
  ds_read_b64_tr_b16 a[12:13], v5 offset:16384
  v_mfma_f32_16x16x32_bf16 v[132:135], a[40:43], a[236:239], v[132:135]
  ds_read_b64_tr_b16 a[14:15], v5 offset:17408
  v_mfma_f32_16x16x32_bf16 v[136:139], a[40:43], a[240:243], v[136:139]
  v_mfma_f32_16x16x32_bf16 v[140:143], a[40:43], a[244:247], v[140:143]
  v_mfma_f32_16x16x32_bf16 v[144:147], a[44:47], a[232:235], v[144:147]
  ds_read_b64_tr_b16 a[16:17], v4 offset:24576
  v_mfma_f32_16x16x32_bf16 v[148:151], a[44:47], a[236:239], v[148:151]
  ds_read_b64_tr_b16 a[18:19], v4 offset:25600
  v_mfma_f32_16x16x32_bf16 v[152:155], a[44:47], a[240:243], v[152:155]
  v_mfma_f32_16x16x32_bf16 v[156:159], a[44:47], a[244:247], v[156:159]
  s_waitcnt lgkmcnt(10)
  v_mfma_f32_16x16x32_bf16 v[32:35], a[48:51], a[120:123], v[32:35]
  ds_read_b64_tr_b16 a[20:21], v5 offset:24576
  v_mfma_f32_16x16x32_bf16 v[36:39], a[48:51], a[124:127], v[36:39]
  ds_read_b64_tr_b16 a[22:23], v5 offset:25600
  v_mfma_f32_16x16x32_bf16 v[40:43], a[48:51], a[128:131], v[40:43]
  v_mfma_f32_16x16x32_bf16 v[44:47], a[48:51], a[132:135], v[44:47]
  v_mfma_f32_16x16x32_bf16 v[48:51], a[52:55], a[120:123], v[48:51]
  ds_read_b64_tr_b16 a[24:25], v4 offset:32768
  v_mfma_f32_16x16x32_bf16 v[52:55], a[52:55], a[124:127], v[52:55]
  ds_read_b64_tr_b16 a[26:27], v4 offset:33792
  v_mfma_f32_16x16x32_bf16 v[56:59], a[52:55], a[128:131], v[56:59]
  v_cvt_pk_bf16_f32 v128, v128, v129
  v_mfma_f32_16x16x32_bf16 v[60:63], a[52:55], a[132:135], v[60:63]
  v_cvt_pk_bf16_f32 v129, v130, v131
  s_waitcnt lgkmcnt(10)
  v_mfma_f32_16x16x32_bf16 v[32:35], a[0:3], a[136:139], v[32:35]
  ds_read_b64_tr_b16 a[28:29], v5 offset:32768
  v_cvt_pk_bf16_f32 v130, v132, v133
  v_mfma_f32_16x16x32_bf16 v[36:39], a[0:3], a[140:143], v[36:39]
  ds_read_b64_tr_b16 a[30:31], v5 offset:33792
  v_cvt_pk_bf16_f32 v131, v134, v135
  v_mfma_f32_16x16x32_bf16 v[40:43], a[0:3], a[144:147], v[40:43]
  buffer_store_dwordx4 v[128:131], v15, s[56:59], s46 offen offset:0 sc1
  v_mfma_f32_16x16x32_bf16 v[44:47], a[0:3], a[148:151], v[44:47]
  v_mfma_f32_16x16x32_bf16 v[48:51], a[4:7], a[136:139], v[48:51]
  ds_read_b64_tr_b16 a[32:33], v4 offset:40960
  v_cvt_pk_bf16_f32 v132, v136, v137
  v_mfma_f32_16x16x32_bf16 v[52:55], a[4:7], a[140:143], v[52:55]
  ds_read_b64_tr_b16 a[34:35], v4 offset:41984
  v_cvt_pk_bf16_f32 v133, v138, v139
  v_mfma_f32_16x16x32_bf16 v[56:59], a[4:7], a[144:147], v[56:59]
  v_cvt_pk_bf16_f32 v134, v140, v141
  v_mfma_f32_16x16x32_bf16 v[60:63], a[4:7], a[148:151], v[60:63]
  v_cvt_pk_bf16_f32 v135, v142, v143
  s_waitcnt lgkmcnt(10)
  v_mfma_f32_16x16x32_bf16 v[32:35], a[8:11], a[152:155], v[32:35]
  ds_read_b64_tr_b16 a[36:37], v5 offset:40960
  v_mfma_f32_16x16x32_bf16 v[36:39], a[8:11], a[156:159], v[36:39]
  ds_read_b64_tr_b16 a[38:39], v5 offset:41984
  v_mfma_f32_16x16x32_bf16 v[40:43], a[8:11], a[160:163], v[40:43]
  buffer_store_dwordx4 v[132:135], v15, s[56:59], s46 offen offset:1024 sc1
  v_cvt_pk_bf16_f32 v136, v144, v145
  v_mfma_f32_16x16x32_bf16 v[44:47], a[8:11], a[164:167], v[44:47]
  v_cvt_pk_bf16_f32 v137, v146, v147
  v_mfma_f32_16x16x32_bf16 v[48:51], a[12:15], a[152:155], v[48:51]
  ds_read_b64_tr_b16 a[40:41], v4 offset:49152
  v_cvt_pk_bf16_f32 v138, v148, v149
  v_mfma_f32_16x16x32_bf16 v[52:55], a[12:15], a[156:159], v[52:55]
  ds_read_b64_tr_b16 a[42:43], v4 offset:50176
  v_mfma_f32_16x16x32_bf16 v[56:59], a[12:15], a[160:163], v[56:59]
  v_cvt_pk_bf16_f32 v139, v150, v151
  buffer_store_dwordx4 v[136:139], v15, s[56:59], s46 offen offset:2048 sc1
  v_mfma_f32_16x16x32_bf16 v[60:63], a[12:15], a[164:167], v[60:63]
  s_waitcnt lgkmcnt(10)
  v_mfma_f32_16x16x32_bf16 v[32:35], a[16:19], a[168:171], v[32:35]
  ds_read_b64_tr_b16 a[44:45], v5 offset:49152
  v_cvt_pk_bf16_f32 v140, v152, v153
  v_mfma_f32_16x16x32_bf16 v[36:39], a[16:19], a[172:175], v[36:39]
  ds_read_b64_tr_b16 a[46:47], v5 offset:50176
  v_cvt_pk_bf16_f32 v141, v154, v155
  v_mfma_f32_16x16x32_bf16 v[40:43], a[16:19], a[176:179], v[40:43]
  v_mfma_f32_16x16x32_bf16 v[44:47], a[16:19], a[180:183], v[44:47]
  v_cvt_pk_bf16_f32 v142, v156, v157
  v_mfma_f32_16x16x32_bf16 v[48:51], a[20:23], a[168:171], v[48:51]
  ds_read_b64_tr_b16 a[48:49], v4 offset:57344
  v_cvt_pk_bf16_f32 v143, v158, v159
  v_mfma_f32_16x16x32_bf16 v[52:55], a[20:23], a[172:175], v[52:55]
  ds_read_b64_tr_b16 a[50:51], v4 offset:58368
  v_mfma_f32_16x16x32_bf16 v[56:59], a[20:23], a[176:179], v[56:59]
  buffer_store_dwordx4 v[140:143], v15, s[56:59], s46 offen offset:3072 sc1
  s_add_u32 s46, s46, 4096
  v_mfma_f32_16x16x32_bf16 v[60:63], a[20:23], a[180:183], v[60:63]
  s_waitcnt lgkmcnt(10)
  v_mfma_f32_16x16x32_bf16 v[32:35], a[24:27], a[184:187], v[32:35]
  ds_read_b64_tr_b16 a[52:53], v5 offset:57344
  v_mfma_f32_16x16x32_bf16 v[36:39], a[24:27], a[188:191], v[36:39]
  ds_read_b64_tr_b16 a[54:55], v5 offset:58368
  v_mfma_f32_16x16x32_bf16 v[40:43], a[24:27], a[192:195], v[40:43]
  v_mfma_f32_16x16x32_bf16 v[44:47], a[24:27], a[196:199], v[44:47]
  v_mfma_f32_16x16x32_bf16 v[48:51], a[28:31], a[184:187], v[48:51]
  v_mfma_f32_16x16x32_bf16 v[52:55], a[28:31], a[188:191], v[52:55]
  v_mfma_f32_16x16x32_bf16 v[56:59], a[28:31], a[192:195], v[56:59]
  v_mfma_f32_16x16x32_bf16 v[60:63], a[28:31], a[196:199], v[60:63]
  s_waitcnt lgkmcnt(8)
  v_mfma_f32_16x16x32_bf16 v[32:35], a[32:35], a[200:203], v[32:35]
  v_mfma_f32_16x16x32_bf16 v[36:39], a[32:35], a[204:207], v[36:39]
  v_mfma_f32_16x16x32_bf16 v[40:43], a[32:35], a[208:211], v[40:43]
  v_mfma_f32_16x16x32_bf16 v[44:47], a[32:35], a[212:215], v[44:47]
  v_mfma_f32_16x16x32_bf16 v[48:51], a[36:39], a[200:203], v[48:51]
  v_mfma_f32_16x16x32_bf16 v[52:55], a[36:39], a[204:207], v[52:55]
  v_mfma_f32_16x16x32_bf16 v[56:59], a[36:39], a[208:211], v[56:59]
  v_mfma_f32_16x16x32_bf16 v[60:63], a[36:39], a[212:215], v[60:63]
  s_waitcnt lgkmcnt(4)
  v_mfma_f32_16x16x32_bf16 v[32:35], a[40:43], a[216:219], v[32:35]
  v_mfma_f32_16x16x32_bf16 v[36:39], a[40:43], a[220:223], v[36:39]
  v_mfma_f32_16x16x32_bf16 v[40:43], a[40:43], a[224:227], v[40:43]
  v_mfma_f32_16x16x32_bf16 v[44:47], a[40:43], a[228:231], v[44:47]
  v_mfma_f32_16x16x32_bf16 v[48:51], a[44:47], a[216:219], v[48:51]
  v_mfma_f32_16x16x32_bf16 v[52:55], a[44:47], a[220:223], v[52:55]
  v_mfma_f32_16x16x32_bf16 v[56:59], a[44:47], a[224:227], v[56:59]
  v_mfma_f32_16x16x32_bf16 v[60:63], a[44:47], a[228:231], v[60:63]
  s_waitcnt lgkmcnt(0)
  v_mfma_f32_16x16x32_bf16 v[32:35], a[48:51], a[232:235], v[32:35]
  v_mfma_f32_16x16x32_bf16 v[36:39], a[48:51], a[236:239], v[36:39]
  v_mfma_f32_16x16x32_bf16 v[40:43], a[48:51], a[240:243], v[40:43]
  v_mfma_f32_16x16x32_bf16 v[44:47], a[48:51], a[244:247], v[44:47]
  v_mfma_f32_16x16x32_bf16 v[48:51], a[52:55], a[232:235], v[48:51]
  v_mfma_f32_16x16x32_bf16 v[52:55], a[52:55], a[236:239], v[52:55]
  v_mfma_f32_16x16x32_bf16 v[56:59], a[52:55], a[240:243], v[56:59]
  v_mfma_f32_16x16x32_bf16 v[60:63], a[52:55], a[244:247], v[60:63]
  s_waitcnt vmcnt(0)
  v_mov_b32 v0, 0
  v_mov_b32 v1, 1
  s_mov_b64 exec, 1
  buffer_store_dword v1, v0, s[48:51], s77 offen sc1
  s_mov_b64 exec, -1
  s_nop 3
  v_lshlrev_b32 v22, 16, v160
  v_and_b32 v23, 0xffff0000, v160
  v_pk_add_f32 v[32:33], v[32:33], v[22:23]
  v_lshlrev_b32 v22, 16, v161
  v_and_b32 v23, 0xffff0000, v161
  v_pk_add_f32 v[34:35], v[34:35], v[22:23]
  v_lshlrev_b32 v22, 16, v162
  v_and_b32 v23, 0xffff0000, v162
  v_pk_add_f32 v[36:37], v[36:37], v[22:23]
  v_lshlrev_b32 v22, 16, v163
  v_and_b32 v23, 0xffff0000, v163
  v_pk_add_f32 v[38:39], v[38:39], v[22:23]
  v_lshlrev_b32 v22, 16, v164
  v_and_b32 v23, 0xffff0000, v164
  v_pk_add_f32 v[40:41], v[40:41], v[22:23]
  v_lshlrev_b32 v22, 16, v165
  v_and_b32 v23, 0xffff0000, v165
  v_pk_add_f32 v[42:43], v[42:43], v[22:23]
  v_lshlrev_b32 v22, 16, v166
  v_and_b32 v23, 0xffff0000, v166
  v_pk_add_f32 v[44:45], v[44:45], v[22:23]
  v_lshlrev_b32 v22, 16, v167
  v_and_b32 v23, 0xffff0000, v167
  v_pk_add_f32 v[46:47], v[46:47], v[22:23]
  v_lshlrev_b32 v22, 16, v168
  v_and_b32 v23, 0xffff0000, v168
  v_pk_add_f32 v[48:49], v[48:49], v[22:23]
  v_lshlrev_b32 v22, 16, v169
  v_and_b32 v23, 0xffff0000, v169
  v_pk_add_f32 v[50:51], v[50:51], v[22:23]
  v_lshlrev_b32 v22, 16, v170
  v_and_b32 v23, 0xffff0000, v170
  v_pk_add_f32 v[52:53], v[52:53], v[22:23]
  v_lshlrev_b32 v22, 16, v171
  v_and_b32 v23, 0xffff0000, v171
  v_pk_add_f32 v[54:55], v[54:55], v[22:23]
  v_lshlrev_b32 v22, 16, v172
  v_and_b32 v23, 0xffff0000, v172
  v_pk_add_f32 v[56:57], v[56:57], v[22:23]
  v_lshlrev_b32 v22, 16, v173
  v_and_b32 v23, 0xffff0000, v173
  v_pk_add_f32 v[58:59], v[58:59], v[22:23]
  v_lshlrev_b32 v22, 16, v174
  v_and_b32 v23, 0xffff0000, v174
  v_pk_add_f32 v[60:61], v[60:61], v[22:23]
  v_lshlrev_b32 v22, 16, v175
  v_and_b32 v23, 0xffff0000, v175
  v_pk_add_f32 v[62:63], v[62:63], v[22:23]
  s_mov_b32 s39, 0x8000
L_poll_f3:
  buffer_load_dword v22, v21, s[48:51], 0 offen sc1
  s_waitcnt vmcnt(0)
  v_cmp_gt_u32 vcc, 1, v22
  s_nop 1
  s_cmp_eq_u64 vcc, 0
  s_cbranch_scc1 L_polled_f3
  s_sleep 1
  s_sub_u32 s39, s39, 1
  s_cmp_lg_u32 s39, 0
  s_cbranch_scc1 L_poll_f3

L_polled_f3:
  s_xor_b32 s47, s99, 131072
  s_add_u32 s47, s47, 0
  buffer_load_dwordx4 v[176:179], v15, s[56:59], s47 offen offset:0 sc1
  buffer_load_dwordx4 v[180:183], v15, s[56:59], s47 offen offset:1024 sc1
  buffer_load_dwordx4 v[184:187], v15, s[56:59], s47 offen offset:2048 sc1
  buffer_load_dwordx4 v[188:191], v15, s[56:59], s47 offen offset:3072 sc1
  s_xor_b32 s47, s99, 262144
  s_add_u32 s47, s47, 4096
  buffer_load_dwordx4 v[192:195], v15, s[56:59], s47 offen offset:0 sc1
  buffer_load_dwordx4 v[196:199], v15, s[56:59], s47 offen offset:1024 sc1
  buffer_load_dwordx4 v[200:203], v15, s[56:59], s47 offen offset:2048 sc1
  buffer_load_dwordx4 v[204:207], v15, s[56:59], s47 offen offset:3072 sc1
  s_xor_b32 s47, s99, 393216
  s_add_u32 s47, s47, 8192
  buffer_load_dwordx4 v[208:211], v15, s[56:59], s47 offen offset:0 sc1
  buffer_load_dwordx4 v[212:215], v15, s[56:59], s47 offen offset:1024 sc1
  buffer_load_dwordx4 v[216:219], v15, s[56:59], s47 offen offset:2048 sc1
  buffer_load_dwordx4 v[220:223], v15, s[56:59], s47 offen offset:3072 sc1
  s_waitcnt vmcnt(8)
  v_lshlrev_b32 v22, 16, v176
  v_and_b32 v23, 0xffff0000, v176
  v_pk_add_f32 v[32:33], v[32:33], v[22:23]
  v_lshlrev_b32 v22, 16, v177
  v_and_b32 v23, 0xffff0000, v177
  v_pk_add_f32 v[34:35], v[34:35], v[22:23]
  v_lshlrev_b32 v22, 16, v178
  v_and_b32 v23, 0xffff0000, v178
  v_pk_add_f32 v[36:37], v[36:37], v[22:23]
  v_lshlrev_b32 v22, 16, v179
  v_and_b32 v23, 0xffff0000, v179
  v_pk_add_f32 v[38:39], v[38:39], v[22:23]
  v_lshlrev_b32 v22, 16, v180
  v_and_b32 v23, 0xffff0000, v180
  v_pk_add_f32 v[40:41], v[40:41], v[22:23]
  v_lshlrev_b32 v22, 16, v181
  v_and_b32 v23, 0xffff0000, v181
  v_pk_add_f32 v[42:43], v[42:43], v[22:23]
  v_lshlrev_b32 v22, 16, v182
  v_and_b32 v23, 0xffff0000, v182
  v_pk_add_f32 v[44:45], v[44:45], v[22:23]
  v_lshlrev_b32 v22, 16, v183
  v_and_b32 v23, 0xffff0000, v183
  v_pk_add_f32 v[46:47], v[46:47], v[22:23]
  v_lshlrev_b32 v22, 16, v184
  v_and_b32 v23, 0xffff0000, v184
  v_pk_add_f32 v[48:49], v[48:49], v[22:23]
  v_lshlrev_b32 v22, 16, v185
  v_and_b32 v23, 0xffff0000, v185
  v_pk_add_f32 v[50:51], v[50:51], v[22:23]
  v_lshlrev_b32 v22, 16, v186
  v_and_b32 v23, 0xffff0000, v186
  v_pk_add_f32 v[52:53], v[52:53], v[22:23]
  v_lshlrev_b32 v22, 16, v187
  v_and_b32 v23, 0xffff0000, v187
  v_pk_add_f32 v[54:55], v[54:55], v[22:23]
  v_lshlrev_b32 v22, 16, v188
  v_and_b32 v23, 0xffff0000, v188
  v_pk_add_f32 v[56:57], v[56:57], v[22:23]
  v_lshlrev_b32 v22, 16, v189
  v_and_b32 v23, 0xffff0000, v189
  v_pk_add_f32 v[58:59], v[58:59], v[22:23]
  v_lshlrev_b32 v22, 16, v190
  v_and_b32 v23, 0xffff0000, v190
  v_pk_add_f32 v[60:61], v[60:61], v[22:23]
  v_lshlrev_b32 v22, 16, v191
  v_and_b32 v23, 0xffff0000, v191
  v_pk_add_f32 v[62:63], v[62:63], v[22:23]
  s_waitcnt vmcnt(4)
  v_lshlrev_b32 v22, 16, v192
  v_and_b32 v23, 0xffff0000, v192
  v_pk_add_f32 v[32:33], v[32:33], v[22:23]
  v_lshlrev_b32 v22, 16, v193
  v_and_b32 v23, 0xffff0000, v193
  v_pk_add_f32 v[34:35], v[34:35], v[22:23]
  v_lshlrev_b32 v22, 16, v194
  v_and_b32 v23, 0xffff0000, v194
  v_pk_add_f32 v[36:37], v[36:37], v[22:23]
  v_lshlrev_b32 v22, 16, v195
  v_and_b32 v23, 0xffff0000, v195
  v_pk_add_f32 v[38:39], v[38:39], v[22:23]
  v_lshlrev_b32 v22, 16, v196
  v_and_b32 v23, 0xffff0000, v196
  v_pk_add_f32 v[40:41], v[40:41], v[22:23]
  v_lshlrev_b32 v22, 16, v197
  v_and_b32 v23, 0xffff0000, v197
  v_pk_add_f32 v[42:43], v[42:43], v[22:23]
  v_lshlrev_b32 v22, 16, v198
  v_and_b32 v23, 0xffff0000, v198
  v_pk_add_f32 v[44:45], v[44:45], v[22:23]
  v_lshlrev_b32 v22, 16, v199
  v_and_b32 v23, 0xffff0000, v199
  v_pk_add_f32 v[46:47], v[46:47], v[22:23]
  v_lshlrev_b32 v22, 16, v200
  v_and_b32 v23, 0xffff0000, v200
  v_pk_add_f32 v[48:49], v[48:49], v[22:23]
  v_lshlrev_b32 v22, 16, v201
  v_and_b32 v23, 0xffff0000, v201
  v_pk_add_f32 v[50:51], v[50:51], v[22:23]
  v_lshlrev_b32 v22, 16, v202
  v_and_b32 v23, 0xffff0000, v202
  v_pk_add_f32 v[52:53], v[52:53], v[22:23]
  v_lshlrev_b32 v22, 16, v203
  v_and_b32 v23, 0xffff0000, v203
  v_pk_add_f32 v[54:55], v[54:55], v[22:23]
  v_lshlrev_b32 v22, 16, v204
  v_and_b32 v23, 0xffff0000, v204
  v_pk_add_f32 v[56:57], v[56:57], v[22:23]
  v_lshlrev_b32 v22, 16, v205
  v_and_b32 v23, 0xffff0000, v205
  v_pk_add_f32 v[58:59], v[58:59], v[22:23]
  v_lshlrev_b32 v22, 16, v206
  v_and_b32 v23, 0xffff0000, v206
  v_pk_add_f32 v[60:61], v[60:61], v[22:23]
  v_lshlrev_b32 v22, 16, v207
  v_and_b32 v23, 0xffff0000, v207
  v_pk_add_f32 v[62:63], v[62:63], v[22:23]
  s_waitcnt vmcnt(0)
  v_lshlrev_b32 v22, 16, v208
  v_and_b32 v23, 0xffff0000, v208
  v_pk_add_f32 v[32:33], v[32:33], v[22:23]
  v_cvt_pk_bf16_f32 v160, v32, v33
  v_lshlrev_b32 v22, 16, v209
  v_and_b32 v23, 0xffff0000, v209
  v_pk_add_f32 v[34:35], v[34:35], v[22:23]
  v_cvt_pk_bf16_f32 v161, v34, v35
  v_lshlrev_b32 v22, 16, v210
  v_and_b32 v23, 0xffff0000, v210
  v_pk_add_f32 v[36:37], v[36:37], v[22:23]
  v_cvt_pk_bf16_f32 v162, v36, v37
  v_lshlrev_b32 v22, 16, v211
  v_and_b32 v23, 0xffff0000, v211
  v_pk_add_f32 v[38:39], v[38:39], v[22:23]
  v_cvt_pk_bf16_f32 v163, v38, v39
  v_permlane16_swap_b32 v160, v162
  s_nop 0
  v_permlane16_swap_b32 v161, v163
  buffer_store_dwordx4 v[160:163], v3, s[40:43], s78 offen offset:0
  v_lshlrev_b32 v22, 16, v212
  v_and_b32 v23, 0xffff0000, v212
  v_pk_add_f32 v[40:41], v[40:41], v[22:23]
  v_cvt_pk_bf16_f32 v164, v40, v41
  v_lshlrev_b32 v22, 16, v213
  v_and_b32 v23, 0xffff0000, v213
  v_pk_add_f32 v[42:43], v[42:43], v[22:23]
  v_cvt_pk_bf16_f32 v165, v42, v43
  v_lshlrev_b32 v22, 16, v214
  v_and_b32 v23, 0xffff0000, v214
  v_pk_add_f32 v[44:45], v[44:45], v[22:23]
  v_cvt_pk_bf16_f32 v166, v44, v45
  v_lshlrev_b32 v22, 16, v215
  v_and_b32 v23, 0xffff0000, v215
  v_pk_add_f32 v[46:47], v[46:47], v[22:23]
  v_cvt_pk_bf16_f32 v167, v46, v47
  v_permlane16_swap_b32 v164, v166
  s_nop 0
  v_permlane16_swap_b32 v165, v167
  buffer_store_dwordx4 v[164:167], v3, s[40:43], s79 offen offset:0
  v_lshlrev_b32 v22, 16, v216
  v_and_b32 v23, 0xffff0000, v216
  v_pk_add_f32 v[48:49], v[48:49], v[22:23]
  v_cvt_pk_bf16_f32 v168, v48, v49
  v_lshlrev_b32 v22, 16, v217
  v_and_b32 v23, 0xffff0000, v217
  v_pk_add_f32 v[50:51], v[50:51], v[22:23]
  v_cvt_pk_bf16_f32 v169, v50, v51
  v_lshlrev_b32 v22, 16, v218
  v_and_b32 v23, 0xffff0000, v218
  v_pk_add_f32 v[52:53], v[52:53], v[22:23]
  v_cvt_pk_bf16_f32 v170, v52, v53
  v_lshlrev_b32 v22, 16, v219
  v_and_b32 v23, 0xffff0000, v219
  v_pk_add_f32 v[54:55], v[54:55], v[22:23]
  v_cvt_pk_bf16_f32 v171, v54, v55
  v_permlane16_swap_b32 v168, v170
  s_nop 0
  v_permlane16_swap_b32 v169, v171
  buffer_store_dwordx4 v[168:171], v3, s[40:43], s78 offen offset:32
  v_lshlrev_b32 v22, 16, v220
  v_and_b32 v23, 0xffff0000, v220
  v_pk_add_f32 v[56:57], v[56:57], v[22:23]
  v_cvt_pk_bf16_f32 v172, v56, v57
  v_lshlrev_b32 v22, 16, v221
  v_and_b32 v23, 0xffff0000, v221
  v_pk_add_f32 v[58:59], v[58:59], v[22:23]
  v_cvt_pk_bf16_f32 v173, v58, v59
  v_lshlrev_b32 v22, 16, v222
  v_and_b32 v23, 0xffff0000, v222
  v_pk_add_f32 v[60:61], v[60:61], v[22:23]
  v_cvt_pk_bf16_f32 v174, v60, v61
  v_lshlrev_b32 v22, 16, v223
  v_and_b32 v23, 0xffff0000, v223
  v_pk_add_f32 v[62:63], v[62:63], v[22:23]
  v_cvt_pk_bf16_f32 v175, v62, v63
  v_permlane16_swap_b32 v172, v174
  s_nop 0
  v_permlane16_swap_b32 v173, v175
  buffer_store_dwordx4 v[172:175], v3, s[40:43], s79 offen offset:32
  s_endpgm
L_g2_slow1:
  s_mov_b32 s39, 0x8000
L_poll_f2s1:
  buffer_load_dword v20, v21, s[48:51], s98 offen sc1
  s_waitcnt vmcnt(0)
  v_cmp_gt_u32 vcc, 1, v20
  s_nop 1
  s_cmp_eq_u64 vcc, 0
  s_cbranch_scc1 L_polled_f2s1
  s_sleep 1
  s_sub_u32 s39, s39, 1
  s_cmp_lg_u32 s39, 0
  s_cbranch_scc1 L_poll_f2s1

L_polled_f2s1:
  s_branch L_g2_back1
L_g2_slow2:
  s_mov_b32 s39, 0x8000
L_poll_f2s2:
  buffer_load_dword v20, v21, s[48:51], s98 offen sc1
  s_waitcnt vmcnt(0)
  v_cmp_gt_u32 vcc, 1, v20
  s_nop 1
  s_cmp_eq_u64 vcc, 0
  s_cbranch_scc1 L_polled_f2s2
  s_sleep 1
  s_sub_u32 s39, s39, 1
  s_cmp_lg_u32 s39, 0
  s_cbranch_scc1 L_poll_f2s2

L_polled_f2s2:
  s_branch L_g2_back2
L_g2_slow3:
  s_mov_b32 s39, 0x8000
L_poll_f2s3:
  buffer_load_dword v20, v21, s[48:51], s98 offen sc1
  s_waitcnt vmcnt(0)
  v_cmp_gt_u32 vcc, 1, v20
  s_nop 1
  s_cmp_eq_u64 vcc, 0
  s_cbranch_scc1 L_polled_f2s3
  s_sleep 1
  s_sub_u32 s39, s39, 1
  s_cmp_lg_u32 s39, 0
  s_cbranch_scc1 L_poll_f2s3

L_polled_f2s3:
  s_branch L_g2_back3
L_gate_slow:
  v_mov_b32 v1, 1
  buffer_store_dword v1, v180, s[8:11], s99 offen sc1
  s_mov_b32 s39, 0x8000
L_poll_gate:
  buffer_load_dword v31, v21, s[8:11], 0 offen sc1
  s_waitcnt vmcnt(0)
  v_cmp_gt_u32 vcc, 1, v31
  s_nop 1
  s_cmp_eq_u64 vcc, 0
  s_cbranch_scc1 L_polled_gate
  s_sleep 1
  s_sub_u32 s39, s39, 1
  s_cmp_lg_u32 s39, 0
  s_cbranch_scc1 L_poll_gate

L_polled_gate:
  s_branch L_gate_back
L_p1_slow:
  s_and_b32 s98, s2, 7
  s_lshl_b32 s98, s98, 5
  s_mov_b32 s39, 0x8000
L_p1_slow_loop:
  buffer_load_dword v20, v178, s[48:51], 0 offen sc1
  buffer_load_dword v31, v180, s[8:11], s98 offen sc1
  s_waitcnt vmcnt(0)
  v_cmp_eq_u32 vcc, v20, v179
  s_nop 1
  s_cmp_eq_u64 vcc, 0
  s_cbranch_scc1 L_p1_done
  v_cmp_eq_u32 vcc, 0, v31
  s_nop 1
  s_cmp_eq_u64 vcc, 0
  s_cbranch_scc1 L_p1_done
  s_sleep 4
  s_sub_u32 s39, s39, 1
  s_cmp_lg_u32 s39, 0
  s_cbranch_scc1 L_p1_slow_loop

  s_branch L_p1_done
L_g2_slow0:
  s_mov_b32 s39, 0x8000
L_poll_f2s0:
  buffer_load_dword v20, v21, s[48:51], s98 offen sc1
  s_waitcnt vmcnt(0)
  v_cmp_gt_u32 vcc, 1, v20
  s_nop 1
  s_cmp_eq_u64 vcc, 0
  s_cbranch_scc1 L_polled_f2s0
  s_sleep 1
  s_sub_u32 s39, s39, 1
  s_cmp_lg_u32 s39, 0
  s_cbranch_scc1 L_poll_f2s0

L_polled_f2s0:
  s_branch L_g2_back0
L_sequential_preLN__ssm_conv_h3__glu_gated_geglu__prompt_kernel_end:
  s_endpgm
L_code_end:
.section .rodata,"a"
.p2align 6
.amdhsa_kernel sequential_preLN__ssm_conv_h3__glu_gated_geglu__prompt_kernel
  .amdhsa_next_free_vgpr 512
  .amdhsa_next_free_sgpr 102
  .amdhsa_accum_offset 256
  .amdhsa_group_segment_fixed_size 0
  .amdhsa_kernarg_size 104
  .amdhsa_user_sgpr_count 2
  .amdhsa_user_sgpr_kernarg_segment_ptr 1
  .amdhsa_system_sgpr_workgroup_id_x 1
  .amdhsa_float_denorm_mode_32 3
.end_amdhsa_kernel
```
